```python
import torch

def _softmax(x, axis=-1):
    return torch.softmax(x, dim=axis)
def _gelu(x):
    return torch.nn.functional.gelu(x, approximate="tanh")
def _silu(x):
    return torch.nn.functional.silu(x)
def _sigmoid(x):
    return torch.sigmoid(x)
def _layernorm(x, axis=-1, eps=1e-5):
    m = x.mean(dim=axis, keepdim=True)
    v = x.var(dim=axis, keepdim=True, unbiased=False)
    return (x - m) / torch.sqrt(v + eps)
def _scatter_add(tgt, idx, src, axis=0):
    return tgt.clone().index_add_(axis, idx, src)
def _segment_sum(src, seg, n):
    out = torch.zeros((n,) + src.shape[1:], dtype=src.dtype)
    return out.index_add_(0, seg, src)
def _pad(x, pw):
    flat = tuple(v for pair in reversed(pw) for v in pair)
    return torch.nn.functional.pad(x, flat)

kernel_name = 'interleave_layers__mha_block_cached__glu_gated_reglu__decode'

def setup_inputs():

    _w = (lambda a: (lambda t: t.to(torch.bfloat16) if t.is_floating_point() else t)(torch.as_tensor(a)))
    def _A_setup():
        B, Sq, D = 4, 1, 448
        H, Sk, Dh = 16, 4096, 256
        return {
            "x": _w((lambda *s: torch.randn(*s, dtype=torch.bfloat16) * 0.05)(B, Sq, D)),
            "k_cache": _w((lambda *s: torch.randn(*s, dtype=torch.bfloat16) * 0.8)(B, H, Sk, Dh)),
            "v_cache": _w((lambda *s: torch.randn(*s, dtype=torch.bfloat16) * 0.8)(B, H, Sk, Dh)),
            "wq": _w((lambda *s: torch.randn(*s, dtype=torch.bfloat16) * 0.8)(D, H * Dh) * (D ** -0.5)),
            "wo": _w((lambda *s: torch.randn(*s, dtype=torch.bfloat16) * 0.8)(H * Dh, D) * ((H * Dh) ** -0.5)),
        }
    _A_in = _A_setup()

    def _B_setup():
        B, S, D, F = 4, 1, 448, 1792
        return {
            "x": _w((lambda *s: torch.randn(*s, dtype=torch.bfloat16) * 0.05)(B, S, D)),
            "W_gate": _w((lambda *s: torch.randn(*s, dtype=torch.bfloat16) * 0.2)(D, F) * (2.0 / D) ** 0.5),
            "W_up": _w((lambda *s: torch.randn(*s, dtype=torch.bfloat16) * 0.2)(D, F) * (2.0 / D) ** 0.5),
            "W_down": _w((lambda *s: torch.randn(*s, dtype=torch.bfloat16) * 0.2)(F, D) * (1.0 / F) ** 0.5),
        }
    _B_in = _B_setup()

    return {
        "A_x": _A_in["x"],
        "A_k_cache": _A_in["k_cache"],
        "A_v_cache": _A_in["v_cache"],
        "A_wq": _A_in["wq"],
        "A_wo": _A_in["wo"],
        "B_x": _B_in["x"],
        "B_W_gate": _B_in["W_gate"],
        "B_W_up": _B_in["W_up"],
        "B_W_down": _B_in["W_down"],
    }

def reference(A_x, A_k_cache, A_v_cache, A_wq, A_wo, B_x, B_W_gate, B_W_up, B_W_down):
    def _A_ref(x, k_cache, v_cache, wq, wo):
        B, Sq, D = x.shape
        H, Dh = 16, 256
        q = (lambda x, *d: x.permute(*d))((x @ wq).reshape(B, Sq, H, Dh), 0, 2, 1, 3)
        scores = torch.einsum("bhqd,bhkd->bhqk", q, k_cache) * (Dh ** -0.5)
        p = _softmax(scores, axis=-1)
        o = torch.einsum("bhqk,bhkd->bhqd", p, v_cache)
        return (lambda x, *d: x.permute(*d))(o, 0, 2, 1, 3).reshape(B, Sq, H * Dh) @ wo

    def _B_ref(x, W_gate, W_up, W_down):
        gate = torch.einsum("bsd,df->bsf", x, W_gate)
        up = torch.einsum("bsd,df->bsf", x, W_up)
        gate = gate * (lambda x, dt: x.to(dt))(gate > 0, gate.dtype)
        h = gate * up
        return torch.einsum("bsf,fd->bsd", h, W_down)

    x = A_x
    x = x + _A_ref(_layernorm(x, axis=-1), A_k_cache, A_v_cache, A_wq, A_wo)
    x = x + _B_ref(_layernorm(x, axis=-1), B_W_gate, B_W_up, B_W_down)
    x = x + _A_ref(_layernorm(x, axis=-1), A_k_cache, A_v_cache, A_wq, A_wo)
    x = x + _B_ref(_layernorm(x, axis=-1), B_W_gate, B_W_up, B_W_down)
    return x
```

```asm
; @launch grid=(256,1,1) block=(256,1,1) lds=163840
.amdgcn_target "amdgcn-amd-amdhsa--gfx950"
.text
.globl interleave_layers__mha_block_cached__glu_gated_reglu__decode_kernel
.p2align 8
.type interleave_layers__mha_block_cached__glu_gated_reglu__decode_kernel,@function
interleave_layers__mha_block_cached__glu_gated_reglu__decode_kernel:
s_memrealtime s[94:95]
s_cmp_ge_u32 s2, 256
s_cbranch_scc1 L_end
s_lshr_b32 s97, s2, 3
s_and_b32 s96, s2, 7
s_cmp_lt_u32 s2, 32
s_cbranch_scc1 L_chain
L_attn:
s_load_dwordx16 s[64:79], s[0:1], 0
s_load_dwordx8 s[80:87], s[0:1], 64
v_lshrrev_b32 v43, 6, v0
v_and_b32 v40, 63, v0
v_readfirstlane_b32 s3, v43
v_and_b32 v41, 15, v0
v_lshrrev_b32 v42, 4, v40
s_mul_i32 s48, s96, 28
s_add_u32 s48, s48, s97
s_sub_u32 s48, s48, 4
s_add_u32 s2, s48, 32
s_mul_i32 s49, s48, 4682
s_lshr_b32 s49, s49, 16
s_mul_i32 s50, s49, 14
s_sub_u32 s50, s48, s50
s_lshl_b32 s50, s50, 2
s_add_u32 s50, s50, s3
s_mul_i32 s51, s50, 1198373
s_add_u32 s52, s51, 1198373
s_lshr_b32 s51, s51, 16
s_lshr_b32 s52, s52, 16
s_lshl_b32 s53, s49, 21
s_lshl_b32 s54, s51, 11
s_add_u32 s53, s53, s54
v_lshrrev_b32 v43, 2, v41
v_lshlrev_b32 v43, 9, v43
v_lshl_add_u32 v43, v42, 6, v43
v_and_b32 v44, 3, v41
v_lshl_add_u32 v43, v44, 4, v43
v_add_u32 v0, s53, v43
v_lshlrev_b32 v43, 9, v42
v_lshl_add_u32 v43, v41, 4, v43
v_add_u32 v1, s53, v43
s_mul_i32 s33, s3, 40960
s_mov_b32 s25, 0
s_mov_b32 s10, 0x8000000
s_mov_b32 s11, 0x20000
s_mov_b32 s14, 0x8000000
s_mov_b32 s15, 0x20000
s_mov_b32 s18, 8388608
s_mov_b32 s19, 0x20000
s_mov_b32 s22, 256
s_mov_b32 s23, 0x20000
s_mov_b32 s60, s96
s_lshl_b32 s61, s97, 2
s_add_u32 s61, s61, s3
s_sub_u32 s61, s61, 16
v_lshlrev_b32 v52, 4, v40
s_getpc_b64 s[56:57]
L_pc:
s_mov_b32 s58, L_codeend-L_pc
s_mov_b32 s59, 0x20000
s_lshl_b32 s62, s61, 10
buffer_load_dwordx4 a[124:127], v52, s[56:59], s62 offen
s_lshl_b32 s62, s61, 15
s_lshl_b32 s63, s60, 10
s_add_u32 s62, s62, s63
v_add_u32 v45, s62, v52
s_mov_b32 s59, 0x20000
s_waitcnt lgkmcnt(0)
s_mov_b32 s12, s68
s_mov_b32 s13, s69
s_mov_b32 s56, s70
s_mov_b32 s57, s71
s_mov_b32 s58, 3670016
buffer_load_dwordx4 a[128:131], v45, s[56:59], 0 offen offset:0
s_movk_i32 s62, 8192
buffer_load_dwordx4 a[132:135], v45, s[56:59], s62 offen offset:0
s_movk_i32 s62, 16384
buffer_load_dwordx4 a[136:139], v45, s[56:59], s62 offen offset:0
s_movk_i32 s62, 24576
buffer_load_dwordx4 a[140:143], v45, s[56:59], s62 offen offset:0
s_mov_b32 s24, 0
s_add_u32 m0, s33, 0
s_nop 0
buffer_load_dwordx4 v1, s[12:15], s24 offen offset:0 sc1 nt lds
buffer_load_dwordx4 v[184:187], v1, s[12:15], s24 offen offset:256 sc1 nt
s_mov_b32 s8, s66
s_mov_b32 s9, s67
s_mov_b32 s16, s86
s_mov_b32 s17, s87
s_mov_b32 s20, s84
s_mov_b32 s21, s85
s_mul_i32 s62, s60, 458752
s_lshl_b32 s63, s61, 12
s_add_u32 s62, s62, s63
v_add_u32 v47, s62, v52
v_lshrrev_b32 v43, 5, v40
s_mul_i32 s62, s61, 14336
s_lshl_b32 s63, s60, 7
s_add_u32 s62, s62, s63
v_mul_u32_u24 v46, 3584, v43
v_bfe_u32 v43, v40, 3, 2
v_lshl_add_u32 v46, v43, 10, v46
v_and_b32 v43, 7, v40
v_lshl_add_u32 v46, v43, 4, v46
v_add_u32 v46, s62, v46
s_mul_i32 s62, s61, 2341
s_lshr_b32 s62, s62, 16
s_mul_i32 s63, s62, 28
s_sub_u32 s63, s61, s63
s_lshl_b32 s63, s63, 11
s_lshl_b32 s62, s62, 3
s_add_u32 s62, s62, s60
s_mul_i32 s62, s62, 57344
s_add_u32 s62, s62, s63
v_add_u32 v52, s62, v52
v_lshlrev_b32 v2, 4, v40
v_add_u32 v2, s33, v2
s_lshl_b32 s54, s49, 9
v_lshlrev_b32 v43, 6, v42
v_lshl_add_u32 v43, v44, 4, v43
v_add_u32 v3, s54, v43
s_mul_i32 s54, s49, 9216
s_lshr_b32 s55, s50, 2
s_lshl_b32 s47, s55, 9
s_add_u32 s47, s47, s54
s_lshl_b32 s55, s55, 7
s_add_u32 s55, s55, s54
s_add_u32 s55, s55, 7168
v_lshlrev_b32 v43, 4, v40
s_sub_u32 s55, s55, 512
v_add_u32 v44, s55, v43
v_add_u32 v43, s47, v43
v_cmp_gt_u32 vcc, 32, v40
s_nop 1
v_cndmask_b32 v43, v44, v43, vcc
v_mov_b32 v44, 0x80000000
v_cmp_gt_u32 vcc, 40, v40
s_nop 1
v_cndmask_b32 v4, v44, v43, vcc
v_and_b32 v43, 1, v41
v_mov_b32 v44, 0xffff
v_lshlrev_b32 v43, 4, v43
v_lshlrev_b32 v44, v43, v44
v_bfe_u32 v43, v41, 1, 2
v_cmp_eq_u32 vcc, 0, v43
s_nop 1
v_cndmask_b32 v8, 0, v44, vcc
v_cmp_eq_u32 vcc, 1, v43
s_nop 1
v_cndmask_b32 v9, 0, v44, vcc
v_cmp_eq_u32 vcc, 2, v43
s_nop 1
v_cndmask_b32 v10, 0, v44, vcc
v_cmp_eq_u32 vcc, 3, v43
s_nop 1
v_cndmask_b32 v11, 0, v44, vcc
s_sub_u32 s52, s52, s51
s_cmp_eq_u32 s52, 19
s_cselect_b32 s26, 4096, 1073741824
s_cselect_b32 s27, 0, 0xff800000
s_mov_b32 s28, 0
s_mov_b32 s29, 1073741824
s_mov_b32 s30, 1048576
s_mov_b32 s31, 1073741824
s_mov_b32 s32, 0
s_mov_b32 s34, 100000
s_mov_b32 s35, 0x3db8aa3b
s_waitcnt vmcnt(6)
s_mov_b32 s56, s72
s_mov_b32 s57, s73
s_mov_b32 s58, 3670016
buffer_load_dwordx4 a[144:147], v47, s[56:59], 0 offen offset:0
s_waitcnt vmcnt(6)
buffer_load_dwordx4 a[148:151], v47, s[56:59], 0 offen offset:1024
s_waitcnt vmcnt(6)
buffer_load_dwordx4 a[152:155], v47, s[56:59], 0 offen offset:2048
s_waitcnt vmcnt(6)
buffer_load_dwordx4 a[156:159], v47, s[56:59], 0 offen offset:3072
s_waitcnt vmcnt(6)
s_add_u32 m0, s33, 3072
s_nop 0
buffer_load_dwordx4 v1, s[12:15], s24 offen offset:2048 sc1 nt lds
s_waitcnt vmcnt(6)
buffer_load_dwordx4 v[188:191], v1, s[12:15], s24 offen offset:2304 sc1 nt
s_waitcnt vmcnt(6)
s_mov_b32 s56, s76
s_mov_b32 s57, s77
s_mov_b32 s58, 1605632
s_movk_i32 s62, 7168
buffer_load_dwordx4 a[160:163], v46, s[56:59], 0 offen offset:0
s_waitcnt vmcnt(6)
buffer_load_dwordx4 a[164:167], v46, s[56:59], s62 offen offset:0
s_waitcnt vmcnt(6)
s_mov_b32 s56, s78
s_mov_b32 s57, s79
s_mov_b32 s58, 1605632
s_movk_i32 s62, 7168
buffer_load_dwordx4 a[168:171], v46, s[56:59], 0 offen offset:0
s_lshr_b32 s46, s61, 2
s_lshl_b32 s46, s46, 15
s_and_b32 s47, s61, 2
s_lshl_b32 s47, s47, 12
s_add_u32 s46, s46, s47
s_and_b32 s47, s61, 1
s_lshl1_add_u32 s47, s60, s47
s_lshl_b32 s47, s47, 10
s_add_u32 s46, s46, s47
s_and_b32 s47, s47, 0x2000
s_add_u32 s46, s46, s47
s_add_u32 s46, s46, 131072
s_sub_u32 s47, s61, 32
s_lshl_b32 s47, s47, 13
s_lshl_b32 s54, s60, 10
s_add_u32 s47, s47, s54
s_add_u32 s47, s47, 393216
s_cmp_lt_u32 s61, 32
s_cselect_b32 s46, s46, s47
s_cmp_lt_u32 s61, 96
s_cselect_b32 s46, s46, 1073741824
v_lshlrev_b32 v50, 4, v40
buffer_load_dword v50, v50, s[16:19], s46 offen
s_mul_i32 s47, s3, 147456
s_add_u32 s47, s47, 1048576
s_cmp_lt_u32 s3, 2
s_cselect_b32 s47, s47, 1073741824
buffer_load_dword v51, v4, s[16:19], s47 offen sc1
s_waitcnt vmcnt(6)
buffer_load_dwordx4 a[172:175], v46, s[56:59], s62 offen offset:0
s_waitcnt vmcnt(6)
s_mov_b32 s56, s80
s_mov_b32 s57, s81
s_mov_b32 s58, 1605632
buffer_load_dwordx4 a[176:179], v52, s[56:59], 0 offen offset:0
s_waitcnt vmcnt(6)
buffer_load_dwordx4 a[180:183], v52, s[56:59], 0 offen offset:1024
s_waitcnt vmcnt(6)
s_add_u32 s24, s24, 4096
buffer_load_dwordx4 v[192:195], v1, s[12:15], s24 offen offset:0 sc1 nt
s_waitcnt vmcnt(6)
buffer_load_dwordx4 v[200:203], v1, s[12:15], s24 offen offset:256 sc1 nt
s_waitcnt vmcnt(6)
buffer_load_dwordx4 v[196:199], v1, s[12:15], s24 offen offset:2048 sc1 nt
s_waitcnt vmcnt(6)
buffer_load_dwordx4 v[204:207], v1, s[12:15], s24 offen offset:2304 sc1 nt
s_waitcnt vmcnt(6)
s_add_u32 s24, s24, 4096
s_add_u32 m0, s33, 1024
s_nop 0
buffer_load_dwordx4 v1, s[12:15], s24 offen offset:0 sc1 nt lds
s_waitcnt vmcnt(6)
buffer_load_dwordx4 v[208:211], v1, s[12:15], s24 offen offset:256 sc1 nt
s_waitcnt vmcnt(6)
s_add_u32 m0, s33, 4096
s_nop 0
buffer_load_dwordx4 v1, s[12:15], s24 offen offset:2048 sc1 nt lds
s_waitcnt vmcnt(6)
buffer_load_dwordx4 v[212:215], v1, s[12:15], s24 offen offset:2304 sc1 nt
s_waitcnt vmcnt(6)
s_add_u32 s24, s24, 4096
buffer_load_dwordx4 v[216:219], v1, s[12:15], s24 offen offset:0 sc1 nt
s_waitcnt vmcnt(6)
buffer_load_dwordx4 v[224:227], v1, s[12:15], s24 offen offset:256 sc1 nt
s_waitcnt vmcnt(6)
buffer_load_dwordx4 v[220:223], v1, s[12:15], s24 offen offset:2048 sc1 nt
s_waitcnt vmcnt(6)
buffer_load_dwordx4 v[228:231], v1, s[12:15], s24 offen offset:2304 sc1 nt
s_waitcnt vmcnt(6)
s_add_u32 s24, s24, 4096
s_add_u32 m0, s33, 2048
s_nop 0
buffer_load_dwordx4 v1, s[12:15], s24 offen offset:0 sc1 nt lds
s_waitcnt vmcnt(6)
buffer_load_dwordx4 v[232:235], v1, s[12:15], s24 offen offset:256 sc1 nt
s_waitcnt vmcnt(6)
s_add_u32 m0, s33, 5120
s_nop 0
buffer_load_dwordx4 v1, s[12:15], s24 offen offset:2048 sc1 nt lds
s_waitcnt vmcnt(6)
buffer_load_dwordx4 v[236:239], v1, s[12:15], s24 offen offset:2304 sc1 nt
s_waitcnt vmcnt(6)
s_add_u32 s24, s24, 4096
buffer_load_dwordx4 v[240:243], v1, s[12:15], s24 offen offset:0 sc1 nt
s_waitcnt vmcnt(6)
buffer_load_dwordx4 v[248:251], v1, s[12:15], s24 offen offset:256 sc1 nt
s_waitcnt vmcnt(6)
buffer_load_dwordx4 v[244:247], v1, s[12:15], s24 offen offset:2048 sc1 nt
s_waitcnt vmcnt(6)
buffer_load_dwordx4 v[252:255], v1, s[12:15], s24 offen offset:2304 sc1 nt
s_waitcnt vmcnt(6)
s_add_u32 s24, s24, 4096
s_add_u32 m0, s33, 3072
s_nop 0
buffer_load_dwordx4 v1, s[12:15], s24 offen offset:0 sc1 nt lds
s_waitcnt vmcnt(6)
buffer_load_dwordx4 a[0:3], v1, s[12:15], s24 offen offset:256 sc1 nt
s_waitcnt vmcnt(6)
s_add_u32 m0, s33, 6144
s_nop 0
buffer_load_dwordx4 v1, s[12:15], s24 offen offset:2048 sc1 nt lds
s_waitcnt vmcnt(6)
buffer_load_dwordx4 a[4:7], v1, s[12:15], s24 offen offset:2304 sc1 nt
s_waitcnt vmcnt(6)
s_add_u32 s24, s24, 4096
buffer_load_dwordx4 a[8:11], v1, s[12:15], s24 offen offset:0 sc1 nt
s_lshl_b32 s36, s96, 4
buffer_load_dword v50, off, s[20:23], s36 sc1
s_waitcnt vmcnt(6)
buffer_load_dwordx4 a[16:19], v1, s[12:15], s24 offen offset:256 sc1 nt
s_waitcnt vmcnt(6)
buffer_load_dwordx4 a[12:15], v1, s[12:15], s24 offen offset:2048 sc1 nt
s_waitcnt vmcnt(6)
buffer_load_dwordx4 a[20:23], v1, s[12:15], s24 offen offset:2304 sc1 nt
s_waitcnt vmcnt(6)
s_add_u32 s24, s24, 4096
s_add_u32 m0, s33, 4096
s_nop 0
buffer_load_dwordx4 v1, s[12:15], s24 offen offset:0 sc1 nt lds
s_waitcnt vmcnt(6)
buffer_load_dwordx4 a[24:27], v1, s[12:15], s24 offen offset:256 sc1 nt
s_waitcnt vmcnt(6)
s_add_u32 m0, s33, 7168
s_nop 0
buffer_load_dwordx4 v1, s[12:15], s24 offen offset:2048 sc1 nt lds
s_waitcnt vmcnt(6)
buffer_load_dwordx4 a[28:31], v1, s[12:15], s24 offen offset:2304 sc1 nt
s_waitcnt vmcnt(6)
s_add_u32 s24, s24, s26
buffer_load_dwordx4 v[176:179], v1, s[12:15], s24 offen offset:0 sc1 nt
s_waitcnt vmcnt(6)
buffer_load_dwordx4 v[180:183], v1, s[12:15], s24 offen offset:256 sc1 nt
s_waitcnt vmcnt(6)
s_mov_b32 s24, 0
buffer_load_dwordx4 v[64:67], v0, s[8:11], s24 offen offset:0 sc1 nt
s_waitcnt vmcnt(6)
s_add_u32 m0, s33, 9984
s_nop 0
buffer_load_dwordx4 v0, s[8:11], s24 offen offset:256 sc1 nt lds
v_bfi_b32 v4, 1, v51, v4
L_cc_r:
v_readfirstlane_b32 s37, v50
s_getreg_b32 s62, hwreg(HW_REG_XCC_ID, 0, 3)
s_mul_i32 s63, s62, s62
s_lshl_b32 s63, s63, 8
s_add_u32 s62, s62, s63
s_lshl_b32 s62, s62, 10
s_add_u32 s62, s62, 4
s_and_b32 s63, s37, 63
s_cmp_lt_u32 s63, 4
s_cbranch_scc1 L_cc_s
s_sub_u32 s37, s37, s62
s_cmp_eq_u32 s37, 0
s_cselect_b32 s28, 1572864, 0
s_cbranch_scc0 L_req
L_req_r:
s_add_u32 s29, s28, 8192
s_lshl_b32 s44, s94, 4
s_add_u32 s44, s44, 11170
s_memrealtime s[42:43]
s_waitcnt lgkmcnt(0)
s_sub_u32 s45, s42, s94
s_cmpk_gt_i32 s45, 678
s_cbranch_scc1 L_pk_40
s_waitcnt vmcnt(4)
L_pk_40:
buffer_load_dwordx4 v[68:71], v0, s[8:11], s24 offen offset:2048 sc1 nt
buffer_load_dwordx4 v[12:15], v3, s[16:19], s28 offen sc1
buffer_load_dwordx4 v[16:19], v3, s[16:19], s28 offen offset:256 sc1
s_cmpk_gt_i32 s45, 738
s_cbranch_scc1 L_pk_41
s_waitcnt vmcnt(7)
L_pk_41:
buffer_load_dwordx4 v[72:75], v0, s[8:11], s24 offen offset:2304 sc1 nt
s_memrealtime s[42:43]
s_waitcnt vmcnt(10)
s_waitcnt lgkmcnt(0)
s_sub_u32 s45, s42, s94
s_cmpk_gt_i32 s45, 701
s_cbranch_scc1 L_pk_42
s_waitcnt vmcnt(6)
L_pk_42:
s_add_u32 s24, s24, 4096
buffer_load_dwordx4 v[76:79], v0, s[8:11], s24 offen offset:0 sc1 nt
s_waitcnt vmcnt(10)
s_cmpk_gt_i32 s45, 761
s_cbranch_scc1 L_pk_43
s_waitcnt vmcnt(7)
L_pk_43:
s_add_u32 m0, s33, 11008
s_nop 0
buffer_load_dwordx4 v0, s[8:11], s24 offen offset:256 sc1 nt lds
s_memrealtime s[42:43]
s_waitcnt vmcnt(10)
s_waitcnt lgkmcnt(0)
s_sub_u32 s45, s42, s94
s_cmpk_gt_i32 s45, 725
s_cbranch_scc1 L_pk_44
s_waitcnt vmcnt(6)
L_pk_44:
buffer_load_dwordx4 v[80:83], v0, s[8:11], s24 offen offset:2048 sc1 nt
s_waitcnt vmcnt(10)
s_cmpk_gt_i32 s45, 785
s_cbranch_scc1 L_pk_45
s_waitcnt vmcnt(7)
L_pk_45:
buffer_load_dwordx4 v[84:87], v0, s[8:11], s24 offen offset:2304 sc1 nt
s_memrealtime s[42:43]
s_waitcnt vmcnt(10)
s_waitcnt lgkmcnt(0)
s_sub_u32 s45, s42, s94
s_cmpk_gt_i32 s45, 749
s_cbranch_scc1 L_pk_46
s_waitcnt vmcnt(4)
L_pk_46:
s_add_u32 s24, s24, 4096
buffer_load_dwordx4 v[88:91], v0, s[8:11], s24 offen offset:0 sc1 nt
s_waitcnt vmcnt(10)
s_cmpk_gt_i32 s45, 809
s_cbranch_scc1 L_pk_47
s_waitcnt vmcnt(5)
L_pk_47:
s_add_u32 m0, s33, 12032
s_nop 0
buffer_load_dwordx4 v0, s[8:11], s24 offen offset:256 sc1 nt lds
s_memrealtime s[42:43]
s_waitcnt vmcnt(10)
ds_read_b128 v[52:55], v2 offset:10240
s_waitcnt lgkmcnt(0)
s_sub_u32 s45, s42, s94
s_cmpk_gt_i32 s45, 773
s_cbranch_scc1 L_pk_48
s_waitcnt vmcnt(4)
L_pk_48:
buffer_load_dwordx4 v[92:95], v0, s[8:11], s24 offen offset:2048 sc1 nt
s_waitcnt vmcnt(10)
s_cmpk_gt_i32 s45, 833
s_cbranch_scc1 L_pk_49
s_waitcnt vmcnt(5)
L_pk_49:
buffer_load_dwordx4 v[96:99], v0, s[8:11], s24 offen offset:2304 sc1 nt
s_waitcnt vmcnt(9)
v_max_u32 v30, v12, v16
v_cmp_eq_u32 vcc, -1, v30
s_cbranch_vccnz L_q10_s
L_q10_r:
v_mfma_f32_16x16x32_bf16 v[40:43], v[64:67], v[12:15], 0
v_mfma_f32_16x16x32_bf16 v[40:43], v[52:55], v[16:19], v[40:43]
s_memrealtime s[42:43]
s_waitcnt vmcnt(8)
s_waitcnt lgkmcnt(0)
s_sub_u32 s45, s42, s94
s_cmpk_gt_i32 s45, 816
s_cbranch_scc1 L_pk_50
s_waitcnt vmcnt(5)
L_pk_50:
s_add_u32 s24, s24, 4096
buffer_load_dwordx4 v[100:103], v0, s[8:11], s24 offen offset:0 sc1 nt
s_waitcnt vmcnt(8)
s_cmpk_gt_i32 s45, 866
s_cbranch_scc1 L_pk_51
s_waitcnt vmcnt(6)
L_pk_51:
s_add_u32 m0, s33, 13056
s_nop 0
buffer_load_dwordx4 v0, s[8:11], s24 offen offset:256 sc1 nt lds
v_mfma_f32_16x16x32_bf16 v[44:47], v[68:71], v[12:15], 0
v_mfma_f32_16x16x32_bf16 v[44:47], v[72:75], v[16:19], v[44:47]
s_memrealtime s[42:43]
s_waitcnt vmcnt(8)
ds_read_b128 v[56:59], v2 offset:11264
s_waitcnt lgkmcnt(0)
s_sub_u32 s45, s42, s94
s_cmpk_gt_i32 s45, 840
s_cbranch_scc1 L_pk_52
s_waitcnt vmcnt(5)
L_pk_52:
buffer_load_dwordx4 v[104:107], v0, s[8:11], s24 offen offset:2048 sc1 nt
s_waitcnt vmcnt(8)
s_cmpk_gt_i32 s45, 890
s_cbranch_scc1 L_pk_53
s_waitcnt vmcnt(6)
L_pk_53:
buffer_load_dwordx4 v[108:111], v0, s[8:11], s24 offen offset:2304 sc1 nt
v_mfma_f32_16x16x32_bf16 v[48:51], v[76:79], v[12:15], 0
v_mfma_f32_16x16x32_bf16 v[48:51], v[56:59], v[16:19], v[48:51]
v_mov_b32 v24, 0xff800000
v_add_f32_dpp v30, v41, v40 quad_perm:[1,1,1,1] row_mask:0xf bank_mask:0xf
v_add_f32_dpp v31, v43, v42 quad_perm:[3,3,3,3] row_mask:0xf bank_mask:0xf
s_memrealtime s[42:43]
s_waitcnt vmcnt(8)
s_waitcnt lgkmcnt(0)
s_sub_u32 s45, s42, s94
s_cmpk_gt_i32 s45, 864
s_cbranch_scc1 L_pk_54
s_waitcnt vmcnt(5)
L_pk_54:
s_add_u32 s24, s24, 4096
buffer_load_dwordx4 v[112:115], v0, s[8:11], s24 offen offset:0 sc1 nt
s_waitcnt vmcnt(8)
s_cmpk_gt_i32 s45, 914
s_cbranch_scc1 L_pk_55
s_waitcnt vmcnt(6)
L_pk_55:
s_add_u32 m0, s33, 14080
s_nop 0
buffer_load_dwordx4 v0, s[8:11], s24 offen offset:256 sc1 nt lds
v_mfma_f32_16x16x32_bf16 v[40:43], v[80:83], v[12:15], 0
v_mfma_f32_16x16x32_bf16 v[40:43], v[84:87], v[16:19], v[40:43]
v_add_f32_dpp v20, v31, v30 quad_perm:[2,2,2,2] row_mask:0xf bank_mask:0x1
v_add_f32_dpp v30, v45, v44 quad_perm:[1,1,1,1] row_mask:0xf bank_mask:0xf
v_add_f32_dpp v31, v47, v46 quad_perm:[3,3,3,3] row_mask:0xf bank_mask:0xf
s_memrealtime s[42:43]
s_waitcnt vmcnt(8)
ds_read_b128 v[52:55], v2 offset:12288
s_waitcnt lgkmcnt(0)
s_sub_u32 s45, s42, s94
s_cmpk_gt_i32 s45, 888
s_cbranch_scc1 L_pk_56
s_waitcnt vmcnt(5)
L_pk_56:
buffer_load_dwordx4 v[116:119], v0, s[8:11], s24 offen offset:2048 sc1 nt
s_waitcnt vmcnt(8)
s_cmpk_gt_i32 s45, 938
s_cbranch_scc1 L_pk_57
s_waitcnt vmcnt(6)
L_pk_57:
buffer_load_dwordx4 v[120:123], v0, s[8:11], s24 offen offset:2304 sc1 nt
v_mfma_f32_16x16x32_bf16 v[44:47], v[88:91], v[12:15], 0
v_mfma_f32_16x16x32_bf16 v[44:47], v[52:55], v[16:19], v[44:47]
v_add_f32_dpp v20, v31, v30 quad_perm:[2,2,2,2] row_mask:0xf bank_mask:0x2
v_add_f32_dpp v30, v49, v48 quad_perm:[1,1,1,1] row_mask:0xf bank_mask:0xf
v_add_f32_dpp v31, v51, v50 quad_perm:[3,3,3,3] row_mask:0xf bank_mask:0xf
s_memrealtime s[42:43]
s_waitcnt vmcnt(8)
s_waitcnt lgkmcnt(0)
s_sub_u32 s45, s42, s94
s_cmpk_gt_i32 s45, 911
s_cbranch_scc1 L_pk_58
s_waitcnt vmcnt(5)
L_pk_58:
s_add_u32 s24, s24, 4096
buffer_load_dwordx4 v[124:127], v0, s[8:11], s24 offen offset:0 sc1 nt
buffer_load_dwordx4 v[32:35], v3, s[16:19], s29 offen sc1
buffer_load_dwordx4 v[36:39], v3, s[16:19], s29 offen offset:256 sc1
s_waitcnt vmcnt(10)
s_cmpk_gt_i32 s45, 961
s_cbranch_scc1 L_pk_59
s_waitcnt vmcnt(8)
L_pk_59:
s_add_u32 m0, s33, 15104
s_nop 0
buffer_load_dwordx4 v0, s[8:11], s24 offen offset:256 sc1 nt lds
v_mfma_f32_16x16x32_bf16 v[48:51], v[92:95], v[12:15], 0
v_mfma_f32_16x16x32_bf16 v[48:51], v[96:99], v[16:19], v[48:51]
v_add_f32_dpp v20, v31, v30 quad_perm:[2,2,2,2] row_mask:0xf bank_mask:0x4
v_add_f32_dpp v30, v41, v40 quad_perm:[1,1,1,1] row_mask:0xf bank_mask:0xf
v_add_f32_dpp v31, v43, v42 quad_perm:[3,3,3,3] row_mask:0xf bank_mask:0xf
s_memrealtime s[42:43]
s_waitcnt vmcnt(10)
ds_read_b128 v[56:59], v2 offset:13312
s_waitcnt lgkmcnt(0)
s_sub_u32 s45, s42, s94
s_cmpk_gt_i32 s45, 935
s_cbranch_scc1 L_pk_60
s_waitcnt vmcnt(7)
L_pk_60:
buffer_load_dwordx4 v[128:131], v0, s[8:11], s24 offen offset:2048 sc1 nt
s_waitcnt vmcnt(10)
s_cmpk_gt_i32 s45, 985
s_cbranch_scc1 L_pk_61
s_waitcnt vmcnt(8)
L_pk_61:
buffer_load_dwordx4 v[132:135], v0, s[8:11], s24 offen offset:2304 sc1 nt
v_mfma_f32_16x16x32_bf16 v[40:43], v[100:103], v[12:15], 0
v_mfma_f32_16x16x32_bf16 v[40:43], v[56:59], v[16:19], v[40:43]
v_add_f32_dpp v20, v31, v30 quad_perm:[2,2,2,2] row_mask:0xf bank_mask:0x8
v_add_f32_dpp v30, v45, v44 quad_perm:[1,1,1,1] row_mask:0xf bank_mask:0xf
v_add_f32_dpp v31, v47, v46 quad_perm:[3,3,3,3] row_mask:0xf bank_mask:0xf
s_memrealtime s[42:43]
s_waitcnt vmcnt(10)
s_waitcnt lgkmcnt(0)
s_sub_u32 s45, s42, s94
s_cmpk_gt_i32 s45, 959
s_cbranch_scc1 L_pk_62
s_waitcnt vmcnt(7)
L_pk_62:
s_add_u32 s24, s24, 4096
buffer_load_dwordx4 v[136:139], v0, s[8:11], s24 offen offset:0 sc1 nt
s_waitcnt vmcnt(10)
s_cmpk_gt_i32 s45, 1009
s_cbranch_scc1 L_pk_63
s_waitcnt vmcnt(8)
L_pk_63:
s_add_u32 m0, s33, 16128
s_nop 0
buffer_load_dwordx4 v0, s[8:11], s24 offen offset:256 sc1 nt lds
v_mfma_f32_16x16x32_bf16 v[44:47], v[104:107], v[12:15], 0
v_mfma_f32_16x16x32_bf16 v[44:47], v[108:111], v[16:19], v[44:47]
v_add_f32_dpp v21, v31, v30 quad_perm:[2,2,2,2] row_mask:0xf bank_mask:0x1
v_add_f32_dpp v30, v49, v48 quad_perm:[1,1,1,1] row_mask:0xf bank_mask:0xf
v_add_f32_dpp v31, v51, v50 quad_perm:[3,3,3,3] row_mask:0xf bank_mask:0xf
s_memrealtime s[42:43]
s_waitcnt vmcnt(10)
ds_read_b128 v[52:55], v2 offset:14336
s_waitcnt lgkmcnt(0)
s_sub_u32 s45, s42, s94
s_cmpk_gt_i32 s45, 983
s_cbranch_scc1 L_pk_64
s_waitcnt vmcnt(7)
L_pk_64:
buffer_load_dwordx4 v[140:143], v0, s[8:11], s24 offen offset:2048 sc1 nt
s_waitcnt vmcnt(10)
s_cmpk_gt_i32 s45, 1033
s_cbranch_scc1 L_pk_65
s_waitcnt vmcnt(8)
L_pk_65:
buffer_load_dwordx4 v[144:147], v0, s[8:11], s24 offen offset:2304 sc1 nt
v_mfma_f32_16x16x32_bf16 v[48:51], v[112:115], v[12:15], 0
v_mfma_f32_16x16x32_bf16 v[48:51], v[52:55], v[16:19], v[48:51]
ds_read_b128 v[52:55], v2 offset:0
v_add_f32_dpp v21, v31, v30 quad_perm:[2,2,2,2] row_mask:0xf bank_mask:0x2
v_add_f32_dpp v30, v41, v40 quad_perm:[1,1,1,1] row_mask:0xf bank_mask:0xf
v_add_f32_dpp v31, v43, v42 quad_perm:[3,3,3,3] row_mask:0xf bank_mask:0xf
s_memrealtime s[42:43]
s_waitcnt vmcnt(10)
s_waitcnt lgkmcnt(0)
s_sub_u32 s45, s42, s94
s_cmpk_gt_i32 s45, 1006
s_cbranch_scc1 L_pk_66
s_waitcnt vmcnt(5)
L_pk_66:
s_add_u32 s24, s24, 4096
buffer_load_dwordx4 v[148:151], v0, s[8:11], s24 offen offset:0 sc1 nt
s_waitcnt vmcnt(10)
s_cmpk_gt_i32 s45, 1056
s_cbranch_scc1 L_pk_67
s_waitcnt vmcnt(6)
L_pk_67:
s_add_u32 m0, s33, 17152
s_nop 0
buffer_load_dwordx4 v0, s[8:11], s24 offen offset:256 sc1 nt lds
s_waitcnt vmcnt(9)
v_max_u32 v60, v32, v36
v_cmp_eq_u32 vcc, -1, v60
s_cbranch_vccnz L_q20_s
L_q20_r:
v_mfma_f32_16x16x32_bf16 v[40:43], v[116:119], v[12:15], 0
v_mfma_f32_16x16x32_bf16 v[40:43], v[120:123], v[16:19], v[40:43]
v_add_f32_dpp v21, v31, v30 quad_perm:[2,2,2,2] row_mask:0xf bank_mask:0x4
v_add_f32_dpp v30, v45, v44 quad_perm:[1,1,1,1] row_mask:0xf bank_mask:0xf
v_add_f32_dpp v31, v47, v46 quad_perm:[3,3,3,3] row_mask:0xf bank_mask:0xf
s_memrealtime s[42:43]
s_waitcnt vmcnt(8)
ds_read_b128 v[56:59], v2 offset:15360
s_waitcnt lgkmcnt(0)
s_sub_u32 s45, s42, s94
s_cmpk_gt_i32 s45, 1030
s_cbranch_scc1 L_pk_68
s_waitcnt vmcnt(5)
L_pk_68:
buffer_load_dwordx4 v[152:155], v0, s[8:11], s24 offen offset:2048 sc1 nt
s_waitcnt vmcnt(8)
s_cmpk_gt_i32 s45, 1080
s_cbranch_scc1 L_pk_69
s_waitcnt vmcnt(6)
L_pk_69:
buffer_load_dwordx4 v[156:159], v0, s[8:11], s24 offen offset:2304 sc1 nt
v_mfma_f32_16x16x32_bf16 v[44:47], v[124:127], v[12:15], 0
v_mfma_f32_16x16x32_bf16 v[44:47], v[56:59], v[16:19], v[44:47]
ds_read_b128 v[56:59], v2 offset:5120
v_add_f32_dpp v21, v31, v30 quad_perm:[2,2,2,2] row_mask:0xf bank_mask:0x8
v_add_f32_dpp v30, v49, v48 quad_perm:[1,1,1,1] row_mask:0xf bank_mask:0xf
v_add_f32_dpp v31, v51, v50 quad_perm:[3,3,3,3] row_mask:0xf bank_mask:0xf
s_memrealtime s[42:43]
s_waitcnt vmcnt(8)
s_waitcnt lgkmcnt(0)
s_sub_u32 s45, s42, s94
s_cmpk_gt_i32 s45, 1054
s_cbranch_scc1 L_pk_70
s_waitcnt vmcnt(5)
L_pk_70:
s_add_u32 s24, s24, 4096
buffer_load_dwordx4 v[160:163], v0, s[8:11], s24 offen offset:0 sc1 nt
s_waitcnt vmcnt(8)
s_cmpk_gt_i32 s45, 1104
s_cbranch_scc1 L_pk_71
s_waitcnt vmcnt(6)
L_pk_71:
s_add_u32 m0, s33, 18176
s_nop 0
buffer_load_dwordx4 v0, s[8:11], s24 offen offset:256 sc1 nt lds
v_mfma_f32_16x16x32_bf16 v[48:51], v[128:131], v[12:15], 0
v_mfma_f32_16x16x32_bf16 v[48:51], v[132:135], v[16:19], v[48:51]
v_add_f32_dpp v22, v31, v30 quad_perm:[2,2,2,2] row_mask:0xf bank_mask:0x1
v_add_f32_dpp v30, v41, v40 quad_perm:[1,1,1,1] row_mask:0xf bank_mask:0xf
v_add_f32_dpp v31, v43, v42 quad_perm:[3,3,3,3] row_mask:0xf bank_mask:0xf
s_nop 1
v_add_f32_dpp v22, v31, v30 quad_perm:[2,2,2,2] row_mask:0xf bank_mask:0x2
v_add_f32_dpp v30, v45, v44 quad_perm:[1,1,1,1] row_mask:0xf bank_mask:0xf
v_add_f32_dpp v31, v47, v46 quad_perm:[3,3,3,3] row_mask:0xf bank_mask:0xf
s_nop 1
v_add_f32_dpp v22, v31, v30 quad_perm:[2,2,2,2] row_mask:0xf bank_mask:0x4
v_add_f32_dpp v30, v49, v48 quad_perm:[1,1,1,1] row_mask:0xf bank_mask:0xf
v_add_f32_dpp v31, v51, v50 quad_perm:[3,3,3,3] row_mask:0xf bank_mask:0xf
s_nop 1
v_add_f32_dpp v22, v31, v30 quad_perm:[2,2,2,2] row_mask:0xf bank_mask:0x8
s_memrealtime s[42:43]
s_waitcnt vmcnt(8)
s_waitcnt lgkmcnt(0)
s_sub_u32 s45, s42, s94
s_cmpk_gt_i32 s45, 1078
s_cbranch_scc1 L_pk_72
s_waitcnt vmcnt(5)
L_pk_72:
buffer_load_dwordx4 v[164:167], v0, s[8:11], s24 offen offset:2048 sc1 nt
v_max3_f32 v6, v20, v21, v22
s_nop 1
v_max_f32_dpp v6, v6, v6 row_ror:4 row_mask:0xf bank_mask:0xf
s_nop 1
v_max_f32_dpp v6, v6, v6 row_ror:8 row_mask:0xf bank_mask:0xf
v_mov_b32 v30, v6
s_nop 1
v_permlane16_swap_b32 v6, v30
v_max_f32 v6, v6, v30
v_mov_b32 v30, v6
s_nop 1
v_permlane32_swap_b32 v6, v30
v_max_f32 v6, v6, v30
v_mul_f32 v6, s35, v6
v_fma_f32 v20, v20, s35, -v6
v_fma_f32 v21, v21, s35, -v6
v_fma_f32 v22, v22, s35, -v6
v_exp_f32 v20, v20
v_exp_f32 v21, v21
v_exp_f32 v22, v22
v_add_f32 v7, v20, v21
v_cvt_pk_bf16_f32 v20, v20, v20
v_cvt_pk_bf16_f32 v21, v21, v21
v_add_f32 v7, v7, v22
v_cvt_pk_bf16_f32 v22, v22, v22
v_and_b32_dpp v60, v20, v8 row_newbcast:0 row_mask:0xf bank_mask:0xf
v_and_b32_dpp v61, v20, v9 row_newbcast:0 row_mask:0xf bank_mask:0xf
v_and_b32_dpp v62, v20, v10 row_newbcast:0 row_mask:0xf bank_mask:0xf
v_and_b32_dpp v63, v20, v11 row_newbcast:0 row_mask:0xf bank_mask:0xf
s_waitcnt vmcnt(8)
s_cmpk_gt_i32 s45, 1128
s_cbranch_scc1 L_pk_73
s_waitcnt vmcnt(6)
L_pk_73:
buffer_load_dwordx4 v[168:171], v0, s[8:11], s24 offen offset:2304 sc1 nt
v_and_b32_dpp v26, v20, v8 row_newbcast:4 row_mask:0xf bank_mask:0xf
v_and_b32_dpp v27, v20, v9 row_newbcast:4 row_mask:0xf bank_mask:0xf
v_mfma_f32_16x16x32_bf16 v[32:35], v[60:63], v[52:55], 0
ds_read_b128 v[52:55], v2 offset:16384
v_and_b32_dpp v28, v20, v10 row_newbcast:4 row_mask:0xf bank_mask:0xf
v_and_b32_dpp v29, v20, v11 row_newbcast:4 row_mask:0xf bank_mask:0xf
v_mfma_f32_16x16x32_bf16 v[36:39], v[60:63], v[184:187], 0
v_and_b32_dpp v60, v20, v8 row_newbcast:8 row_mask:0xf bank_mask:0xf
v_and_b32_dpp v61, v20, v9 row_newbcast:8 row_mask:0xf bank_mask:0xf
v_mfma_f32_16x16x32_bf16 v[32:35], v[26:29], v[56:59], v[32:35]
ds_read_b128 v[56:59], v2 offset:1024
v_and_b32_dpp v62, v20, v10 row_newbcast:8 row_mask:0xf bank_mask:0xf
v_and_b32_dpp v63, v20, v11 row_newbcast:8 row_mask:0xf bank_mask:0xf
v_mfma_f32_16x16x32_bf16 v[36:39], v[26:29], v[188:191], v[36:39]
v_and_b32_dpp v26, v20, v8 row_newbcast:12 row_mask:0xf bank_mask:0xf
v_and_b32_dpp v27, v20, v9 row_newbcast:12 row_mask:0xf bank_mask:0xf
v_mfma_f32_16x16x32_bf16 v[32:35], v[60:63], v[192:195], v[32:35]
v_and_b32_dpp v28, v20, v10 row_newbcast:12 row_mask:0xf bank_mask:0xf
v_and_b32_dpp v29, v20, v11 row_newbcast:12 row_mask:0xf bank_mask:0xf
v_mfma_f32_16x16x32_bf16 v[36:39], v[60:63], v[200:203], v[36:39]
v_mfma_f32_16x16x32_bf16 v[40:43], v[136:139], v[12:15], 0
s_waitcnt lgkmcnt(1)
v_mfma_f32_16x16x32_bf16 v[40:43], v[52:55], v[16:19], v[40:43]
ds_read_b128 v[52:55], v2 offset:6144
s_memrealtime s[42:43]
s_waitcnt vmcnt(8)
s_waitcnt lgkmcnt(0)
s_sub_u32 s45, s42, s94
s_cmpk_gt_i32 s45, 1101
s_cbranch_scc1 L_pk_74
s_waitcnt vmcnt(5)
L_pk_74:
s_add_u32 s24, s24, s26
buffer_load_dwordx4 v[172:175], v0, s[8:11], s24 offen offset:0 sc1 nt
v_and_b32_dpp v60, v21, v8 row_newbcast:0 row_mask:0xf bank_mask:0xf
v_and_b32_dpp v61, v21, v9 row_newbcast:0 row_mask:0xf bank_mask:0xf
v_mfma_f32_16x16x32_bf16 v[32:35], v[26:29], v[196:199], v[32:35]
v_and_b32_dpp v62, v21, v10 row_newbcast:0 row_mask:0xf bank_mask:0xf
v_and_b32_dpp v63, v21, v11 row_newbcast:0 row_mask:0xf bank_mask:0xf
v_mfma_f32_16x16x32_bf16 v[36:39], v[26:29], v[204:207], v[36:39]
v_and_b32_dpp v26, v21, v8 row_newbcast:4 row_mask:0xf bank_mask:0xf
v_and_b32_dpp v27, v21, v9 row_newbcast:4 row_mask:0xf bank_mask:0xf
v_mfma_f32_16x16x32_bf16 v[32:35], v[60:63], v[56:59], v[32:35]
ds_read_b128 v[56:59], v2 offset:2048
v_and_b32_dpp v28, v21, v10 row_newbcast:4 row_mask:0xf bank_mask:0xf
v_and_b32_dpp v29, v21, v11 row_newbcast:4 row_mask:0xf bank_mask:0xf
v_mfma_f32_16x16x32_bf16 v[36:39], v[60:63], v[208:211], v[36:39]
v_and_b32_dpp v60, v21, v8 row_newbcast:8 row_mask:0xf bank_mask:0xf
v_and_b32_dpp v61, v21, v9 row_newbcast:8 row_mask:0xf bank_mask:0xf
v_mfma_f32_16x16x32_bf16 v[32:35], v[26:29], v[52:55], v[32:35]
v_and_b32_dpp v62, v21, v10 row_newbcast:8 row_mask:0xf bank_mask:0xf
v_and_b32_dpp v63, v21, v11 row_newbcast:8 row_mask:0xf bank_mask:0xf
v_mfma_f32_16x16x32_bf16 v[36:39], v[26:29], v[212:215], v[36:39]
s_waitcnt vmcnt(8)
s_cmpk_gt_i32 s45, 1151
s_cbranch_scc1 L_pk_75
s_waitcnt vmcnt(6)
L_pk_75:
s_add_u32 m0, s33, 19200
s_nop 0
buffer_load_dwordx4 v0, s[8:11], s24 offen offset:256 sc1 nt lds
v_and_b32_dpp v26, v21, v8 row_newbcast:12 row_mask:0xf bank_mask:0xf
v_and_b32_dpp v27, v21, v9 row_newbcast:12 row_mask:0xf bank_mask:0xf
v_mfma_f32_16x16x32_bf16 v[32:35], v[60:63], v[216:219], v[32:35]
v_and_b32_dpp v28, v21, v10 row_newbcast:12 row_mask:0xf bank_mask:0xf
v_and_b32_dpp v29, v21, v11 row_newbcast:12 row_mask:0xf bank_mask:0xf
v_mfma_f32_16x16x32_bf16 v[36:39], v[60:63], v[224:227], v[36:39]
v_and_b32_dpp v60, v22, v8 row_newbcast:0 row_mask:0xf bank_mask:0xf
v_and_b32_dpp v61, v22, v9 row_newbcast:0 row_mask:0xf bank_mask:0xf
v_mfma_f32_16x16x32_bf16 v[32:35], v[26:29], v[220:223], v[32:35]
v_and_b32_dpp v62, v22, v10 row_newbcast:0 row_mask:0xf bank_mask:0xf
v_and_b32_dpp v63, v22, v11 row_newbcast:0 row_mask:0xf bank_mask:0xf
v_mfma_f32_16x16x32_bf16 v[36:39], v[26:29], v[228:231], v[36:39]
v_and_b32_dpp v26, v22, v8 row_newbcast:4 row_mask:0xf bank_mask:0xf
v_and_b32_dpp v27, v22, v9 row_newbcast:4 row_mask:0xf bank_mask:0xf
s_waitcnt lgkmcnt(0)
v_mfma_f32_16x16x32_bf16 v[32:35], v[60:63], v[56:59], v[32:35]
ds_read_b128 v[56:59], v2 offset:7168
v_and_b32_dpp v28, v22, v10 row_newbcast:4 row_mask:0xf bank_mask:0xf
v_and_b32_dpp v29, v22, v11 row_newbcast:4 row_mask:0xf bank_mask:0xf
v_mfma_f32_16x16x32_bf16 v[36:39], v[60:63], v[232:235], v[36:39]
v_mfma_f32_16x16x32_bf16 v[44:47], v[140:143], v[12:15], 0
v_mfma_f32_16x16x32_bf16 v[44:47], v[144:147], v[16:19], v[44:47]
s_add_u32 s28, s28, 8192
s_add_u32 s29, s28, 24576
v_mfma_f32_16x16x32_bf16 v[48:51], v[148:151], v[12:15], 0
s_waitcnt vmcnt(8)
ds_read_b128 v[52:55], v2 offset:17408
s_waitcnt lgkmcnt(0)
v_mfma_f32_16x16x32_bf16 v[48:51], v[52:55], v[16:19], v[48:51]
v_add_f32_dpp v30, v41, v40 quad_perm:[1,1,1,1] row_mask:0xf bank_mask:0xf
v_add_f32_dpp v31, v43, v42 quad_perm:[3,3,3,3] row_mask:0xf bank_mask:0xf
s_cmpk_gt_i32 s45, 1101
s_cbranch_scc1 L_pk_76
s_waitcnt vmcnt(5)
L_pk_76:
s_mov_b32 s24, 33554432
buffer_load_dwordx4 a[32:35], v0, s[8:11], s24 offen offset:0 sc1 nt
v_and_b32_dpp v60, v22, v8 row_newbcast:8 row_mask:0xf bank_mask:0xf
v_and_b32_dpp v61, v22, v9 row_newbcast:8 row_mask:0xf bank_mask:0xf
v_mfma_f32_16x16x32_bf16 v[32:35], v[26:29], v[56:59], v[32:35]
v_and_b32_dpp v62, v22, v10 row_newbcast:8 row_mask:0xf bank_mask:0xf
v_and_b32_dpp v63, v22, v11 row_newbcast:8 row_mask:0xf bank_mask:0xf
v_mfma_f32_16x16x32_bf16 v[36:39], v[26:29], v[236:239], v[36:39]
v_and_b32_dpp v26, v22, v8 row_newbcast:12 row_mask:0xf bank_mask:0xf
v_and_b32_dpp v27, v22, v9 row_newbcast:12 row_mask:0xf bank_mask:0xf
v_mfma_f32_16x16x32_bf16 v[32:35], v[60:63], v[240:243], v[32:35]
v_and_b32_dpp v28, v22, v10 row_newbcast:12 row_mask:0xf bank_mask:0xf
v_and_b32_dpp v29, v22, v11 row_newbcast:12 row_mask:0xf bank_mask:0xf
v_mfma_f32_16x16x32_bf16 v[36:39], v[60:63], v[248:251], v[36:39]
s_nop 0
v_mfma_f32_16x16x32_bf16 v[32:35], v[26:29], v[244:247], v[32:35]
v_mfma_f32_16x16x32_bf16 v[36:39], v[26:29], v[252:255], v[36:39]
s_waitcnt vmcnt(8)
s_cmpk_gt_i32 s45, 1151
s_cbranch_scc1 L_pk_77
s_waitcnt vmcnt(6)
L_pk_77:
s_add_u32 m0, s33, 30464
s_nop 0
buffer_load_dwordx4 v0, s[8:11], s24 offen offset:256 sc1 nt lds
v_mfma_f32_16x16x32_bf16 v[40:43], v[152:155], v[12:15], 0
s_waitcnt vmcnt(8)
v_mfma_f32_16x16x32_bf16 v[40:43], v[156:159], v[16:19], v[40:43]
v_add_f32_dpp v23, v31, v30 quad_perm:[2,2,2,2] row_mask:0xf bank_mask:0x1
v_add_f32_dpp v30, v45, v44 quad_perm:[1,1,1,1] row_mask:0xf bank_mask:0xf
v_add_f32_dpp v31, v47, v46 quad_perm:[3,3,3,3] row_mask:0xf bank_mask:0xf
s_cmpk_gt_i32 s45, 1101
s_cbranch_scc1 L_pk_78
s_waitcnt vmcnt(5)
L_pk_78:
buffer_load_dwordx4 a[36:39], v0, s[8:11], s24 offen offset:2048 sc1 nt
s_waitcnt vmcnt(8)
s_cmpk_gt_i32 s45, 1151
s_cbranch_scc1 L_pk_79
s_waitcnt vmcnt(6)
L_pk_79:
buffer_load_dwordx4 a[40:43], v0, s[8:11], s24 offen offset:2304 sc1 nt
v_mfma_f32_16x16x32_bf16 v[44:47], v[160:163], v[12:15], 0
s_waitcnt vmcnt(8)
ds_read_b128 v[52:55], v2 offset:18432
s_waitcnt lgkmcnt(0)
v_mfma_f32_16x16x32_bf16 v[44:47], v[52:55], v[16:19], v[44:47]
ds_read_b128 v[52:55], v2 offset:3072
v_add_f32_dpp v23, v31, v30 quad_perm:[2,2,2,2] row_mask:0xf bank_mask:0x2
v_add_f32_dpp v30, v49, v48 quad_perm:[1,1,1,1] row_mask:0xf bank_mask:0xf
v_add_f32_dpp v31, v51, v50 quad_perm:[3,3,3,3] row_mask:0xf bank_mask:0xf
s_cmpk_gt_i32 s45, 1101
s_cbranch_scc1 L_pk_80
s_waitcnt vmcnt(5)
L_pk_80:
s_add_u32 s24, s24, 4096
buffer_load_dwordx4 a[44:47], v0, s[8:11], s24 offen offset:0 sc1 nt
s_waitcnt vmcnt(8)
s_cmpk_gt_i32 s45, 1151
s_cbranch_scc1 L_pk_81
s_waitcnt vmcnt(6)
L_pk_81:
s_add_u32 m0, s33, 31488
s_nop 0
buffer_load_dwordx4 v0, s[8:11], s24 offen offset:256 sc1 nt lds
v_mfma_f32_16x16x32_bf16 v[48:51], v[164:167], v[12:15], 0
s_waitcnt vmcnt(8)
v_mfma_f32_16x16x32_bf16 v[48:51], v[168:171], v[16:19], v[48:51]
v_add_f32_dpp v23, v31, v30 quad_perm:[2,2,2,2] row_mask:0xf bank_mask:0x4
v_add_f32_dpp v30, v41, v40 quad_perm:[1,1,1,1] row_mask:0xf bank_mask:0xf
v_add_f32_dpp v31, v43, v42 quad_perm:[3,3,3,3] row_mask:0xf bank_mask:0xf
s_cmpk_gt_i32 s45, 1101
s_cbranch_scc1 L_pk_82
s_waitcnt vmcnt(5)
L_pk_82:
buffer_load_dwordx4 a[48:51], v0, s[8:11], s24 offen offset:2048 sc1 nt
s_waitcnt vmcnt(8)
s_cmpk_gt_i32 s45, 1151
s_cbranch_scc1 L_pk_83
s_waitcnt vmcnt(6)
L_pk_83:
buffer_load_dwordx4 a[52:55], v0, s[8:11], s24 offen offset:2304 sc1 nt
v_mfma_f32_16x16x32_bf16 v[40:43], v[172:175], v[12:15], 0
s_waitcnt vmcnt(8)
ds_read_b128 v[56:59], v2 offset:19456
s_waitcnt lgkmcnt(0)
v_mfma_f32_16x16x32_bf16 v[40:43], v[56:59], v[16:19], v[40:43]
ds_read_b128 v[56:59], v2 offset:8192
v_add_f32_dpp v23, v31, v30 quad_perm:[2,2,2,2] row_mask:0xf bank_mask:0x8
v_add_f32_dpp v30, v45, v44 quad_perm:[1,1,1,1] row_mask:0xf bank_mask:0xf
v_add_f32_dpp v31, v47, v46 quad_perm:[3,3,3,3] row_mask:0xf bank_mask:0xf
s_nop 1
v_add_f32_dpp v24, v31, v30 quad_perm:[2,2,2,2] row_mask:0xf bank_mask:0x1
v_add_f32_dpp v30, v49, v48 quad_perm:[1,1,1,1] row_mask:0xf bank_mask:0xf
v_add_f32_dpp v31, v51, v50 quad_perm:[3,3,3,3] row_mask:0xf bank_mask:0xf
s_nop 1
v_add_f32_dpp v24, v31, v30 quad_perm:[2,2,2,2] row_mask:0xf bank_mask:0x2
v_add_f32_dpp v30, v41, v40 quad_perm:[1,1,1,1] row_mask:0xf bank_mask:0xf
v_add_f32_dpp v31, v43, v42 quad_perm:[3,3,3,3] row_mask:0xf bank_mask:0xf
v_add_f32 v30, s27, v30
s_nop 1
v_add_f32_dpp v24, v31, v30 quad_perm:[2,2,2,2] row_mask:0xf bank_mask:0x4
v_max_f32 v31, v23, v24
s_nop 1
v_max_f32_dpp v31, v31, v31 row_ror:4 row_mask:0xf bank_mask:0xf
s_nop 1
v_max_f32_dpp v31, v31, v31 row_ror:8 row_mask:0xf bank_mask:0xf
v_mov_b32 v30, v31
s_nop 1
v_permlane16_swap_b32 v31, v30
v_max_f32 v31, v31, v30
v_mov_b32 v30, v31
s_nop 1
v_permlane32_swap_b32 v31, v30
v_max_f32 v31, v31, v30
v_mul_f32 v31, s35, v31
v_max_f32 v31, v31, v6
v_fma_f32 v23, v23, s35, -v31
v_fma_f32 v24, v24, s35, -v31
v_sub_f32 v30, v6, v31
v_exp_f32 v23, v23
v_exp_f32 v24, v24
v_exp_f32 v30, v30
v_mov_b32 v6, v31
v_add_f32 v31, v23, v24
v_cvt_pk_bf16_f32 v23, v23, v23
v_cvt_pk_bf16_f32 v24, v24, v24
s_nop 0
v_and_b32_dpp v40, v23, v8 row_newbcast:0 row_mask:0xf bank_mask:0xf
v_and_b32_dpp v41, v23, v9 row_newbcast:0 row_mask:0xf bank_mask:0xf
v_and_b32_dpp v42, v23, v10 row_newbcast:0 row_mask:0xf bank_mask:0xf
v_and_b32_dpp v43, v23, v11 row_newbcast:0 row_mask:0xf bank_mask:0xf
v_mul_f32_dpp v32, v30, v32 quad_perm:[0,0,0,0] row_mask:0xf bank_mask:0xf
v_mul_f32_dpp v33, v30, v33 quad_perm:[0,0,0,0] row_mask:0xf bank_mask:0xf
v_mul_f32_dpp v34, v30, v34 quad_perm:[0,0,0,0] row_mask:0xf bank_mask:0xf
v_mul_f32_dpp v35, v30, v35 quad_perm:[0,0,0,0] row_mask:0xf bank_mask:0xf
v_mul_f32_dpp v36, v30, v36 quad_perm:[0,0,0,0] row_mask:0xf bank_mask:0xf
v_mul_f32_dpp v37, v30, v37 quad_perm:[0,0,0,0] row_mask:0xf bank_mask:0xf
v_mul_f32_dpp v38, v30, v38 quad_perm:[0,0,0,0] row_mask:0xf bank_mask:0xf
v_mul_f32_dpp v39, v30, v39 quad_perm:[0,0,0,0] row_mask:0xf bank_mask:0xf
v_fma_f32 v7, v7, v30, v31
s_cmpk_gt_i32 s45, 1101
s_cbranch_scc1 L_pk_84
s_waitcnt vmcnt(5)
L_pk_84:
s_add_u32 s24, s24, 4096
buffer_load_dwordx4 a[56:59], v0, s[8:11], s24 offen offset:0 sc1 nt
v_and_b32_dpp v44, v23, v8 row_newbcast:4 row_mask:0xf bank_mask:0xf
v_and_b32_dpp v45, v23, v9 row_newbcast:4 row_mask:0xf bank_mask:0xf
v_mfma_f32_16x16x32_bf16 v[32:35], v[40:43], v[52:55], v[32:35]
ds_read_b128 v[52:55], v2 offset:4096
v_and_b32_dpp v46, v23, v10 row_newbcast:4 row_mask:0xf bank_mask:0xf
v_and_b32_dpp v47, v23, v11 row_newbcast:4 row_mask:0xf bank_mask:0xf
v_mfma_f32_16x16x32_bf16 v[36:39], v[40:43], a[0:3], v[36:39]
v_and_b32_dpp v40, v23, v8 row_newbcast:8 row_mask:0xf bank_mask:0xf
v_and_b32_dpp v41, v23, v9 row_newbcast:8 row_mask:0xf bank_mask:0xf
s_waitcnt lgkmcnt(1)
v_mfma_f32_16x16x32_bf16 v[32:35], v[44:47], v[56:59], v[32:35]
ds_read_b128 v[56:59], v2 offset:9216
v_and_b32_dpp v42, v23, v10 row_newbcast:8 row_mask:0xf bank_mask:0xf
v_and_b32_dpp v43, v23, v11 row_newbcast:8 row_mask:0xf bank_mask:0xf
v_mfma_f32_16x16x32_bf16 v[36:39], v[44:47], a[4:7], v[36:39]
v_and_b32_dpp v44, v23, v8 row_newbcast:12 row_mask:0xf bank_mask:0xf
v_and_b32_dpp v45, v23, v9 row_newbcast:12 row_mask:0xf bank_mask:0xf
v_mfma_f32_16x16x32_bf16 v[32:35], v[40:43], a[8:11], v[32:35]
v_and_b32_dpp v46, v23, v10 row_newbcast:12 row_mask:0xf bank_mask:0xf
v_and_b32_dpp v47, v23, v11 row_newbcast:12 row_mask:0xf bank_mask:0xf
v_mfma_f32_16x16x32_bf16 v[36:39], v[40:43], a[16:19], v[36:39]
v_and_b32_dpp v40, v24, v8 row_newbcast:0 row_mask:0xf bank_mask:0xf
v_and_b32_dpp v41, v24, v9 row_newbcast:0 row_mask:0xf bank_mask:0xf
v_mfma_f32_16x16x32_bf16 v[32:35], v[44:47], a[12:15], v[32:35]
v_and_b32_dpp v42, v24, v10 row_newbcast:0 row_mask:0xf bank_mask:0xf
v_and_b32_dpp v43, v24, v11 row_newbcast:0 row_mask:0xf bank_mask:0xf
v_mfma_f32_16x16x32_bf16 v[36:39], v[44:47], a[20:23], v[36:39]
v_and_b32_dpp v44, v24, v8 row_newbcast:4 row_mask:0xf bank_mask:0xf
v_and_b32_dpp v45, v24, v9 row_newbcast:4 row_mask:0xf bank_mask:0xf
s_waitcnt lgkmcnt(1)
v_mfma_f32_16x16x32_bf16 v[32:35], v[40:43], v[52:55], v[32:35]
v_and_b32_dpp v46, v24, v10 row_newbcast:4 row_mask:0xf bank_mask:0xf
v_and_b32_dpp v47, v24, v11 row_newbcast:4 row_mask:0xf bank_mask:0xf
v_mfma_f32_16x16x32_bf16 v[36:39], v[40:43], a[24:27], v[36:39]
v_and_b32_dpp v40, v24, v8 row_newbcast:8 row_mask:0xf bank_mask:0xf
v_and_b32_dpp v41, v24, v9 row_newbcast:8 row_mask:0xf bank_mask:0xf
s_waitcnt lgkmcnt(0)
v_mfma_f32_16x16x32_bf16 v[32:35], v[44:47], v[56:59], v[32:35]
v_and_b32_dpp v42, v24, v10 row_newbcast:8 row_mask:0xf bank_mask:0xf
v_and_b32_dpp v43, v24, v11 row_newbcast:8 row_mask:0xf bank_mask:0xf
v_mfma_f32_16x16x32_bf16 v[36:39], v[44:47], a[28:31], v[36:39]
s_nop 0
v_mfma_f32_16x16x32_bf16 v[32:35], v[40:43], v[176:179], v[32:35]
v_mfma_f32_16x16x32_bf16 v[36:39], v[40:43], v[180:183], v[36:39]
v_add_f32_dpp v7, v7, v7 row_ror:4 row_mask:0xf bank_mask:0xf
s_nop 1
v_add_f32_dpp v7, v7, v7 row_ror:8 row_mask:0xf bank_mask:0xf
v_mov_b32 v30, v7
s_nop 1
v_permlane16_swap_b32 v7, v30
v_add_f32 v7, v7, v30
v_mov_b32 v30, v7
s_nop 1
v_permlane32_swap_b32 v7, v30
v_add_f32 v7, v7, v30
v_cvt_pk_bf16_f32 v32, v32, v33
v_cvt_pk_bf16_f32 v33, v34, v35
v_cvt_pk_bf16_f32 v34, v36, v37
v_cvt_pk_bf16_f32 v35, v38, v39
v_mov_b32_dpp v32, v6 quad_perm:[0,0,0,0] row_mask:0xc bank_mask:0xf
v_mov_b32_dpp v33, v7 quad_perm:[0,0,0,0] row_mask:0xc bank_mask:0xf
ds_write_b128 v2, v[32:35] offset:39936
v_subrev_u32 v24, s33, v2
v_lshrrev_b32 v60, 8, v24
v_mul_u32_u24 v60, 40704, v60
v_add_u32 v24, v24, v60
s_cmp_lg_u32 s3, 0
s_waitcnt lgkmcnt(0)
s_barrier
s_cbranch_scc1 L_np11
L_np11_e:
ds_read_b64 v[6:7], v24 offset:40448
ds_read_b128 v[32:35], v24 offset:39936
ds_read_b128 v[36:39], v24 offset:40192
s_waitcnt lgkmcnt(2)
v_mov_b32 v60, v6
v_mov_b32 v61, v6
s_nop 1
v_permlane16_swap_b32 v60, v61
v_max_f32 v60, v60, v61
v_mov_b32 v61, v60
s_nop 1
v_permlane32_swap_b32 v60, v61
v_max_f32 v24, v60, v61
v_sub_f32 v6, v6, v24
v_exp_f32 v6, v6
s_nop 0
v_cvt_pk_bf16_f32 v60, v6, v6
v_and_b32 v20, v60, v8
v_and_b32 v21, v60, v9
v_and_b32 v22, v60, v10
v_and_b32 v23, v60, v11
s_cmp_lg_u32 s37, 0
v_mul_f32 v7, v7, v6
v_mov_b32 v6, v7
s_waitcnt lgkmcnt(1)
v_mfma_f32_16x16x32_bf16 v[60:63], v[20:23], v[32:35], 0
s_waitcnt lgkmcnt(0)
v_mfma_f32_16x16x32_bf16 v[32:35], v[20:23], v[36:39], 0
v_permlane16_swap_b32 v7, v6
v_add_f32 v7, v7, v6
v_mov_b32 v6, v7
s_nop 1
v_permlane32_swap_b32 v7, v6
v_add_f32 v7, v7, v6
v_and_b32 v6, -2, v4
v_xor_b32 v4, 1, v4
v_cvt_pk_bf16_f32 v60, v60, v61
v_cvt_pk_bf16_f32 v61, v62, v63
v_cvt_pk_bf16_f32 v62, v32, v33
v_cvt_pk_bf16_f32 v63, v34, v35
v_mov_b32_dpp v60, v7 quad_perm:[0,1,2,3] row_mask:0xc bank_mask:0xf
v_mov_b32_dpp v61, v24 quad_perm:[0,1,2,3] row_mask:0xc bank_mask:0xf
v_bfi_b32 v60, 1, v4, v60
s_cbranch_scc1 L_np11_g
buffer_store_dwordx4 v[60:63], v6, s[16:19], s30 offen
s_nop 1
L_np11:
s_waitcnt vmcnt(8)
s_cmpk_gt_i32 s45, 1151
s_cbranch_scc1 L_pk_85
s_waitcnt vmcnt(6)
L_pk_85:
s_add_u32 m0, s33, 32512
s_nop 0
buffer_load_dwordx4 v0, s[8:11], s24 offen offset:256 sc1 nt lds
s_waitcnt vmcnt(8)
ds_read_b128 v[52:55], v2 offset:30720
s_cmpk_gt_i32 s45, 1101
s_cbranch_scc1 L_pk_86
s_waitcnt vmcnt(5)
L_pk_86:
buffer_load_dwordx4 a[60:63], v0, s[8:11], s24 offen offset:2048 sc1 nt
s_waitcnt vmcnt(8)
s_cmpk_gt_i32 s45, 1151
s_cbranch_scc1 L_pk_87
s_waitcnt vmcnt(6)
L_pk_87:
buffer_load_dwordx4 a[64:67], v0, s[8:11], s24 offen offset:2304 sc1 nt
s_waitcnt vmcnt(8)
s_cmpk_gt_i32 s45, 1101
s_cbranch_scc1 L_pk_88
s_waitcnt vmcnt(5)
L_pk_88:
s_add_u32 s24, s24, 4096
buffer_load_dwordx4 a[68:71], v0, s[8:11], s24 offen offset:0 sc1 nt
s_waitcnt vmcnt(8)
s_cmpk_gt_i32 s45, 1151
s_cbranch_scc1 L_pk_89
s_waitcnt vmcnt(6)
L_pk_89:
s_add_u32 m0, s33, 33536
s_nop 0
buffer_load_dwordx4 v0, s[8:11], s24 offen offset:256 sc1 nt lds
s_waitcnt vmcnt(8)
ds_read_b128 v[56:59], v2 offset:31744
s_cmpk_gt_i32 s45, 1101
s_cbranch_scc1 L_pk_90
s_waitcnt vmcnt(5)
L_pk_90:
buffer_load_dwordx4 a[72:75], v0, s[8:11], s24 offen offset:2048 sc1 nt
s_waitcnt vmcnt(8)
s_cmpk_gt_i32 s45, 1151
s_cbranch_scc1 L_pk_91
s_waitcnt vmcnt(6)
L_pk_91:
buffer_load_dwordx4 a[76:79], v0, s[8:11], s24 offen offset:2304 sc1 nt
s_memrealtime s[42:43]
s_waitcnt vmcnt(8)
s_waitcnt lgkmcnt(0)
s_sub_u32 s45, s42, s94
s_cmpk_gt_i32 s45, 1315
s_cbranch_scc1 L_pk_92
s_waitcnt vmcnt(5)
L_pk_92:
s_add_u32 s24, s24, 4096
buffer_load_dwordx4 a[80:83], v0, s[8:11], s24 offen offset:0 sc1 nt
s_waitcnt vmcnt(8)
s_cmpk_gt_i32 s45, 1365
s_cbranch_scc1 L_pk_93
s_waitcnt vmcnt(6)
L_pk_93:
s_add_u32 m0, s33, 34560
s_nop 0
buffer_load_dwordx4 v0, s[8:11], s24 offen offset:256 sc1 nt lds
s_memrealtime s[42:43]
s_waitcnt vmcnt(8)
s_waitcnt lgkmcnt(0)
s_sub_u32 s45, s42, s94
s_cmpk_gt_i32 s45, 1339
s_cbranch_scc1 L_pk_94
s_waitcnt vmcnt(5)
L_pk_94:
buffer_load_dwordx4 a[84:87], v0, s[8:11], s24 offen offset:2048 sc1 nt
s_waitcnt vmcnt(8)
s_cmpk_gt_i32 s45, 1389
s_cbranch_scc1 L_pk_95
s_waitcnt vmcnt(6)
L_pk_95:
buffer_load_dwordx4 a[88:91], v0, s[8:11], s24 offen offset:2304 sc1 nt
s_memrealtime s[42:43]
s_waitcnt vmcnt(8)
s_waitcnt lgkmcnt(0)
s_sub_u32 s45, s42, s94
s_cmpk_gt_i32 s45, 1363
s_cbranch_scc1 L_pk_96
s_waitcnt vmcnt(5)
L_pk_96:
s_add_u32 s24, s24, 4096
buffer_load_dwordx4 a[92:95], v0, s[8:11], s24 offen offset:0 sc1 nt
s_waitcnt vmcnt(8)
s_cmpk_gt_i32 s45, 1413
s_cbranch_scc1 L_pk_97
s_waitcnt vmcnt(6)
L_pk_97:
s_add_u32 m0, s33, 35584
s_nop 0
buffer_load_dwordx4 v0, s[8:11], s24 offen offset:256 sc1 nt lds
s_memrealtime s[42:43]
s_waitcnt vmcnt(8)
s_waitcnt lgkmcnt(0)
s_sub_u32 s45, s42, s94
s_cmpk_gt_i32 s45, 1386
s_cbranch_scc1 L_pk_98
s_waitcnt vmcnt(5)
L_pk_98:
buffer_load_dwordx4 a[96:99], v0, s[8:11], s24 offen offset:2048 sc1 nt
s_waitcnt vmcnt(8)
s_cmpk_gt_i32 s45, 1436
s_cbranch_scc1 L_pk_99
s_waitcnt vmcnt(6)
L_pk_99:
buffer_load_dwordx4 a[100:103], v0, s[8:11], s24 offen offset:2304 sc1 nt
s_memrealtime s[42:43]
s_waitcnt vmcnt(8)
s_waitcnt lgkmcnt(0)
s_sub_u32 s45, s42, s94
s_cmpk_gt_i32 s45, 1410
s_cbranch_scc1 L_pk_100
s_waitcnt vmcnt(5)
L_pk_100:
s_add_u32 s24, s24, 4096
buffer_load_dwordx4 a[104:107], v0, s[8:11], s24 offen offset:0 sc1 nt
s_barrier
s_waitcnt vmcnt(8)
s_cmpk_gt_i32 s45, 1460
s_cbranch_scc1 L_pk_101
s_waitcnt vmcnt(6)
L_pk_101:
s_add_u32 m0, s33, 36608
s_nop 0
buffer_load_dwordx4 v0, s[8:11], s24 offen offset:256 sc1 nt lds
s_memrealtime s[42:43]
s_waitcnt vmcnt(8)
s_waitcnt lgkmcnt(0)
s_sub_u32 s45, s42, s94
s_cmpk_gt_i32 s45, 1434
s_cbranch_scc1 L_pk_102
s_waitcnt vmcnt(5)
L_pk_102:
buffer_load_dwordx4 a[108:111], v0, s[8:11], s24 offen offset:2048 sc1 nt
s_waitcnt vmcnt(8)
s_cmpk_gt_i32 s45, 1484
s_cbranch_scc1 L_pk_103
s_waitcnt vmcnt(6)
L_pk_103:
buffer_load_dwordx4 a[112:115], v0, s[8:11], s24 offen offset:2304 sc1 nt
s_memrealtime s[42:43]
s_waitcnt vmcnt(8)
s_waitcnt lgkmcnt(0)
s_sub_u32 s45, s42, s94
s_cmpk_gt_i32 s45, 1458
s_cbranch_scc1 L_pk_104
s_waitcnt vmcnt(5)
L_pk_104:
s_add_u32 s24, s24, 4096
buffer_load_dwordx4 a[116:119], v0, s[8:11], s24 offen offset:0 sc1 nt
s_waitcnt vmcnt(8)
s_cmpk_gt_i32 s45, 1508
s_cbranch_scc1 L_pk_105
s_waitcnt vmcnt(6)
L_pk_105:
s_add_u32 m0, s33, 37632
s_nop 0
buffer_load_dwordx4 v0, s[8:11], s24 offen offset:256 sc1 nt lds
s_memrealtime s[42:43]
s_waitcnt vmcnt(8)
s_waitcnt lgkmcnt(0)
s_sub_u32 s45, s42, s94
s_cmpk_gt_i32 s45, 1481
s_cbranch_scc1 L_pk_106
s_waitcnt vmcnt(5)
L_pk_106:
buffer_load_dwordx4 a[120:123], v0, s[8:11], s24 offen offset:2048 sc1 nt
s_waitcnt vmcnt(8)
s_cmpk_gt_i32 s45, 1531
s_cbranch_scc1 L_pk_107
s_waitcnt vmcnt(6)
L_pk_107:
buffer_load_dwordx4 a[124:127], v0, s[8:11], s24 offen offset:2304 sc1 nt
s_memrealtime s[42:43]
s_waitcnt vmcnt(8)
s_waitcnt lgkmcnt(0)
s_sub_u32 s45, s42, s94
s_cmpk_gt_i32 s45, 1505
s_cbranch_scc1 L_pk_108
s_waitcnt vmcnt(5)
L_pk_108:
s_add_u32 s24, s24, 4096
buffer_load_dwordx4 a[128:131], v0, s[8:11], s24 offen offset:0 sc1 nt
s_waitcnt vmcnt(8)
s_cmpk_gt_i32 s45, 1555
s_cbranch_scc1 L_pk_109
s_waitcnt vmcnt(6)
L_pk_109:
s_add_u32 m0, s33, 38656
s_nop 0
buffer_load_dwordx4 v0, s[8:11], s24 offen offset:256 sc1 nt lds
s_memrealtime s[42:43]
s_waitcnt vmcnt(8)
s_waitcnt lgkmcnt(0)
s_sub_u32 s45, s42, s94
s_cmpk_gt_i32 s45, 1529
s_cbranch_scc1 L_pk_110
s_waitcnt vmcnt(5)
L_pk_110:
buffer_load_dwordx4 a[132:135], v0, s[8:11], s24 offen offset:2048 sc1 nt
s_waitcnt vmcnt(8)
s_cmpk_gt_i32 s45, 1579
s_cbranch_scc1 L_pk_111
s_waitcnt vmcnt(6)
L_pk_111:
buffer_load_dwordx4 a[136:139], v0, s[8:11], s24 offen offset:2304 sc1 nt
s_memrealtime s[42:43]
s_waitcnt vmcnt(8)
s_waitcnt lgkmcnt(0)
s_sub_u32 s45, s42, s94
s_cmpk_gt_i32 s45, 1553
s_cbranch_scc1 L_pk_112
s_waitcnt vmcnt(5)
L_pk_112:
s_add_u32 s24, s24, s26
buffer_load_dwordx4 a[140:143], v0, s[8:11], s24 offen offset:0 sc1 nt
s_waitcnt vmcnt(8)
s_cmpk_gt_i32 s45, 1603
s_cbranch_scc1 L_pk_113
s_waitcnt vmcnt(6)
L_pk_113:
s_add_u32 m0, s33, 39680
s_nop 0
buffer_load_dwordx4 v0, s[8:11], s24 offen offset:256 sc1 nt lds
s_memrealtime s[42:43]
s_waitcnt vmcnt(8)
s_waitcnt lgkmcnt(0)
s_sub_u32 s45, s42, s94
s_cmpk_gt_i32 s45, 1556
s_cbranch_scc1 L_pk_114
s_waitcnt vmcnt(4)
L_pk_114:
s_mov_b32 s24, 33554432
s_add_u32 m0, s33, 20480
s_nop 0
buffer_load_dwordx4 v1, s[12:15], s24 offen offset:0 sc1 nt lds
s_waitcnt vmcnt(8)
s_cmpk_gt_i32 s45, 1616
s_cbranch_scc1 L_pk_115
s_waitcnt vmcnt(5)
L_pk_115:
buffer_load_dwordx4 a[152:155], v1, s[12:15], s24 offen offset:256 sc1 nt
s_memrealtime s[42:43]
s_waitcnt vmcnt(8)
s_waitcnt lgkmcnt(0)
s_sub_u32 s45, s42, s94
s_cmpk_gt_i32 s45, 1580
s_cbranch_scc1 L_pk_116
s_waitcnt vmcnt(4)
L_pk_116:
s_add_u32 m0, s33, 23552
s_nop 0
buffer_load_dwordx4 v1, s[12:15], s24 offen offset:2048 sc1 nt lds
buffer_load_dwordx4 v[12:15], v3, s[16:19], s28 offen sc1
buffer_load_dwordx4 v[16:19], v3, s[16:19], s28 offen offset:256 sc1
s_waitcnt vmcnt(10)
s_cmpk_gt_i32 s45, 1640
s_cbranch_scc1 L_pk_117
s_waitcnt vmcnt(7)
L_pk_117:
buffer_load_dwordx4 a[156:159], v1, s[12:15], s24 offen offset:2304 sc1 nt
s_memrealtime s[42:43]
s_waitcnt vmcnt(10)
s_waitcnt lgkmcnt(0)
s_sub_u32 s45, s42, s94
s_cmpk_gt_i32 s45, 1604
s_cbranch_scc1 L_pk_118
s_waitcnt vmcnt(6)
L_pk_118:
s_add_u32 s24, s24, 4096
buffer_load_dwordx4 a[160:163], v1, s[12:15], s24 offen offset:0 sc1 nt
s_waitcnt vmcnt(10)
s_cmpk_gt_i32 s45, 1664
s_cbranch_scc1 L_pk_119
s_waitcnt vmcnt(7)
L_pk_119:
buffer_load_dwordx4 a[168:171], v1, s[12:15], s24 offen offset:256 sc1 nt
s_memrealtime s[42:43]
s_waitcnt vmcnt(10)
s_waitcnt lgkmcnt(0)
s_sub_u32 s45, s42, s94
s_cmpk_gt_i32 s45, 1628
s_cbranch_scc1 L_pk_120
s_waitcnt vmcnt(6)
L_pk_120:
buffer_load_dwordx4 a[164:167], v1, s[12:15], s24 offen offset:2048 sc1 nt
s_waitcnt vmcnt(10)
s_cmpk_gt_i32 s45, 1688
s_cbranch_scc1 L_pk_121
s_waitcnt vmcnt(7)
L_pk_121:
buffer_load_dwordx4 a[172:175], v1, s[12:15], s24 offen offset:2304 sc1 nt
s_memrealtime s[42:43]
s_waitcnt vmcnt(10)
s_waitcnt lgkmcnt(0)
s_sub_u32 s45, s42, s94
s_cmpk_gt_i32 s45, 1651
s_cbranch_scc1 L_pk_122
s_waitcnt vmcnt(4)
L_pk_122:
s_add_u32 s24, s24, 4096
s_add_u32 m0, s33, 21504
s_nop 0
buffer_load_dwordx4 v1, s[12:15], s24 offen offset:0 sc1 nt lds
s_waitcnt vmcnt(10)
s_cmpk_gt_i32 s45, 1711
s_cbranch_scc1 L_pk_123
s_waitcnt vmcnt(5)
L_pk_123:
buffer_load_dwordx4 a[176:179], v1, s[12:15], s24 offen offset:256 sc1 nt
s_memrealtime s[42:43]
s_waitcnt vmcnt(10)
s_waitcnt lgkmcnt(0)
s_sub_u32 s45, s42, s94
s_cmpk_gt_i32 s45, 1675
s_cbranch_scc1 L_pk_124
s_waitcnt vmcnt(4)
L_pk_124:
s_add_u32 m0, s33, 24576
s_nop 0
buffer_load_dwordx4 v1, s[12:15], s24 offen offset:2048 sc1 nt lds
s_waitcnt vmcnt(10)
s_cmpk_gt_i32 s45, 1735
s_cbranch_scc1 L_pk_125
s_waitcnt vmcnt(5)
L_pk_125:
buffer_load_dwordx4 a[180:183], v1, s[12:15], s24 offen offset:2304 sc1 nt
s_waitcnt vmcnt(9)
v_max_u32 v30, v12, v16
v_cmp_eq_u32 vcc, -1, v30
s_cbranch_vccnz L_q11_s
L_q11_r:
v_mfma_f32_16x16x32_bf16 v[40:43], a[32:35], v[12:15], 0
v_mfma_f32_16x16x32_bf16 v[40:43], v[52:55], v[16:19], v[40:43]
ds_read_b128 v[52:55], v2 offset:32768
v_mfma_f32_16x16x32_bf16 v[44:47], a[36:39], v[12:15], 0
v_mfma_f32_16x16x32_bf16 v[44:47], a[40:43], v[16:19], v[44:47]
v_mfma_f32_16x16x32_bf16 v[48:51], a[44:47], v[12:15], 0
v_mfma_f32_16x16x32_bf16 v[48:51], v[56:59], v[16:19], v[48:51]
ds_read_b128 v[56:59], v2 offset:33792
v_mov_b32 v24, 0xff800000
s_nop 0
v_add_f32_dpp v30, v41, v40 quad_perm:[1,1,1,1] row_mask:0xf bank_mask:0xf
v_add_f32_dpp v31, v43, v42 quad_perm:[3,3,3,3] row_mask:0xf bank_mask:0xf
v_mfma_f32_16x16x32_bf16 v[40:43], a[48:51], v[12:15], 0
v_mfma_f32_16x16x32_bf16 v[40:43], a[52:55], v[16:19], v[40:43]
v_add_f32_dpp v20, v31, v30 quad_perm:[2,2,2,2] row_mask:0xf bank_mask:0x1
v_add_f32_dpp v30, v45, v44 quad_perm:[1,1,1,1] row_mask:0xf bank_mask:0xf
v_add_f32_dpp v31, v47, v46 quad_perm:[3,3,3,3] row_mask:0xf bank_mask:0xf
s_memrealtime s[42:43]
s_waitcnt vmcnt(8)
s_waitcnt lgkmcnt(0)
s_sub_u32 s45, s42, s94
s_cmpk_gt_i32 s45, 1719
s_cbranch_scc1 L_pk_126
s_waitcnt vmcnt(5)
L_pk_126:
s_add_u32 s24, s24, 4096
buffer_load_dwordx4 a[184:187], v1, s[12:15], s24 offen offset:0 sc1 nt
v_mfma_f32_16x16x32_bf16 v[44:47], a[56:59], v[12:15], 0
v_mfma_f32_16x16x32_bf16 v[44:47], v[52:55], v[16:19], v[44:47]
ds_read_b128 v[52:55], v2 offset:34816
v_add_f32_dpp v20, v31, v30 quad_perm:[2,2,2,2] row_mask:0xf bank_mask:0x2
v_add_f32_dpp v30, v49, v48 quad_perm:[1,1,1,1] row_mask:0xf bank_mask:0xf
v_add_f32_dpp v31, v51, v50 quad_perm:[3,3,3,3] row_mask:0xf bank_mask:0xf
v_mfma_f32_16x16x32_bf16 v[48:51], a[60:63], v[12:15], 0
v_mfma_f32_16x16x32_bf16 v[48:51], a[64:67], v[16:19], v[48:51]
v_add_f32_dpp v20, v31, v30 quad_perm:[2,2,2,2] row_mask:0xf bank_mask:0x4
v_add_f32_dpp v30, v41, v40 quad_perm:[1,1,1,1] row_mask:0xf bank_mask:0xf
v_add_f32_dpp v31, v43, v42 quad_perm:[3,3,3,3] row_mask:0xf bank_mask:0xf
v_mfma_f32_16x16x32_bf16 v[40:43], a[68:71], v[12:15], 0
v_mfma_f32_16x16x32_bf16 v[40:43], v[56:59], v[16:19], v[40:43]
ds_read_b128 v[56:59], v2 offset:35840
v_add_f32_dpp v20, v31, v30 quad_perm:[2,2,2,2] row_mask:0xf bank_mask:0x8
v_add_f32_dpp v30, v45, v44 quad_perm:[1,1,1,1] row_mask:0xf bank_mask:0xf
v_add_f32_dpp v31, v47, v46 quad_perm:[3,3,3,3] row_mask:0xf bank_mask:0xf
v_mfma_f32_16x16x32_bf16 v[44:47], a[72:75], v[12:15], 0
v_mfma_f32_16x16x32_bf16 v[44:47], a[76:79], v[16:19], v[44:47]
v_add_f32_dpp v21, v31, v30 quad_perm:[2,2,2,2] row_mask:0xf bank_mask:0x1
v_add_f32_dpp v30, v49, v48 quad_perm:[1,1,1,1] row_mask:0xf bank_mask:0xf
v_add_f32_dpp v31, v51, v50 quad_perm:[3,3,3,3] row_mask:0xf bank_mask:0xf
s_waitcnt vmcnt(8)
s_cmpk_gt_i32 s45, 1769
s_cbranch_scc1 L_pk_127
s_waitcnt vmcnt(6)
L_pk_127:
buffer_load_dwordx4 a[192:195], v1, s[12:15], s24 offen offset:256 sc1 nt
v_mfma_f32_16x16x32_bf16 v[48:51], a[80:83], v[12:15], 0
s_waitcnt lgkmcnt(1)
v_mfma_f32_16x16x32_bf16 v[48:51], v[52:55], v[16:19], v[48:51]
ds_read_b128 v[52:55], v2 offset:36864
v_add_f32_dpp v21, v31, v30 quad_perm:[2,2,2,2] row_mask:0xf bank_mask:0x2
v_add_f32_dpp v30, v41, v40 quad_perm:[1,1,1,1] row_mask:0xf bank_mask:0xf
v_add_f32_dpp v31, v43, v42 quad_perm:[3,3,3,3] row_mask:0xf bank_mask:0xf
v_mfma_f32_16x16x32_bf16 v[40:43], a[84:87], v[12:15], 0
v_mfma_f32_16x16x32_bf16 v[40:43], a[88:91], v[16:19], v[40:43]
v_add_f32_dpp v21, v31, v30 quad_perm:[2,2,2,2] row_mask:0xf bank_mask:0x4
v_add_f32_dpp v30, v45, v44 quad_perm:[1,1,1,1] row_mask:0xf bank_mask:0xf
v_add_f32_dpp v31, v47, v46 quad_perm:[3,3,3,3] row_mask:0xf bank_mask:0xf
v_mfma_f32_16x16x32_bf16 v[44:47], a[92:95], v[12:15], 0
s_waitcnt lgkmcnt(1)
v_mfma_f32_16x16x32_bf16 v[44:47], v[56:59], v[16:19], v[44:47]
ds_read_b128 v[56:59], v2 offset:37888
v_add_f32_dpp v21, v31, v30 quad_perm:[2,2,2,2] row_mask:0xf bank_mask:0x8
v_add_f32_dpp v30, v49, v48 quad_perm:[1,1,1,1] row_mask:0xf bank_mask:0xf
v_add_f32_dpp v31, v51, v50 quad_perm:[3,3,3,3] row_mask:0xf bank_mask:0xf
v_mfma_f32_16x16x32_bf16 v[48:51], a[96:99], v[12:15], 0
v_mfma_f32_16x16x32_bf16 v[48:51], a[100:103], v[16:19], v[48:51]
v_add_f32_dpp v22, v31, v30 quad_perm:[2,2,2,2] row_mask:0xf bank_mask:0x1
v_add_f32_dpp v30, v41, v40 quad_perm:[1,1,1,1] row_mask:0xf bank_mask:0xf
v_add_f32_dpp v31, v43, v42 quad_perm:[3,3,3,3] row_mask:0xf bank_mask:0xf
s_memrealtime s[42:43]
s_waitcnt vmcnt(8)
s_waitcnt lgkmcnt(0)
s_sub_u32 s45, s42, s94
s_cmpk_gt_i32 s45, 1743
s_cbranch_scc1 L_pk_128
s_waitcnt vmcnt(5)
L_pk_128:
buffer_load_dwordx4 a[188:191], v1, s[12:15], s24 offen offset:2048 sc1 nt
v_mfma_f32_16x16x32_bf16 v[40:43], a[104:107], v[12:15], 0
v_mfma_f32_16x16x32_bf16 v[40:43], v[52:55], v[16:19], v[40:43]
ds_read_b128 v[52:55], v2 offset:38912
v_add_f32_dpp v22, v31, v30 quad_perm:[2,2,2,2] row_mask:0xf bank_mask:0x2
v_add_f32_dpp v30, v45, v44 quad_perm:[1,1,1,1] row_mask:0xf bank_mask:0xf
v_add_f32_dpp v31, v47, v46 quad_perm:[3,3,3,3] row_mask:0xf bank_mask:0xf
v_mfma_f32_16x16x32_bf16 v[44:47], a[108:111], v[12:15], 0
v_mfma_f32_16x16x32_bf16 v[44:47], a[112:115], v[16:19], v[44:47]
v_add_f32_dpp v22, v31, v30 quad_perm:[2,2,2,2] row_mask:0xf bank_mask:0x4
v_add_f32_dpp v30, v49, v48 quad_perm:[1,1,1,1] row_mask:0xf bank_mask:0xf
v_add_f32_dpp v31, v51, v50 quad_perm:[3,3,3,3] row_mask:0xf bank_mask:0xf
v_mfma_f32_16x16x32_bf16 v[48:51], a[116:119], v[12:15], 0
v_mfma_f32_16x16x32_bf16 v[48:51], v[56:59], v[16:19], v[48:51]
ds_read_b128 v[56:59], v2 offset:39936
v_add_f32_dpp v22, v31, v30 quad_perm:[2,2,2,2] row_mask:0xf bank_mask:0x8
v_add_f32_dpp v30, v41, v40 quad_perm:[1,1,1,1] row_mask:0xf bank_mask:0xf
v_add_f32_dpp v31, v43, v42 quad_perm:[3,3,3,3] row_mask:0xf bank_mask:0xf
v_mfma_f32_16x16x32_bf16 v[40:43], a[120:123], v[12:15], 0
v_mfma_f32_16x16x32_bf16 v[40:43], a[124:127], v[16:19], v[40:43]
v_add_f32_dpp v23, v31, v30 quad_perm:[2,2,2,2] row_mask:0xf bank_mask:0x1
v_add_f32_dpp v30, v45, v44 quad_perm:[1,1,1,1] row_mask:0xf bank_mask:0xf
v_add_f32_dpp v31, v47, v46 quad_perm:[3,3,3,3] row_mask:0xf bank_mask:0xf
s_waitcnt vmcnt(8)
s_cmpk_gt_i32 s45, 1793
s_cbranch_scc1 L_pk_129
s_waitcnt vmcnt(6)
L_pk_129:
buffer_load_dwordx4 a[196:199], v1, s[12:15], s24 offen offset:2304 sc1 nt
v_mfma_f32_16x16x32_bf16 v[44:47], a[128:131], v[12:15], 0
s_waitcnt lgkmcnt(1)
v_mfma_f32_16x16x32_bf16 v[44:47], v[52:55], v[16:19], v[44:47]
ds_read_b128 v[52:55], v2 offset:20480
v_add_f32_dpp v23, v31, v30 quad_perm:[2,2,2,2] row_mask:0xf bank_mask:0x2
v_add_f32_dpp v30, v49, v48 quad_perm:[1,1,1,1] row_mask:0xf bank_mask:0xf
v_add_f32_dpp v31, v51, v50 quad_perm:[3,3,3,3] row_mask:0xf bank_mask:0xf
v_mfma_f32_16x16x32_bf16 v[48:51], a[132:135], v[12:15], 0
v_mfma_f32_16x16x32_bf16 v[48:51], a[136:139], v[16:19], v[48:51]
v_add_f32_dpp v23, v31, v30 quad_perm:[2,2,2,2] row_mask:0xf bank_mask:0x4
v_add_f32_dpp v30, v41, v40 quad_perm:[1,1,1,1] row_mask:0xf bank_mask:0xf
v_add_f32_dpp v31, v43, v42 quad_perm:[3,3,3,3] row_mask:0xf bank_mask:0xf
v_mfma_f32_16x16x32_bf16 v[40:43], a[140:143], v[12:15], 0
s_waitcnt lgkmcnt(1)
v_mfma_f32_16x16x32_bf16 v[40:43], v[56:59], v[16:19], v[40:43]
ds_read_b128 v[56:59], v2 offset:25600
v_add_f32_dpp v23, v31, v30 quad_perm:[2,2,2,2] row_mask:0xf bank_mask:0x8
v_add_f32_dpp v30, v45, v44 quad_perm:[1,1,1,1] row_mask:0xf bank_mask:0xf
v_add_f32_dpp v31, v47, v46 quad_perm:[3,3,3,3] row_mask:0xf bank_mask:0xf
s_nop 1
v_add_f32_dpp v24, v31, v30 quad_perm:[2,2,2,2] row_mask:0xf bank_mask:0x1
v_add_f32_dpp v30, v49, v48 quad_perm:[1,1,1,1] row_mask:0xf bank_mask:0xf
v_add_f32_dpp v31, v51, v50 quad_perm:[3,3,3,3] row_mask:0xf bank_mask:0xf
s_memrealtime s[42:43]
s_waitcnt vmcnt(8)
s_waitcnt lgkmcnt(0)
s_sub_u32 s45, s42, s94
s_cmpk_gt_i32 s45, 1766
s_cbranch_scc1 L_pk_130
s_waitcnt vmcnt(5)
L_pk_130:
s_add_u32 s24, s24, 4096
s_add_u32 m0, s33, 22528
s_nop 0
buffer_load_dwordx4 v1, s[12:15], s24 offen offset:0 sc1 nt lds
v_add_f32_dpp v24, v31, v30 quad_perm:[2,2,2,2] row_mask:0xf bank_mask:0x2
v_add_f32_dpp v30, v41, v40 quad_perm:[1,1,1,1] row_mask:0xf bank_mask:0xf
v_add_f32_dpp v31, v43, v42 quad_perm:[3,3,3,3] row_mask:0xf bank_mask:0xf
v_add_f32 v30, s27, v30
s_nop 1
v_add_f32_dpp v24, v31, v30 quad_perm:[2,2,2,2] row_mask:0xf bank_mask:0x4
s_waitcnt vmcnt(8)
s_cmpk_gt_i32 s45, 1816
s_cbranch_scc1 L_pk_131
s_waitcnt vmcnt(6)
L_pk_131:
buffer_load_dwordx4 a[200:203], v1, s[12:15], s24 offen offset:256 sc1 nt
v_max3_f32 v6, v20, v21, v22
v_max3_f32 v6, v6, v23, v24
s_nop 1
v_max_f32_dpp v6, v6, v6 row_ror:4 row_mask:0xf bank_mask:0xf
s_nop 1
v_max_f32_dpp v6, v6, v6 row_ror:8 row_mask:0xf bank_mask:0xf
v_mov_b32 v30, v6
s_nop 1
v_permlane16_swap_b32 v6, v30
v_max_f32 v6, v6, v30
v_mov_b32 v30, v6
s_nop 1
v_permlane32_swap_b32 v6, v30
v_max_f32 v6, v6, v30
v_mul_f32 v6, s35, v6
v_fma_f32 v20, v20, s35, -v6
v_fma_f32 v21, v21, s35, -v6
v_fma_f32 v22, v22, s35, -v6
v_fma_f32 v23, v23, s35, -v6
v_fma_f32 v24, v24, s35, -v6
v_exp_f32 v20, v20
v_exp_f32 v21, v21
v_exp_f32 v22, v22
v_exp_f32 v23, v23
v_exp_f32 v24, v24
v_add_f32 v7, v20, v21
v_cvt_pk_bf16_f32 v20, v20, v20
v_add_f32 v31, v22, v23
v_cvt_pk_bf16_f32 v21, v21, v21
v_add_f32 v7, v7, v24
v_cvt_pk_bf16_f32 v22, v22, v22
v_add_f32 v7, v7, v31
v_cvt_pk_bf16_f32 v23, v23, v23
v_cvt_pk_bf16_f32 v24, v24, v24
v_add_f32_dpp v7, v7, v7 row_ror:4 row_mask:0xf bank_mask:0xf
s_nop 1
v_add_f32_dpp v7, v7, v7 row_ror:8 row_mask:0xf bank_mask:0xf
v_mov_b32 v30, v7
s_nop 1
v_permlane16_swap_b32 v7, v30
v_add_f32 v7, v7, v30
v_mov_b32 v30, v7
s_nop 1
v_permlane32_swap_b32 v7, v30
v_add_f32 v7, v7, v30
v_and_b32_dpp v40, v20, v8 row_newbcast:0 row_mask:0xf bank_mask:0xf
v_and_b32_dpp v41, v20, v9 row_newbcast:0 row_mask:0xf bank_mask:0xf
v_and_b32_dpp v42, v20, v10 row_newbcast:0 row_mask:0xf bank_mask:0xf
v_and_b32_dpp v43, v20, v11 row_newbcast:0 row_mask:0xf bank_mask:0xf
s_memrealtime s[42:43]
s_waitcnt vmcnt(8)
s_waitcnt lgkmcnt(0)
s_sub_u32 s45, s42, s94
s_cmpk_gt_i32 s45, 1790
s_cbranch_scc1 L_pk_132
s_waitcnt vmcnt(5)
L_pk_132:
s_add_u32 m0, s33, 25600
s_nop 0
buffer_load_dwordx4 v1, s[12:15], s24 offen offset:2048 sc1 nt lds
v_and_b32_dpp v44, v20, v8 row_newbcast:4 row_mask:0xf bank_mask:0xf
v_and_b32_dpp v45, v20, v9 row_newbcast:4 row_mask:0xf bank_mask:0xf
v_mfma_f32_16x16x32_bf16 v[32:35], v[40:43], v[52:55], 0
ds_read_b128 v[52:55], v2 offset:21504
v_and_b32_dpp v46, v20, v10 row_newbcast:4 row_mask:0xf bank_mask:0xf
v_and_b32_dpp v47, v20, v11 row_newbcast:4 row_mask:0xf bank_mask:0xf
v_mfma_f32_16x16x32_bf16 v[36:39], v[40:43], a[152:155], 0
v_and_b32_dpp v40, v20, v8 row_newbcast:8 row_mask:0xf bank_mask:0xf
v_and_b32_dpp v41, v20, v9 row_newbcast:8 row_mask:0xf bank_mask:0xf
v_mfma_f32_16x16x32_bf16 v[32:35], v[44:47], v[56:59], v[32:35]
v_and_b32_dpp v42, v20, v10 row_newbcast:8 row_mask:0xf bank_mask:0xf
v_and_b32_dpp v43, v20, v11 row_newbcast:8 row_mask:0xf bank_mask:0xf
v_mfma_f32_16x16x32_bf16 v[36:39], v[44:47], a[156:159], v[36:39]
v_and_b32_dpp v44, v20, v8 row_newbcast:12 row_mask:0xf bank_mask:0xf
v_and_b32_dpp v45, v20, v9 row_newbcast:12 row_mask:0xf bank_mask:0xf
v_mfma_f32_16x16x32_bf16 v[32:35], v[40:43], a[160:163], v[32:35]
v_and_b32_dpp v46, v20, v10 row_newbcast:12 row_mask:0xf bank_mask:0xf
v_and_b32_dpp v47, v20, v11 row_newbcast:12 row_mask:0xf bank_mask:0xf
v_mfma_f32_16x16x32_bf16 v[36:39], v[40:43], a[168:171], v[36:39]
v_and_b32_dpp v40, v21, v8 row_newbcast:0 row_mask:0xf bank_mask:0xf
v_and_b32_dpp v41, v21, v9 row_newbcast:0 row_mask:0xf bank_mask:0xf
v_mfma_f32_16x16x32_bf16 v[32:35], v[44:47], a[164:167], v[32:35]
v_and_b32_dpp v42, v21, v10 row_newbcast:0 row_mask:0xf bank_mask:0xf
v_and_b32_dpp v43, v21, v11 row_newbcast:0 row_mask:0xf bank_mask:0xf
v_mfma_f32_16x16x32_bf16 v[36:39], v[44:47], a[172:175], v[36:39]
s_waitcnt vmcnt(8)
ds_read_b128 v[56:59], v2 offset:26624
s_cmpk_gt_i32 s45, 1840
s_cbranch_scc1 L_pk_133
s_waitcnt vmcnt(6)
L_pk_133:
buffer_load_dwordx4 a[204:207], v1, s[12:15], s24 offen offset:2304 sc1 nt
v_and_b32_dpp v44, v21, v8 row_newbcast:4 row_mask:0xf bank_mask:0xf
v_and_b32_dpp v45, v21, v9 row_newbcast:4 row_mask:0xf bank_mask:0xf
s_waitcnt lgkmcnt(1)
v_mfma_f32_16x16x32_bf16 v[32:35], v[40:43], v[52:55], v[32:35]
v_and_b32_dpp v46, v21, v10 row_newbcast:4 row_mask:0xf bank_mask:0xf
v_and_b32_dpp v47, v21, v11 row_newbcast:4 row_mask:0xf bank_mask:0xf
v_mfma_f32_16x16x32_bf16 v[36:39], v[40:43], a[176:179], v[36:39]
s_memrealtime s[42:43]
s_waitcnt vmcnt(8)
s_waitcnt lgkmcnt(0)
s_sub_u32 s45, s42, s94
s_cmpk_gt_i32 s45, 1814
s_cbranch_scc1 L_pk_134
s_waitcnt vmcnt(5)
L_pk_134:
s_add_u32 s24, s24, 4096
buffer_load_dwordx4 a[208:211], v1, s[12:15], s24 offen offset:0 sc1 nt
v_and_b32_dpp v40, v21, v8 row_newbcast:8 row_mask:0xf bank_mask:0xf
v_and_b32_dpp v41, v21, v9 row_newbcast:8 row_mask:0xf bank_mask:0xf
v_mfma_f32_16x16x32_bf16 v[32:35], v[44:47], v[56:59], v[32:35]
v_and_b32_dpp v42, v21, v10 row_newbcast:8 row_mask:0xf bank_mask:0xf
v_and_b32_dpp v43, v21, v11 row_newbcast:8 row_mask:0xf bank_mask:0xf
v_mfma_f32_16x16x32_bf16 v[36:39], v[44:47], a[180:183], v[36:39]
s_waitcnt vmcnt(8)
s_cmpk_gt_i32 s45, 1864
s_cbranch_scc1 L_pk_135
s_waitcnt vmcnt(6)
L_pk_135:
buffer_load_dwordx4 a[216:219], v1, s[12:15], s24 offen offset:256 sc1 nt
s_memrealtime s[42:43]
s_waitcnt vmcnt(8)
s_waitcnt lgkmcnt(0)
s_sub_u32 s45, s42, s94
s_cmpk_gt_i32 s45, 1838
s_cbranch_scc1 L_pk_136
s_waitcnt vmcnt(5)
L_pk_136:
buffer_load_dwordx4 a[212:215], v1, s[12:15], s24 offen offset:2048 sc1 nt
v_and_b32_dpp v44, v21, v8 row_newbcast:12 row_mask:0xf bank_mask:0xf
v_and_b32_dpp v45, v21, v9 row_newbcast:12 row_mask:0xf bank_mask:0xf
v_mfma_f32_16x16x32_bf16 v[32:35], v[40:43], a[184:187], v[32:35]
v_and_b32_dpp v46, v21, v10 row_newbcast:12 row_mask:0xf bank_mask:0xf
v_and_b32_dpp v47, v21, v11 row_newbcast:12 row_mask:0xf bank_mask:0xf
v_mfma_f32_16x16x32_bf16 v[36:39], v[40:43], a[192:195], v[36:39]
s_waitcnt vmcnt(8)
s_cmpk_gt_i32 s45, 1888
s_cbranch_scc1 L_pk_137
s_waitcnt vmcnt(6)
L_pk_137:
buffer_load_dwordx4 a[220:223], v1, s[12:15], s24 offen offset:2304 sc1 nt
s_memrealtime s[42:43]
s_waitcnt vmcnt(8)
s_waitcnt lgkmcnt(0)
s_sub_u32 s45, s42, s94
s_cmpk_gt_i32 s45, 1861
s_cbranch_scc1 L_pk_138
s_waitcnt vmcnt(5)
L_pk_138:
s_add_u32 s24, s24, 4096
s_add_u32 m0, s33, 23552
s_nop 0
buffer_load_dwordx4 v1, s[12:15], s24 offen offset:0 sc1 nt lds
v_and_b32_dpp v40, v22, v8 row_newbcast:0 row_mask:0xf bank_mask:0xf
v_and_b32_dpp v41, v22, v9 row_newbcast:0 row_mask:0xf bank_mask:0xf
v_mfma_f32_16x16x32_bf16 v[32:35], v[44:47], a[188:191], v[32:35]
v_and_b32_dpp v42, v22, v10 row_newbcast:0 row_mask:0xf bank_mask:0xf
v_and_b32_dpp v43, v22, v11 row_newbcast:0 row_mask:0xf bank_mask:0xf
v_mfma_f32_16x16x32_bf16 v[36:39], v[44:47], a[196:199], v[36:39]
s_waitcnt vmcnt(8)
ds_read_b128 v[52:55], v2 offset:22528
s_cmpk_gt_i32 s45, 1911
s_cbranch_scc1 L_pk_139
s_waitcnt vmcnt(6)
L_pk_139:
buffer_load_dwordx4 a[224:227], v1, s[12:15], s24 offen offset:256 sc1 nt
s_memrealtime s[42:43]
s_waitcnt vmcnt(8)
s_waitcnt lgkmcnt(0)
s_sub_u32 s45, s42, s94
s_cmpk_gt_i32 s45, 1885
s_cbranch_scc1 L_pk_140
s_waitcnt vmcnt(5)
L_pk_140:
s_add_u32 m0, s33, 26624
s_nop 0
buffer_load_dwordx4 v1, s[12:15], s24 offen offset:2048 sc1 nt lds
v_and_b32_dpp v44, v22, v8 row_newbcast:4 row_mask:0xf bank_mask:0xf
v_and_b32_dpp v45, v22, v9 row_newbcast:4 row_mask:0xf bank_mask:0xf
v_mfma_f32_16x16x32_bf16 v[32:35], v[40:43], v[52:55], v[32:35]
v_and_b32_dpp v46, v22, v10 row_newbcast:4 row_mask:0xf bank_mask:0xf
v_and_b32_dpp v47, v22, v11 row_newbcast:4 row_mask:0xf bank_mask:0xf
v_mfma_f32_16x16x32_bf16 v[36:39], v[40:43], a[200:203], v[36:39]
s_waitcnt vmcnt(8)
ds_read_b128 v[56:59], v2 offset:27648
s_cmpk_gt_i32 s45, 1935
s_cbranch_scc1 L_pk_141
s_waitcnt vmcnt(6)
L_pk_141:
buffer_load_dwordx4 a[228:231], v1, s[12:15], s24 offen offset:2304 sc1 nt
s_memrealtime s[42:43]
s_waitcnt vmcnt(8)
s_waitcnt lgkmcnt(0)
s_sub_u32 s45, s42, s94
s_cmpk_gt_i32 s45, 1909
s_cbranch_scc1 L_pk_142
s_waitcnt vmcnt(5)
L_pk_142:
s_add_u32 s24, s24, 4096
buffer_load_dwordx4 a[232:235], v1, s[12:15], s24 offen offset:0 sc1 nt
v_and_b32_dpp v40, v22, v8 row_newbcast:8 row_mask:0xf bank_mask:0xf
v_and_b32_dpp v41, v22, v9 row_newbcast:8 row_mask:0xf bank_mask:0xf
v_mfma_f32_16x16x32_bf16 v[32:35], v[44:47], v[56:59], v[32:35]
v_and_b32_dpp v42, v22, v10 row_newbcast:8 row_mask:0xf bank_mask:0xf
v_and_b32_dpp v43, v22, v11 row_newbcast:8 row_mask:0xf bank_mask:0xf
v_mfma_f32_16x16x32_bf16 v[36:39], v[44:47], a[204:207], v[36:39]
s_waitcnt vmcnt(8)
s_cmpk_gt_i32 s45, 1959
s_cbranch_scc1 L_pk_143
s_waitcnt vmcnt(6)
L_pk_143:
buffer_load_dwordx4 a[240:243], v1, s[12:15], s24 offen offset:256 sc1 nt
s_memrealtime s[42:43]
s_waitcnt vmcnt(8)
s_waitcnt lgkmcnt(0)
s_sub_u32 s45, s42, s94
s_cmpk_gt_i32 s45, 1933
s_cbranch_scc1 L_pk_144
s_waitcnt vmcnt(5)
L_pk_144:
buffer_load_dwordx4 a[236:239], v1, s[12:15], s24 offen offset:2048 sc1 nt
v_and_b32_dpp v44, v22, v8 row_newbcast:12 row_mask:0xf bank_mask:0xf
v_and_b32_dpp v45, v22, v9 row_newbcast:12 row_mask:0xf bank_mask:0xf
v_mfma_f32_16x16x32_bf16 v[32:35], v[40:43], a[208:211], v[32:35]
v_and_b32_dpp v46, v22, v10 row_newbcast:12 row_mask:0xf bank_mask:0xf
v_and_b32_dpp v47, v22, v11 row_newbcast:12 row_mask:0xf bank_mask:0xf
v_mfma_f32_16x16x32_bf16 v[36:39], v[40:43], a[216:219], v[36:39]
s_waitcnt vmcnt(8)
s_cmpk_gt_i32 s45, 1983
s_cbranch_scc1 L_pk_145
s_waitcnt vmcnt(6)
L_pk_145:
buffer_load_dwordx4 a[244:247], v1, s[12:15], s24 offen offset:2304 sc1 nt
buffer_load_dwordx4 v[12:15], v3, s[16:19], s29 offen sc1
buffer_load_dwordx4 v[16:19], v3, s[16:19], s29 offen offset:256 sc1
s_memrealtime s[42:43]
s_waitcnt vmcnt(10)
s_waitcnt lgkmcnt(0)
s_sub_u32 s45, s42, s94
s_cmpk_gt_i32 s45, 1956
s_cbranch_scc1 L_pk_146
s_waitcnt vmcnt(7)
L_pk_146:
s_add_u32 s24, s24, 4096
s_add_u32 m0, s33, 24576
s_nop 0
buffer_load_dwordx4 v1, s[12:15], s24 offen offset:0 sc1 nt lds
v_and_b32_dpp v40, v23, v8 row_newbcast:0 row_mask:0xf bank_mask:0xf
v_and_b32_dpp v41, v23, v9 row_newbcast:0 row_mask:0xf bank_mask:0xf
v_mfma_f32_16x16x32_bf16 v[32:35], v[44:47], a[212:215], v[32:35]
v_and_b32_dpp v42, v23, v10 row_newbcast:0 row_mask:0xf bank_mask:0xf
v_and_b32_dpp v43, v23, v11 row_newbcast:0 row_mask:0xf bank_mask:0xf
v_mfma_f32_16x16x32_bf16 v[36:39], v[44:47], a[220:223], v[36:39]
s_waitcnt vmcnt(10)
ds_read_b128 v[52:55], v2 offset:23552
s_cmpk_gt_i32 s45, 2006
s_cbranch_scc1 L_pk_147
s_waitcnt vmcnt(8)
L_pk_147:
buffer_load_dwordx4 a[248:251], v1, s[12:15], s24 offen offset:256 sc1 nt
s_memrealtime s[42:43]
s_waitcnt vmcnt(10)
s_waitcnt lgkmcnt(0)
s_sub_u32 s45, s42, s94
s_cmpk_gt_i32 s45, 1980
s_cbranch_scc1 L_pk_148
s_waitcnt vmcnt(7)
L_pk_148:
s_add_u32 m0, s33, 27648
s_nop 0
buffer_load_dwordx4 v1, s[12:15], s24 offen offset:2048 sc1 nt lds
v_and_b32_dpp v44, v23, v8 row_newbcast:4 row_mask:0xf bank_mask:0xf
v_and_b32_dpp v45, v23, v9 row_newbcast:4 row_mask:0xf bank_mask:0xf
v_mfma_f32_16x16x32_bf16 v[32:35], v[40:43], v[52:55], v[32:35]
ds_read_b128 v[52:55], v2 offset:10240
v_and_b32_dpp v46, v23, v10 row_newbcast:4 row_mask:0xf bank_mask:0xf
v_and_b32_dpp v47, v23, v11 row_newbcast:4 row_mask:0xf bank_mask:0xf
v_mfma_f32_16x16x32_bf16 v[36:39], v[40:43], a[224:227], v[36:39]
s_waitcnt vmcnt(10)
ds_read_b128 v[56:59], v2 offset:28672
s_cmpk_gt_i32 s45, 2030
s_cbranch_scc1 L_pk_149
s_waitcnt vmcnt(8)
L_pk_149:
buffer_load_dwordx4 a[252:255], v1, s[12:15], s24 offen offset:2304 sc1 nt
s_memrealtime s[42:43]
s_waitcnt vmcnt(10)
s_waitcnt lgkmcnt(0)
s_sub_u32 s45, s42, s94
s_cmpk_gt_i32 s45, 2004
s_cbranch_scc1 L_pk_150
s_waitcnt vmcnt(7)
L_pk_150:
s_add_u32 s24, s24, s26
buffer_load_dwordx4 a[144:147], v1, s[12:15], s24 offen offset:0 sc1 nt
v_mfma_f32_16x16x32_bf16 v[32:35], v[44:47], v[56:59], v[32:35]
ds_read_b128 v[56:59], v2 offset:11264
v_mfma_f32_16x16x32_bf16 v[36:39], v[44:47], a[228:231], v[36:39]
s_waitcnt vmcnt(10)
s_cmpk_gt_i32 s45, 2054
s_cbranch_scc1 L_pk_151
s_waitcnt vmcnt(8)
L_pk_151:
buffer_load_dwordx4 a[148:151], v1, s[12:15], s24 offen offset:256 sc1 nt
s_waitcnt vmcnt(6)
v_max_u32 v30, v12, v16
v_cmp_eq_u32 vcc, -1, v30
s_cbranch_vccnz L_q21_s
L_q21_r:
s_add_u32 s28, s28, 8192
s_add_u32 s29, s28, 24576
s_mov_b32 s31, 1196032
v_mfma_f32_16x16x32_bf16 v[40:43], v[64:67], v[12:15], 0
v_mfma_f32_16x16x32_bf16 v[40:43], v[52:55], v[16:19], v[40:43]
ds_read_b128 v[52:55], v2 offset:12288
v_mfma_f32_16x16x32_bf16 v[44:47], v[68:71], v[12:15], 0
v_mfma_f32_16x16x32_bf16 v[44:47], v[72:75], v[16:19], v[44:47]
v_mfma_f32_16x16x32_bf16 v[48:51], v[76:79], v[12:15], 0
s_waitcnt lgkmcnt(1)
v_mfma_f32_16x16x32_bf16 v[48:51], v[56:59], v[16:19], v[48:51]
ds_read_b128 v[56:59], v2 offset:13312
v_mov_b32 v29, 0xff800000
v_add_f32_dpp v30, v41, v40 quad_perm:[1,1,1,1] row_mask:0xf bank_mask:0xf
v_add_f32_dpp v31, v43, v42 quad_perm:[3,3,3,3] row_mask:0xf bank_mask:0xf
v_mfma_f32_16x16x32_bf16 v[40:43], v[80:83], v[12:15], 0
v_mfma_f32_16x16x32_bf16 v[40:43], v[84:87], v[16:19], v[40:43]
v_add_f32_dpp v25, v31, v30 quad_perm:[2,2,2,2] row_mask:0xf bank_mask:0x1
v_add_f32_dpp v30, v45, v44 quad_perm:[1,1,1,1] row_mask:0xf bank_mask:0xf
v_add_f32_dpp v31, v47, v46 quad_perm:[3,3,3,3] row_mask:0xf bank_mask:0xf
v_and_b32_dpp v60, v23, v8 row_newbcast:8 row_mask:0xf bank_mask:0xf
v_and_b32_dpp v61, v23, v9 row_newbcast:8 row_mask:0xf bank_mask:0xf
v_and_b32_dpp v62, v23, v10 row_newbcast:8 row_mask:0xf bank_mask:0xf
v_and_b32_dpp v63, v23, v11 row_newbcast:8 row_mask:0xf bank_mask:0xf
s_nop 1
v_mfma_f32_16x16x32_bf16 v[32:35], v[60:63], a[232:235], v[32:35]
v_mfma_f32_16x16x32_bf16 v[36:39], v[60:63], a[240:243], v[36:39]
s_cmpk_gt_i32 s45, 2004
s_cbranch_scc1 L_pk_152
s_waitcnt vmcnt(5)
L_pk_152:
s_mov_b32 s24, 67108864
buffer_load_dwordx4 v[64:67], v1, s[12:15], s24 offen offset:0 sc1 nt
v_mfma_f32_16x16x32_bf16 v[44:47], v[88:91], v[12:15], 0
s_waitcnt lgkmcnt(1)
v_mfma_f32_16x16x32_bf16 v[44:47], v[52:55], v[16:19], v[44:47]
ds_read_b128 v[52:55], v2 offset:14336
v_add_f32_dpp v25, v31, v30 quad_perm:[2,2,2,2] row_mask:0xf bank_mask:0x2
v_add_f32_dpp v30, v49, v48 quad_perm:[1,1,1,1] row_mask:0xf bank_mask:0xf
v_add_f32_dpp v31, v51, v50 quad_perm:[3,3,3,3] row_mask:0xf bank_mask:0xf
v_mfma_f32_16x16x32_bf16 v[48:51], v[92:95], v[12:15], 0
v_mfma_f32_16x16x32_bf16 v[48:51], v[96:99], v[16:19], v[48:51]
v_add_f32_dpp v25, v31, v30 quad_perm:[2,2,2,2] row_mask:0xf bank_mask:0x4
v_add_f32_dpp v30, v41, v40 quad_perm:[1,1,1,1] row_mask:0xf bank_mask:0xf
v_add_f32_dpp v31, v43, v42 quad_perm:[3,3,3,3] row_mask:0xf bank_mask:0xf
v_mfma_f32_16x16x32_bf16 v[40:43], v[100:103], v[12:15], 0
s_waitcnt lgkmcnt(1)
v_mfma_f32_16x16x32_bf16 v[40:43], v[56:59], v[16:19], v[40:43]
ds_read_b128 v[56:59], v2 offset:15360
v_add_f32_dpp v25, v31, v30 quad_perm:[2,2,2,2] row_mask:0xf bank_mask:0x8
v_add_f32_dpp v30, v45, v44 quad_perm:[1,1,1,1] row_mask:0xf bank_mask:0xf
v_add_f32_dpp v31, v47, v46 quad_perm:[3,3,3,3] row_mask:0xf bank_mask:0xf
v_mfma_f32_16x16x32_bf16 v[44:47], v[104:107], v[12:15], 0
v_mfma_f32_16x16x32_bf16 v[44:47], v[108:111], v[16:19], v[44:47]
v_add_f32_dpp v26, v31, v30 quad_perm:[2,2,2,2] row_mask:0xf bank_mask:0x1
v_add_f32_dpp v30, v49, v48 quad_perm:[1,1,1,1] row_mask:0xf bank_mask:0xf
v_add_f32_dpp v31, v51, v50 quad_perm:[3,3,3,3] row_mask:0xf bank_mask:0xf
s_cmpk_gt_i32 s45, 2054
s_cbranch_scc1 L_pk_153
s_waitcnt vmcnt(6)
L_pk_153:
s_add_u32 m0, s33, 9984
s_nop 0
buffer_load_dwordx4 v1, s[12:15], s24 offen offset:256 sc1 nt lds
v_mfma_f32_16x16x32_bf16 v[48:51], v[112:115], v[12:15], 0
s_waitcnt lgkmcnt(1)
v_mfma_f32_16x16x32_bf16 v[48:51], v[52:55], v[16:19], v[48:51]
ds_read_b128 v[52:55], v2 offset:16384
v_add_f32_dpp v26, v31, v30 quad_perm:[2,2,2,2] row_mask:0xf bank_mask:0x2
v_add_f32_dpp v30, v41, v40 quad_perm:[1,1,1,1] row_mask:0xf bank_mask:0xf
v_add_f32_dpp v31, v43, v42 quad_perm:[3,3,3,3] row_mask:0xf bank_mask:0xf
v_mfma_f32_16x16x32_bf16 v[40:43], v[116:119], v[12:15], 0
v_mfma_f32_16x16x32_bf16 v[40:43], v[120:123], v[16:19], v[40:43]
v_add_f32_dpp v26, v31, v30 quad_perm:[2,2,2,2] row_mask:0xf bank_mask:0x4
v_add_f32_dpp v30, v45, v44 quad_perm:[1,1,1,1] row_mask:0xf bank_mask:0xf
v_add_f32_dpp v31, v47, v46 quad_perm:[3,3,3,3] row_mask:0xf bank_mask:0xf
v_mfma_f32_16x16x32_bf16 v[44:47], v[124:127], v[12:15], 0
s_waitcnt lgkmcnt(1)
v_mfma_f32_16x16x32_bf16 v[44:47], v[56:59], v[16:19], v[44:47]
ds_read_b128 v[56:59], v2 offset:17408
v_add_f32_dpp v26, v31, v30 quad_perm:[2,2,2,2] row_mask:0xf bank_mask:0x8
v_add_f32_dpp v30, v49, v48 quad_perm:[1,1,1,1] row_mask:0xf bank_mask:0xf
v_add_f32_dpp v31, v51, v50 quad_perm:[3,3,3,3] row_mask:0xf bank_mask:0xf
v_mfma_f32_16x16x32_bf16 v[48:51], v[128:131], v[12:15], 0
v_mfma_f32_16x16x32_bf16 v[48:51], v[132:135], v[16:19], v[48:51]
v_add_f32_dpp v27, v31, v30 quad_perm:[2,2,2,2] row_mask:0xf bank_mask:0x1
v_add_f32_dpp v30, v41, v40 quad_perm:[1,1,1,1] row_mask:0xf bank_mask:0xf
v_add_f32_dpp v31, v43, v42 quad_perm:[3,3,3,3] row_mask:0xf bank_mask:0xf
v_and_b32_dpp v60, v23, v8 row_newbcast:12 row_mask:0xf bank_mask:0xf
v_and_b32_dpp v61, v23, v9 row_newbcast:12 row_mask:0xf bank_mask:0xf
v_and_b32_dpp v62, v23, v10 row_newbcast:12 row_mask:0xf bank_mask:0xf
v_and_b32_dpp v63, v23, v11 row_newbcast:12 row_mask:0xf bank_mask:0xf
s_nop 1
v_mfma_f32_16x16x32_bf16 v[32:35], v[60:63], a[236:239], v[32:35]
v_mfma_f32_16x16x32_bf16 v[36:39], v[60:63], a[244:247], v[36:39]
s_cmpk_gt_i32 s45, 2004
s_cbranch_scc1 L_pk_154
s_waitcnt vmcnt(5)
L_pk_154:
buffer_load_dwordx4 v[68:71], v1, s[12:15], s24 offen offset:2048 sc1 nt
v_mfma_f32_16x16x32_bf16 v[40:43], v[136:139], v[12:15], 0
s_waitcnt lgkmcnt(1)
v_mfma_f32_16x16x32_bf16 v[40:43], v[52:55], v[16:19], v[40:43]
ds_read_b128 v[52:55], v2 offset:18432
v_add_f32_dpp v27, v31, v30 quad_perm:[2,2,2,2] row_mask:0xf bank_mask:0x2
v_add_f32_dpp v30, v45, v44 quad_perm:[1,1,1,1] row_mask:0xf bank_mask:0xf
v_add_f32_dpp v31, v47, v46 quad_perm:[3,3,3,3] row_mask:0xf bank_mask:0xf
v_mfma_f32_16x16x32_bf16 v[44:47], v[140:143], v[12:15], 0
v_mfma_f32_16x16x32_bf16 v[44:47], v[144:147], v[16:19], v[44:47]
v_add_f32_dpp v27, v31, v30 quad_perm:[2,2,2,2] row_mask:0xf bank_mask:0x4
v_add_f32_dpp v30, v49, v48 quad_perm:[1,1,1,1] row_mask:0xf bank_mask:0xf
v_add_f32_dpp v31, v51, v50 quad_perm:[3,3,3,3] row_mask:0xf bank_mask:0xf
v_mfma_f32_16x16x32_bf16 v[48:51], v[148:151], v[12:15], 0
s_waitcnt lgkmcnt(1)
v_mfma_f32_16x16x32_bf16 v[48:51], v[56:59], v[16:19], v[48:51]
ds_read_b128 v[56:59], v2 offset:19456
v_add_f32_dpp v27, v31, v30 quad_perm:[2,2,2,2] row_mask:0xf bank_mask:0x8
v_add_f32_dpp v30, v41, v40 quad_perm:[1,1,1,1] row_mask:0xf bank_mask:0xf
v_add_f32_dpp v31, v43, v42 quad_perm:[3,3,3,3] row_mask:0xf bank_mask:0xf
v_mfma_f32_16x16x32_bf16 v[40:43], v[152:155], v[12:15], 0
v_mfma_f32_16x16x32_bf16 v[40:43], v[156:159], v[16:19], v[40:43]
v_add_f32_dpp v28, v31, v30 quad_perm:[2,2,2,2] row_mask:0xf bank_mask:0x1
v_add_f32_dpp v30, v45, v44 quad_perm:[1,1,1,1] row_mask:0xf bank_mask:0xf
v_add_f32_dpp v31, v47, v46 quad_perm:[3,3,3,3] row_mask:0xf bank_mask:0xf
s_waitcnt vmcnt(8)
s_cmpk_gt_i32 s45, 2054
s_cbranch_scc1 L_pk_155
s_waitcnt vmcnt(6)
L_pk_155:
buffer_load_dwordx4 v[72:75], v1, s[12:15], s24 offen offset:2304 sc1 nt
v_mfma_f32_16x16x32_bf16 v[44:47], v[160:163], v[12:15], 0
s_waitcnt lgkmcnt(1)
v_mfma_f32_16x16x32_bf16 v[44:47], v[52:55], v[16:19], v[44:47]
ds_read_b128 v[52:55], v2 offset:24576
v_add_f32_dpp v28, v31, v30 quad_perm:[2,2,2,2] row_mask:0xf bank_mask:0x2
v_add_f32_dpp v30, v49, v48 quad_perm:[1,1,1,1] row_mask:0xf bank_mask:0xf
v_add_f32_dpp v31, v51, v50 quad_perm:[3,3,3,3] row_mask:0xf bank_mask:0xf
v_mfma_f32_16x16x32_bf16 v[48:51], v[164:167], v[12:15], 0
v_mfma_f32_16x16x32_bf16 v[48:51], v[168:171], v[16:19], v[48:51]
v_add_f32_dpp v28, v31, v30 quad_perm:[2,2,2,2] row_mask:0xf bank_mask:0x4
v_add_f32_dpp v30, v41, v40 quad_perm:[1,1,1,1] row_mask:0xf bank_mask:0xf
v_add_f32_dpp v31, v43, v42 quad_perm:[3,3,3,3] row_mask:0xf bank_mask:0xf
v_mfma_f32_16x16x32_bf16 v[40:43], v[172:175], v[12:15], 0
s_waitcnt lgkmcnt(1)
v_mfma_f32_16x16x32_bf16 v[40:43], v[56:59], v[16:19], v[40:43]
v_add_f32_dpp v28, v31, v30 quad_perm:[2,2,2,2] row_mask:0xf bank_mask:0x8
v_add_f32_dpp v30, v45, v44 quad_perm:[1,1,1,1] row_mask:0xf bank_mask:0xf
v_add_f32_dpp v31, v47, v46 quad_perm:[3,3,3,3] row_mask:0xf bank_mask:0xf
s_nop 1
v_add_f32_dpp v29, v31, v30 quad_perm:[2,2,2,2] row_mask:0xf bank_mask:0x1
v_add_f32_dpp v30, v49, v48 quad_perm:[1,1,1,1] row_mask:0xf bank_mask:0xf
v_add_f32_dpp v31, v51, v50 quad_perm:[3,3,3,3] row_mask:0xf bank_mask:0xf
v_and_b32_dpp v60, v24, v8 row_newbcast:0 row_mask:0xf bank_mask:0xf
v_and_b32_dpp v61, v24, v9 row_newbcast:0 row_mask:0xf bank_mask:0xf
v_and_b32_dpp v62, v24, v10 row_newbcast:0 row_mask:0xf bank_mask:0xf
v_and_b32_dpp v63, v24, v11 row_newbcast:0 row_mask:0xf bank_mask:0xf
s_waitcnt lgkmcnt(0)
s_nop 0
v_mfma_f32_16x16x32_bf16 v[32:35], v[60:63], v[52:55], v[32:35]
ds_read_b128 v[52:55], v2 offset:0
s_waitcnt vmcnt(8)
v_mfma_f32_16x16x32_bf16 v[36:39], v[60:63], a[248:251], v[36:39]
s_cmpk_gt_i32 s45, 2004
s_cbranch_scc1 L_pk_156
s_waitcnt vmcnt(5)
L_pk_156:
s_add_u32 s24, s24, 4096
buffer_load_dwordx4 v[76:79], v1, s[12:15], s24 offen offset:0 sc1 nt
v_add_f32_dpp v29, v31, v30 quad_perm:[2,2,2,2] row_mask:0xf bank_mask:0x2
v_add_f32_dpp v30, v41, v40 quad_perm:[1,1,1,1] row_mask:0xf bank_mask:0xf
v_add_f32_dpp v31, v43, v42 quad_perm:[3,3,3,3] row_mask:0xf bank_mask:0xf
v_add_f32 v30, s27, v30
s_nop 1
v_add_f32_dpp v29, v31, v30 quad_perm:[2,2,2,2] row_mask:0xf bank_mask:0x4
s_waitcnt vmcnt(8)
ds_read_b128 v[56:59], v2 offset:29696
s_cmpk_gt_i32 s45, 2054
s_cbranch_scc1 L_pk_157
s_waitcnt vmcnt(6)
L_pk_157:
s_add_u32 m0, s33, 11008
s_nop 0
buffer_load_dwordx4 v1, s[12:15], s24 offen offset:256 sc1 nt lds
v_and_b32_dpp v60, v24, v8 row_newbcast:4 row_mask:0xf bank_mask:0xf
v_and_b32_dpp v61, v24, v9 row_newbcast:4 row_mask:0xf bank_mask:0xf
v_and_b32_dpp v62, v24, v10 row_newbcast:4 row_mask:0xf bank_mask:0xf
v_and_b32_dpp v63, v24, v11 row_newbcast:4 row_mask:0xf bank_mask:0xf
s_waitcnt lgkmcnt(0)
s_nop 0
v_mfma_f32_16x16x32_bf16 v[32:35], v[60:63], v[56:59], v[32:35]
ds_read_b128 v[56:59], v2 offset:5120
s_waitcnt vmcnt(8)
v_mfma_f32_16x16x32_bf16 v[36:39], v[60:63], a[252:255], v[36:39]
v_max3_f32 v48, v25, v26, v27
v_max3_f32 v48, v48, v28, v29
s_nop 1
v_max_f32_dpp v48, v48, v48 row_ror:4 row_mask:0xf bank_mask:0xf
s_nop 1
v_max_f32_dpp v48, v48, v48 row_ror:8 row_mask:0xf bank_mask:0xf
v_mov_b32 v30, v48
s_nop 1
v_permlane16_swap_b32 v48, v30
v_max_f32 v48, v48, v30
v_mov_b32 v30, v48
s_nop 1
v_permlane32_swap_b32 v48, v30
v_max_f32 v48, v48, v30
v_mul_f32 v48, s35, v48
v_fma_f32 v25, v25, s35, -v48
v_fma_f32 v26, v26, s35, -v48
v_fma_f32 v27, v27, s35, -v48
v_fma_f32 v28, v28, s35, -v48
v_fma_f32 v29, v29, s35, -v48
v_exp_f32 v25, v25
v_exp_f32 v26, v26
v_exp_f32 v27, v27
v_exp_f32 v28, v28
v_exp_f32 v29, v29
v_add_f32 v49, v25, v26
v_cvt_pk_bf16_f32 v25, v25, v25
v_add_f32 v31, v27, v28
v_cvt_pk_bf16_f32 v26, v26, v26
v_add_f32 v49, v49, v29
v_cvt_pk_bf16_f32 v27, v27, v27
v_add_f32 v49, v49, v31
v_cvt_pk_bf16_f32 v28, v28, v28
v_cvt_pk_bf16_f32 v29, v29, v29
s_cmpk_gt_i32 s45, 2004
s_cbranch_scc1 L_pk_158
s_waitcnt vmcnt(5)
L_pk_158:
buffer_load_dwordx4 v[80:83], v1, s[12:15], s24 offen offset:2048 sc1 nt
s_waitcnt vmcnt(8)
s_cmpk_gt_i32 s45, 2054
s_cbranch_scc1 L_pk_159
s_waitcnt vmcnt(6)
L_pk_159:
buffer_load_dwordx4 v[84:87], v1, s[12:15], s24 offen offset:2304 sc1 nt
v_and_b32_dpp v60, v24, v8 row_newbcast:8 row_mask:0xf bank_mask:0xf
v_and_b32_dpp v61, v24, v9 row_newbcast:8 row_mask:0xf bank_mask:0xf
v_and_b32_dpp v62, v24, v10 row_newbcast:8 row_mask:0xf bank_mask:0xf
v_and_b32_dpp v63, v24, v11 row_newbcast:8 row_mask:0xf bank_mask:0xf
s_nop 1
v_mfma_f32_16x16x32_bf16 v[32:35], v[60:63], a[144:147], v[32:35]
s_waitcnt vmcnt(8)
v_mfma_f32_16x16x32_bf16 v[36:39], v[60:63], a[148:151], v[36:39]
s_nop 5
v_cvt_pk_bf16_f32 v32, v32, v33
v_cvt_pk_bf16_f32 v33, v34, v35
v_cvt_pk_bf16_f32 v34, v36, v37
v_cvt_pk_bf16_f32 v35, v38, v39
v_mov_b32_dpp v32, v6 quad_perm:[0,0,0,0] row_mask:0xc bank_mask:0xf
v_mov_b32_dpp v33, v7 quad_perm:[0,0,0,0] row_mask:0xc bank_mask:0xf
ds_write_b128 v2, v[32:35] offset:19456
v_subrev_u32 v24, s33, v2
v_lshrrev_b32 v60, 8, v24
v_mul_u32_u24 v60, 40704, v60
v_add_u32 v24, v24, v60
s_cmp_lg_u32 s3, 0
s_waitcnt lgkmcnt(0)
s_barrier
s_cbranch_scc1 L_np12
L_np12_e:
ds_read_b64 v[6:7], v24 offset:19968
ds_read_b128 v[32:35], v24 offset:19456
ds_read_b128 v[36:39], v24 offset:19712
s_waitcnt lgkmcnt(2)
v_mov_b32 v60, v6
v_mov_b32 v61, v6
s_nop 1
v_permlane16_swap_b32 v60, v61
v_max_f32 v60, v60, v61
v_mov_b32 v61, v60
s_nop 1
v_permlane32_swap_b32 v60, v61
v_max_f32 v24, v60, v61
v_sub_f32 v6, v6, v24
v_exp_f32 v6, v6
s_nop 0
v_cvt_pk_bf16_f32 v60, v6, v6
v_and_b32 v20, v60, v8
v_and_b32 v21, v60, v9
v_and_b32 v22, v60, v10
v_and_b32 v23, v60, v11
s_cmp_lg_u32 s37, 0
v_mul_f32 v7, v7, v6
v_mov_b32 v6, v7
s_waitcnt lgkmcnt(1)
v_mfma_f32_16x16x32_bf16 v[60:63], v[20:23], v[32:35], 0
s_waitcnt lgkmcnt(0)
v_mfma_f32_16x16x32_bf16 v[32:35], v[20:23], v[36:39], 0
v_permlane16_swap_b32 v7, v6
v_add_f32 v7, v7, v6
v_mov_b32 v6, v7
s_nop 1
v_permlane32_swap_b32 v7, v6
v_add_f32 v7, v7, v6
v_and_b32 v6, -2, v4
v_xor_b32 v4, 1, v4
v_cvt_pk_bf16_f32 v60, v60, v61
v_cvt_pk_bf16_f32 v61, v62, v63
v_cvt_pk_bf16_f32 v62, v32, v33
v_cvt_pk_bf16_f32 v63, v34, v35
v_mov_b32_dpp v60, v7 quad_perm:[0,1,2,3] row_mask:0xc bank_mask:0xf
v_mov_b32_dpp v61, v24 quad_perm:[0,1,2,3] row_mask:0xc bank_mask:0xf
v_bfi_b32 v60, 1, v4, v60
s_cbranch_scc1 L_np12_g
buffer_store_dwordx4 v[60:63], v6, s[16:19], s30 offen
s_nop 1
L_np12:
s_cmpk_gt_i32 s45, 2004
s_cbranch_scc1 L_pk_160
s_waitcnt vmcnt(5)
L_pk_160:
s_add_u32 s24, s24, 4096
buffer_load_dwordx4 v[88:91], v1, s[12:15], s24 offen offset:0 sc1 nt
v_and_b32_dpp v12, v25, v8 row_newbcast:0 row_mask:0xf bank_mask:0xf
v_and_b32_dpp v13, v25, v9 row_newbcast:0 row_mask:0xf bank_mask:0xf
v_and_b32_dpp v14, v25, v10 row_newbcast:0 row_mask:0xf bank_mask:0xf
v_and_b32_dpp v15, v25, v11 row_newbcast:0 row_mask:0xf bank_mask:0xf
v_and_b32_dpp v16, v25, v8 row_newbcast:4 row_mask:0xf bank_mask:0xf
v_and_b32_dpp v17, v25, v9 row_newbcast:4 row_mask:0xf bank_mask:0xf
v_mfma_f32_16x16x32_bf16 v[40:43], v[12:15], v[52:55], 0
ds_read_b128 v[52:55], v2 offset:1024
v_and_b32_dpp v18, v25, v10 row_newbcast:4 row_mask:0xf bank_mask:0xf
v_and_b32_dpp v19, v25, v11 row_newbcast:4 row_mask:0xf bank_mask:0xf
v_mfma_f32_16x16x32_bf16 v[44:47], v[12:15], v[184:187], 0
v_and_b32_dpp v12, v25, v8 row_newbcast:8 row_mask:0xf bank_mask:0xf
v_and_b32_dpp v13, v25, v9 row_newbcast:8 row_mask:0xf bank_mask:0xf
v_mfma_f32_16x16x32_bf16 v[40:43], v[16:19], v[56:59], v[40:43]
ds_read_b128 v[56:59], v2 offset:6144
v_and_b32_dpp v14, v25, v10 row_newbcast:8 row_mask:0xf bank_mask:0xf
v_and_b32_dpp v15, v25, v11 row_newbcast:8 row_mask:0xf bank_mask:0xf
v_mfma_f32_16x16x32_bf16 v[44:47], v[16:19], v[188:191], v[44:47]
v_and_b32_dpp v16, v25, v8 row_newbcast:12 row_mask:0xf bank_mask:0xf
v_and_b32_dpp v17, v25, v9 row_newbcast:12 row_mask:0xf bank_mask:0xf
v_mfma_f32_16x16x32_bf16 v[40:43], v[12:15], v[192:195], v[40:43]
v_and_b32_dpp v18, v25, v10 row_newbcast:12 row_mask:0xf bank_mask:0xf
v_and_b32_dpp v19, v25, v11 row_newbcast:12 row_mask:0xf bank_mask:0xf
v_mfma_f32_16x16x32_bf16 v[44:47], v[12:15], v[200:203], v[44:47]
v_add_f32_dpp v49, v49, v49 row_ror:4 row_mask:0xf bank_mask:0xf
s_nop 1
v_add_f32_dpp v49, v49, v49 row_ror:8 row_mask:0xf bank_mask:0xf
v_mov_b32 v30, v49
s_nop 1
v_permlane16_swap_b32 v49, v30
v_add_f32 v49, v49, v30
v_mov_b32 v30, v49
s_nop 1
v_permlane32_swap_b32 v49, v30
v_add_f32 v49, v49, v30
s_waitcnt vmcnt(8)
s_cmpk_gt_i32 s45, 2054
s_cbranch_scc1 L_pk_161
s_waitcnt vmcnt(6)
L_pk_161:
s_add_u32 m0, s33, 12032
s_nop 0
buffer_load_dwordx4 v1, s[12:15], s24 offen offset:256 sc1 nt lds
v_and_b32_dpp v12, v26, v8 row_newbcast:0 row_mask:0xf bank_mask:0xf
v_and_b32_dpp v13, v26, v9 row_newbcast:0 row_mask:0xf bank_mask:0xf
v_mfma_f32_16x16x32_bf16 v[40:43], v[16:19], v[196:199], v[40:43]
v_and_b32_dpp v14, v26, v10 row_newbcast:0 row_mask:0xf bank_mask:0xf
v_and_b32_dpp v15, v26, v11 row_newbcast:0 row_mask:0xf bank_mask:0xf
v_mfma_f32_16x16x32_bf16 v[44:47], v[16:19], v[204:207], v[44:47]
v_and_b32_dpp v16, v26, v8 row_newbcast:4 row_mask:0xf bank_mask:0xf
v_and_b32_dpp v17, v26, v9 row_newbcast:4 row_mask:0xf bank_mask:0xf
s_waitcnt lgkmcnt(1)
v_mfma_f32_16x16x32_bf16 v[40:43], v[12:15], v[52:55], v[40:43]
ds_read_b128 v[52:55], v2 offset:2048
v_and_b32_dpp v18, v26, v10 row_newbcast:4 row_mask:0xf bank_mask:0xf
v_and_b32_dpp v19, v26, v11 row_newbcast:4 row_mask:0xf bank_mask:0xf
v_mfma_f32_16x16x32_bf16 v[44:47], v[12:15], v[208:211], v[44:47]
v_and_b32_dpp v12, v26, v8 row_newbcast:8 row_mask:0xf bank_mask:0xf
v_and_b32_dpp v13, v26, v9 row_newbcast:8 row_mask:0xf bank_mask:0xf
s_waitcnt lgkmcnt(1)
v_mfma_f32_16x16x32_bf16 v[40:43], v[16:19], v[56:59], v[40:43]
ds_read_b128 v[56:59], v2 offset:7168
v_and_b32_dpp v14, v26, v10 row_newbcast:8 row_mask:0xf bank_mask:0xf
v_and_b32_dpp v15, v26, v11 row_newbcast:8 row_mask:0xf bank_mask:0xf
v_mfma_f32_16x16x32_bf16 v[44:47], v[16:19], v[212:215], v[44:47]
v_and_b32_dpp v16, v26, v8 row_newbcast:12 row_mask:0xf bank_mask:0xf
v_and_b32_dpp v17, v26, v9 row_newbcast:12 row_mask:0xf bank_mask:0xf
v_mfma_f32_16x16x32_bf16 v[40:43], v[12:15], v[216:219], v[40:43]
v_and_b32_dpp v18, v26, v10 row_newbcast:12 row_mask:0xf bank_mask:0xf
v_and_b32_dpp v19, v26, v11 row_newbcast:12 row_mask:0xf bank_mask:0xf
v_mfma_f32_16x16x32_bf16 v[44:47], v[12:15], v[224:227], v[44:47]
s_waitcnt vmcnt(8)
s_cmpk_gt_i32 s45, 2004
s_cbranch_scc1 L_pk_162
s_waitcnt vmcnt(5)
L_pk_162:
buffer_load_dwordx4 v[92:95], v1, s[12:15], s24 offen offset:2048 sc1 nt
v_and_b32_dpp v12, v27, v8 row_newbcast:0 row_mask:0xf bank_mask:0xf
v_and_b32_dpp v13, v27, v9 row_newbcast:0 row_mask:0xf bank_mask:0xf
v_mfma_f32_16x16x32_bf16 v[40:43], v[16:19], v[220:223], v[40:43]
v_and_b32_dpp v14, v27, v10 row_newbcast:0 row_mask:0xf bank_mask:0xf
v_and_b32_dpp v15, v27, v11 row_newbcast:0 row_mask:0xf bank_mask:0xf
v_mfma_f32_16x16x32_bf16 v[44:47], v[16:19], v[228:231], v[44:47]
v_and_b32_dpp v16, v27, v8 row_newbcast:4 row_mask:0xf bank_mask:0xf
v_and_b32_dpp v17, v27, v9 row_newbcast:4 row_mask:0xf bank_mask:0xf
s_waitcnt lgkmcnt(1)
v_mfma_f32_16x16x32_bf16 v[40:43], v[12:15], v[52:55], v[40:43]
ds_read_b128 v[52:55], v2 offset:3072
v_and_b32_dpp v18, v27, v10 row_newbcast:4 row_mask:0xf bank_mask:0xf
v_and_b32_dpp v19, v27, v11 row_newbcast:4 row_mask:0xf bank_mask:0xf
v_mfma_f32_16x16x32_bf16 v[44:47], v[12:15], v[232:235], v[44:47]
v_and_b32_dpp v12, v27, v8 row_newbcast:8 row_mask:0xf bank_mask:0xf
v_and_b32_dpp v13, v27, v9 row_newbcast:8 row_mask:0xf bank_mask:0xf
s_waitcnt lgkmcnt(1)
v_mfma_f32_16x16x32_bf16 v[40:43], v[16:19], v[56:59], v[40:43]
ds_read_b128 v[56:59], v2 offset:8192
v_and_b32_dpp v14, v27, v10 row_newbcast:8 row_mask:0xf bank_mask:0xf
v_and_b32_dpp v15, v27, v11 row_newbcast:8 row_mask:0xf bank_mask:0xf
v_mfma_f32_16x16x32_bf16 v[44:47], v[16:19], v[236:239], v[44:47]
v_and_b32_dpp v16, v27, v8 row_newbcast:12 row_mask:0xf bank_mask:0xf
v_and_b32_dpp v17, v27, v9 row_newbcast:12 row_mask:0xf bank_mask:0xf
v_mfma_f32_16x16x32_bf16 v[40:43], v[12:15], v[240:243], v[40:43]
v_and_b32_dpp v18, v27, v10 row_newbcast:12 row_mask:0xf bank_mask:0xf
v_and_b32_dpp v19, v27, v11 row_newbcast:12 row_mask:0xf bank_mask:0xf
v_mfma_f32_16x16x32_bf16 v[44:47], v[12:15], v[248:251], v[44:47]
s_waitcnt vmcnt(8)
s_cmpk_gt_i32 s45, 2054
s_cbranch_scc1 L_pk_163
s_waitcnt vmcnt(6)
L_pk_163:
buffer_load_dwordx4 v[96:99], v1, s[12:15], s24 offen offset:2304 sc1 nt
v_and_b32_dpp v12, v28, v8 row_newbcast:0 row_mask:0xf bank_mask:0xf
v_and_b32_dpp v13, v28, v9 row_newbcast:0 row_mask:0xf bank_mask:0xf
v_mfma_f32_16x16x32_bf16 v[40:43], v[16:19], v[244:247], v[40:43]
v_and_b32_dpp v14, v28, v10 row_newbcast:0 row_mask:0xf bank_mask:0xf
v_and_b32_dpp v15, v28, v11 row_newbcast:0 row_mask:0xf bank_mask:0xf
v_mfma_f32_16x16x32_bf16 v[44:47], v[16:19], v[252:255], v[44:47]
v_and_b32_dpp v16, v28, v8 row_newbcast:4 row_mask:0xf bank_mask:0xf
v_and_b32_dpp v17, v28, v9 row_newbcast:4 row_mask:0xf bank_mask:0xf
s_waitcnt lgkmcnt(1)
v_mfma_f32_16x16x32_bf16 v[40:43], v[12:15], v[52:55], v[40:43]
ds_read_b128 v[52:55], v2 offset:4096
v_and_b32_dpp v18, v28, v10 row_newbcast:4 row_mask:0xf bank_mask:0xf
v_and_b32_dpp v19, v28, v11 row_newbcast:4 row_mask:0xf bank_mask:0xf
v_mfma_f32_16x16x32_bf16 v[44:47], v[12:15], a[0:3], v[44:47]
v_and_b32_dpp v12, v28, v8 row_newbcast:8 row_mask:0xf bank_mask:0xf
v_and_b32_dpp v13, v28, v9 row_newbcast:8 row_mask:0xf bank_mask:0xf
s_waitcnt lgkmcnt(1)
v_mfma_f32_16x16x32_bf16 v[40:43], v[16:19], v[56:59], v[40:43]
ds_read_b128 v[56:59], v2 offset:9216
v_and_b32_dpp v14, v28, v10 row_newbcast:8 row_mask:0xf bank_mask:0xf
v_and_b32_dpp v15, v28, v11 row_newbcast:8 row_mask:0xf bank_mask:0xf
v_mfma_f32_16x16x32_bf16 v[44:47], v[16:19], a[4:7], v[44:47]
v_and_b32_dpp v16, v28, v8 row_newbcast:12 row_mask:0xf bank_mask:0xf
v_and_b32_dpp v17, v28, v9 row_newbcast:12 row_mask:0xf bank_mask:0xf
v_mfma_f32_16x16x32_bf16 v[40:43], v[12:15], a[8:11], v[40:43]
v_and_b32_dpp v18, v28, v10 row_newbcast:12 row_mask:0xf bank_mask:0xf
v_and_b32_dpp v19, v28, v11 row_newbcast:12 row_mask:0xf bank_mask:0xf
v_mfma_f32_16x16x32_bf16 v[44:47], v[12:15], a[16:19], v[44:47]
s_waitcnt vmcnt(8)
s_cmpk_gt_i32 s45, 2004
s_cbranch_scc1 L_pk_164
s_waitcnt vmcnt(5)
L_pk_164:
s_add_u32 s24, s24, 4096
buffer_load_dwordx4 v[100:103], v1, s[12:15], s24 offen offset:0 sc1 nt
v_and_b32_dpp v12, v29, v8 row_newbcast:0 row_mask:0xf bank_mask:0xf
v_and_b32_dpp v13, v29, v9 row_newbcast:0 row_mask:0xf bank_mask:0xf
v_mfma_f32_16x16x32_bf16 v[40:43], v[16:19], a[12:15], v[40:43]
v_and_b32_dpp v14, v29, v10 row_newbcast:0 row_mask:0xf bank_mask:0xf
v_and_b32_dpp v15, v29, v11 row_newbcast:0 row_mask:0xf bank_mask:0xf
v_mfma_f32_16x16x32_bf16 v[44:47], v[16:19], a[20:23], v[44:47]
v_and_b32_dpp v16, v29, v8 row_newbcast:4 row_mask:0xf bank_mask:0xf
v_and_b32_dpp v17, v29, v9 row_newbcast:4 row_mask:0xf bank_mask:0xf
s_waitcnt lgkmcnt(1)
v_mfma_f32_16x16x32_bf16 v[40:43], v[12:15], v[52:55], v[40:43]
v_and_b32_dpp v18, v29, v10 row_newbcast:4 row_mask:0xf bank_mask:0xf
v_and_b32_dpp v19, v29, v11 row_newbcast:4 row_mask:0xf bank_mask:0xf
v_mfma_f32_16x16x32_bf16 v[44:47], v[12:15], a[24:27], v[44:47]
v_and_b32_dpp v12, v29, v8 row_newbcast:8 row_mask:0xf bank_mask:0xf
v_and_b32_dpp v13, v29, v9 row_newbcast:8 row_mask:0xf bank_mask:0xf
s_waitcnt lgkmcnt(0)
v_mfma_f32_16x16x32_bf16 v[40:43], v[16:19], v[56:59], v[40:43]
v_and_b32_dpp v14, v29, v10 row_newbcast:8 row_mask:0xf bank_mask:0xf
v_and_b32_dpp v15, v29, v11 row_newbcast:8 row_mask:0xf bank_mask:0xf
v_mfma_f32_16x16x32_bf16 v[44:47], v[16:19], a[28:31], v[44:47]
s_nop 0
v_mfma_f32_16x16x32_bf16 v[40:43], v[12:15], v[176:179], v[40:43]
v_mfma_f32_16x16x32_bf16 v[44:47], v[12:15], v[180:183], v[44:47]
s_nop 6
v_cvt_pk_bf16_f32 v40, v40, v41
v_cvt_pk_bf16_f32 v41, v42, v43
v_cvt_pk_bf16_f32 v42, v44, v45
v_cvt_pk_bf16_f32 v43, v46, v47
v_mov_b32_dpp v40, v48 quad_perm:[0,0,0,0] row_mask:0xc bank_mask:0xf
v_mov_b32_dpp v41, v49 quad_perm:[0,0,0,0] row_mask:0xc bank_mask:0xf
ds_write_b128 v2, v[40:43] offset:18432
v_subrev_u32 v16, s33, v2
v_lshrrev_b32 v60, 8, v16
v_mul_u32_u24 v60, 40704, v60
v_add_u32 v16, v16, v60
s_cmp_lg_u32 s3, 1
s_waitcnt lgkmcnt(0)
s_barrier
s_cbranch_scc1 L_np22
L_np22_e:
ds_read_b64 v[48:49], v16 offset:18944
ds_read_b128 v[40:43], v16 offset:18432
ds_read_b128 v[44:47], v16 offset:18688
s_waitcnt lgkmcnt(2)
v_mov_b32 v60, v48
v_mov_b32 v61, v48
s_nop 1
v_permlane16_swap_b32 v60, v61
v_max_f32 v60, v60, v61
v_mov_b32 v61, v60
s_nop 1
v_permlane32_swap_b32 v60, v61
v_max_f32 v16, v60, v61
v_sub_f32 v48, v48, v16
v_exp_f32 v48, v48
s_nop 0
v_cvt_pk_bf16_f32 v60, v48, v48
v_and_b32 v12, v60, v8
v_and_b32 v13, v60, v9
v_and_b32 v14, v60, v10
v_and_b32 v15, v60, v11
s_cmp_lg_u32 s37, 0
v_mul_f32 v49, v49, v48
v_mov_b32 v48, v49
s_waitcnt lgkmcnt(1)
v_mfma_f32_16x16x32_bf16 v[60:63], v[12:15], v[40:43], 0
s_waitcnt lgkmcnt(0)
v_mfma_f32_16x16x32_bf16 v[40:43], v[12:15], v[44:47], 0
v_permlane16_swap_b32 v49, v48
v_add_f32 v49, v49, v48
v_mov_b32 v48, v49
s_nop 1
v_permlane32_swap_b32 v49, v48
v_add_f32 v49, v49, v48
v_and_b32 v48, -2, v4
v_xor_b32 v4, 1, v4
v_cvt_pk_bf16_f32 v60, v60, v61
v_cvt_pk_bf16_f32 v61, v62, v63
v_cvt_pk_bf16_f32 v62, v40, v41
v_cvt_pk_bf16_f32 v63, v42, v43
v_mov_b32_dpp v60, v49 quad_perm:[0,1,2,3] row_mask:0xc bank_mask:0xf
v_mov_b32_dpp v61, v16 quad_perm:[0,1,2,3] row_mask:0xc bank_mask:0xf
v_bfi_b32 v60, 1, v4, v60
s_cbranch_scc1 L_np22_g
buffer_store_dwordx4 v[60:63], v48, s[16:19], s31 offen
s_nop 1
L_np22:
s_waitcnt vmcnt(8)
s_cmpk_gt_i32 s45, 2054
s_cbranch_scc1 L_pk_165
s_waitcnt vmcnt(6)
L_pk_165:
s_add_u32 m0, s33, 13056
s_nop 0
buffer_load_dwordx4 v1, s[12:15], s24 offen offset:256 sc1 nt lds
s_waitcnt vmcnt(8)
s_cmpk_gt_i32 s45, 2004
s_cbranch_scc1 L_pk_166
s_waitcnt vmcnt(5)
L_pk_166:
buffer_load_dwordx4 v[104:107], v1, s[12:15], s24 offen offset:2048 sc1 nt
s_waitcnt vmcnt(8)
s_cmpk_gt_i32 s45, 2054
s_cbranch_scc1 L_pk_167
s_waitcnt vmcnt(6)
L_pk_167:
buffer_load_dwordx4 v[108:111], v1, s[12:15], s24 offen offset:2304 sc1 nt
s_memrealtime s[42:43]
s_waitcnt vmcnt(8)
s_waitcnt lgkmcnt(0)
s_sub_u32 s45, s42, s94
s_cmpk_gt_i32 s45, 2218
s_cbranch_scc1 L_pk_168
s_waitcnt vmcnt(5)
L_pk_168:
s_add_u32 s24, s24, 4096
buffer_load_dwordx4 v[112:115], v1, s[12:15], s24 offen offset:0 sc1 nt
s_waitcnt vmcnt(8)
s_cmpk_gt_i32 s45, 2268
s_cbranch_scc1 L_pk_169
s_waitcnt vmcnt(6)
L_pk_169:
s_add_u32 m0, s33, 14080
s_nop 0
buffer_load_dwordx4 v1, s[12:15], s24 offen offset:256 sc1 nt lds
s_memrealtime s[42:43]
s_waitcnt vmcnt(8)
s_waitcnt lgkmcnt(0)
s_sub_u32 s45, s42, s94
s_cmpk_gt_i32 s45, 2241
s_cbranch_scc1 L_pk_170
s_waitcnt vmcnt(5)
L_pk_170:
buffer_load_dwordx4 v[116:119], v1, s[12:15], s24 offen offset:2048 sc1 nt
s_waitcnt vmcnt(8)
s_cmpk_gt_i32 s45, 2291
s_cbranch_scc1 L_pk_171
s_waitcnt vmcnt(6)
L_pk_171:
buffer_load_dwordx4 v[120:123], v1, s[12:15], s24 offen offset:2304 sc1 nt
s_memrealtime s[42:43]
s_waitcnt vmcnt(8)
s_waitcnt lgkmcnt(0)
s_sub_u32 s45, s42, s94
s_cmpk_gt_i32 s45, 2265
s_cbranch_scc1 L_pk_172
s_waitcnt vmcnt(5)
L_pk_172:
s_add_u32 s24, s24, 4096
buffer_load_dwordx4 v[124:127], v1, s[12:15], s24 offen offset:0 sc1 nt
s_waitcnt vmcnt(8)
s_cmpk_gt_i32 s45, 2315
s_cbranch_scc1 L_pk_173
s_waitcnt vmcnt(6)
L_pk_173:
s_add_u32 m0, s33, 15104
s_nop 0
buffer_load_dwordx4 v1, s[12:15], s24 offen offset:256 sc1 nt lds
s_memrealtime s[42:43]
s_waitcnt vmcnt(8)
s_waitcnt lgkmcnt(0)
s_sub_u32 s45, s42, s94
s_cmpk_gt_i32 s45, 2289
s_cbranch_scc1 L_pk_174
s_waitcnt vmcnt(5)
L_pk_174:
buffer_load_dwordx4 v[128:131], v1, s[12:15], s24 offen offset:2048 sc1 nt
s_waitcnt vmcnt(8)
s_cmpk_gt_i32 s45, 2339
s_cbranch_scc1 L_pk_175
s_waitcnt vmcnt(6)
L_pk_175:
buffer_load_dwordx4 v[132:135], v1, s[12:15], s24 offen offset:2304 sc1 nt
s_memrealtime s[42:43]
s_waitcnt vmcnt(8)
s_waitcnt lgkmcnt(0)
s_sub_u32 s45, s42, s94
s_cmpk_gt_i32 s45, 2313
s_cbranch_scc1 L_pk_176
s_waitcnt vmcnt(5)
L_pk_176:
s_add_u32 s24, s24, 4096
buffer_load_dwordx4 v[136:139], v1, s[12:15], s24 offen offset:0 sc1 nt
s_barrier
s_waitcnt vmcnt(8)
s_cmpk_gt_i32 s45, 2363
s_cbranch_scc1 L_pk_177
s_waitcnt vmcnt(6)
L_pk_177:
s_add_u32 m0, s33, 16128
s_nop 0
buffer_load_dwordx4 v1, s[12:15], s24 offen offset:256 sc1 nt lds
s_memrealtime s[42:43]
s_waitcnt vmcnt(8)
s_waitcnt lgkmcnt(0)
s_sub_u32 s45, s42, s94
s_cmpk_gt_i32 s45, 2336
s_cbranch_scc1 L_pk_178
s_waitcnt vmcnt(5)
L_pk_178:
buffer_load_dwordx4 v[140:143], v1, s[12:15], s24 offen offset:2048 sc1 nt
s_waitcnt vmcnt(8)
s_cmpk_gt_i32 s45, 2386
s_cbranch_scc1 L_pk_179
s_waitcnt vmcnt(6)
L_pk_179:
buffer_load_dwordx4 v[144:147], v1, s[12:15], s24 offen offset:2304 sc1 nt
s_memrealtime s[42:43]
s_waitcnt vmcnt(8)
s_waitcnt lgkmcnt(0)
s_sub_u32 s45, s42, s94
s_cmpk_gt_i32 s45, 2360
s_cbranch_scc1 L_pk_180
s_waitcnt vmcnt(5)
L_pk_180:
s_add_u32 s24, s24, 4096
buffer_load_dwordx4 v[148:151], v1, s[12:15], s24 offen offset:0 sc1 nt
s_waitcnt vmcnt(8)
s_cmpk_gt_i32 s45, 2410
s_cbranch_scc1 L_pk_181
s_waitcnt vmcnt(6)
L_pk_181:
s_add_u32 m0, s33, 17152
s_nop 0
buffer_load_dwordx4 v1, s[12:15], s24 offen offset:256 sc1 nt lds
s_memrealtime s[42:43]
s_waitcnt vmcnt(8)
s_waitcnt lgkmcnt(0)
s_sub_u32 s45, s42, s94
s_cmpk_gt_i32 s45, 2384
s_cbranch_scc1 L_pk_182
s_waitcnt vmcnt(5)
L_pk_182:
buffer_load_dwordx4 v[152:155], v1, s[12:15], s24 offen offset:2048 sc1 nt
s_waitcnt vmcnt(8)
s_cmpk_gt_i32 s45, 2434
s_cbranch_scc1 L_pk_183
s_waitcnt vmcnt(6)
L_pk_183:
buffer_load_dwordx4 v[156:159], v1, s[12:15], s24 offen offset:2304 sc1 nt
s_memrealtime s[42:43]
s_waitcnt vmcnt(8)
s_waitcnt lgkmcnt(0)
s_sub_u32 s45, s42, s94
s_cmpk_gt_i32 s45, 2408
s_cbranch_scc1 L_pk_184
s_waitcnt vmcnt(5)
L_pk_184:
s_add_u32 s24, s24, 4096
buffer_load_dwordx4 v[160:163], v1, s[12:15], s24 offen offset:0 sc1 nt
s_waitcnt vmcnt(8)
s_cmpk_gt_i32 s45, 2458
s_cbranch_scc1 L_pk_185
s_waitcnt vmcnt(6)
L_pk_185:
s_add_u32 m0, s33, 18176
s_nop 0
buffer_load_dwordx4 v1, s[12:15], s24 offen offset:256 sc1 nt lds
s_memrealtime s[42:43]
s_waitcnt vmcnt(8)
s_waitcnt lgkmcnt(0)
s_sub_u32 s45, s42, s94
s_cmpk_gt_i32 s45, 2431
s_cbranch_scc1 L_pk_186
s_waitcnt vmcnt(5)
L_pk_186:
buffer_load_dwordx4 v[164:167], v1, s[12:15], s24 offen offset:2048 sc1 nt
s_waitcnt vmcnt(8)
s_cmpk_gt_i32 s45, 2481
s_cbranch_scc1 L_pk_187
s_waitcnt vmcnt(6)
L_pk_187:
buffer_load_dwordx4 v[168:171], v1, s[12:15], s24 offen offset:2304 sc1 nt
s_memrealtime s[42:43]
s_waitcnt vmcnt(8)
s_waitcnt lgkmcnt(0)
s_sub_u32 s45, s42, s94
s_cmpk_gt_i32 s45, 2455
s_cbranch_scc1 L_pk_188
s_waitcnt vmcnt(5)
L_pk_188:
s_add_u32 s24, s24, s26
buffer_load_dwordx4 v[172:175], v1, s[12:15], s24 offen offset:0 sc1 nt
s_waitcnt vmcnt(8)
s_cmpk_gt_i32 s45, 2505
s_cbranch_scc1 L_pk_189
s_waitcnt vmcnt(6)
L_pk_189:
s_add_u32 m0, s33, 19200
s_nop 0
buffer_load_dwordx4 v1, s[12:15], s24 offen offset:256 sc1 nt lds
s_memrealtime s[42:43]
s_waitcnt vmcnt(8)
s_waitcnt lgkmcnt(0)
s_sub_u32 s45, s42, s94
s_cmpk_gt_i32 s45, 2459
s_cbranch_scc1 L_pk_190
s_waitcnt vmcnt(4)
L_pk_190:
s_mov_b32 s24, 67108864
s_add_u32 m0, s33, 0
s_nop 0
buffer_load_dwordx4 v0, s[8:11], s24 offen offset:0 sc1 nt lds
buffer_load_dwordx4 v[32:35], v3, s[16:19], s28 offen sc1
buffer_load_dwordx4 v[36:39], v3, s[16:19], s28 offen offset:256 sc1
s_waitcnt vmcnt(10)
s_cmpk_gt_i32 s45, 2519
s_cbranch_scc1 L_pk_191
s_waitcnt vmcnt(7)
L_pk_191:
buffer_load_dwordx4 v[184:187], v0, s[8:11], s24 offen offset:256 sc1 nt
s_memrealtime s[42:43]
s_waitcnt vmcnt(10)
s_waitcnt lgkmcnt(0)
s_sub_u32 s45, s42, s94
s_cmpk_gt_i32 s45, 2483
s_cbranch_scc1 L_pk_192
s_waitcnt vmcnt(6)
L_pk_192:
s_add_u32 m0, s33, 3072
s_nop 0
buffer_load_dwordx4 v0, s[8:11], s24 offen offset:2048 sc1 nt lds
s_waitcnt vmcnt(10)
s_cmpk_gt_i32 s45, 2543
s_cbranch_scc1 L_pk_193
s_waitcnt vmcnt(7)
L_pk_193:
buffer_load_dwordx4 v[188:191], v0, s[8:11], s24 offen offset:2304 sc1 nt
s_memrealtime s[42:43]
s_waitcnt vmcnt(10)
s_waitcnt lgkmcnt(0)
s_sub_u32 s45, s42, s94
s_cmpk_gt_i32 s45, 2506
s_cbranch_scc1 L_pk_194
s_waitcnt vmcnt(6)
L_pk_194:
s_add_u32 s24, s24, 4096
buffer_load_dwordx4 v[192:195], v0, s[8:11], s24 offen offset:0 sc1 nt
s_waitcnt vmcnt(10)
s_cmpk_gt_i32 s45, 2566
s_cbranch_scc1 L_pk_195
s_waitcnt vmcnt(7)
L_pk_195:
buffer_load_dwordx4 v[200:203], v0, s[8:11], s24 offen offset:256 sc1 nt
s_memrealtime s[42:43]
s_waitcnt vmcnt(10)
s_waitcnt lgkmcnt(0)
s_sub_u32 s45, s42, s94
s_cmpk_gt_i32 s45, 2530
s_cbranch_scc1 L_pk_196
s_waitcnt vmcnt(4)
L_pk_196:
buffer_load_dwordx4 v[196:199], v0, s[8:11], s24 offen offset:2048 sc1 nt
s_waitcnt vmcnt(10)
s_cmpk_gt_i32 s45, 2590
s_cbranch_scc1 L_pk_197
s_waitcnt vmcnt(5)
L_pk_197:
buffer_load_dwordx4 v[204:207], v0, s[8:11], s24 offen offset:2304 sc1 nt
s_memrealtime s[42:43]
s_waitcnt vmcnt(10)
s_waitcnt lgkmcnt(0)
s_sub_u32 s45, s42, s94
s_cmpk_gt_i32 s45, 2554
s_cbranch_scc1 L_pk_198
s_waitcnt vmcnt(4)
L_pk_198:
s_add_u32 s24, s24, 4096
s_add_u32 m0, s33, 1024
s_nop 0
buffer_load_dwordx4 v0, s[8:11], s24 offen offset:0 sc1 nt lds
s_waitcnt vmcnt(10)
ds_read_b128 v[52:55], v2 offset:0
s_cmpk_gt_i32 s45, 2614
s_cbranch_scc1 L_pk_199
s_waitcnt vmcnt(5)
L_pk_199:
buffer_load_dwordx4 v[208:211], v0, s[8:11], s24 offen offset:256 sc1 nt
s_waitcnt vmcnt(9)
v_max_u32 v30, v32, v36
v_cmp_eq_u32 vcc, -1, v30
s_cbranch_vccnz L_q12_s
L_q12_r:
s_memrealtime s[42:43]
s_waitcnt vmcnt(8)
s_waitcnt lgkmcnt(0)
s_sub_u32 s45, s42, s94
s_cmpk_gt_i32 s45, 2578
s_cbranch_scc1 L_pk_200
s_waitcnt vmcnt(4)
L_pk_200:
s_add_u32 m0, s33, 4096
s_nop 0
buffer_load_dwordx4 v0, s[8:11], s24 offen offset:2048 sc1 nt lds
v_mfma_f32_16x16x32_bf16 v[40:43], v[52:55], v[32:35], 0
v_mfma_f32_16x16x32_bf16 v[40:43], v[184:187], v[36:39], v[40:43]
s_waitcnt vmcnt(8)
ds_read_b128 v[56:59], v2 offset:5120
s_cmpk_gt_i32 s45, 2638
s_cbranch_scc1 L_pk_201
s_waitcnt vmcnt(5)
L_pk_201:
buffer_load_dwordx4 v[212:215], v0, s[8:11], s24 offen offset:2304 sc1 nt
s_memrealtime s[42:43]
s_waitcnt vmcnt(8)
s_waitcnt lgkmcnt(0)
s_sub_u32 s45, s42, s94
s_cmpk_gt_i32 s45, 2621
s_cbranch_scc1 L_pk_202
s_waitcnt vmcnt(5)
L_pk_202:
s_add_u32 s24, s24, 4096
buffer_load_dwordx4 v[216:219], v0, s[8:11], s24 offen offset:0 sc1 nt
v_mfma_f32_16x16x32_bf16 v[44:47], v[56:59], v[32:35], 0
v_mfma_f32_16x16x32_bf16 v[44:47], v[188:191], v[36:39], v[44:47]
s_waitcnt vmcnt(8)
s_cmpk_gt_i32 s45, 2671
s_cbranch_scc1 L_pk_203
s_waitcnt vmcnt(6)
L_pk_203:
buffer_load_dwordx4 v[224:227], v0, s[8:11], s24 offen offset:256 sc1 nt
s_memrealtime s[42:43]
s_waitcnt vmcnt(8)
s_waitcnt lgkmcnt(0)
s_sub_u32 s45, s42, s94
s_cmpk_gt_i32 s45, 2645
s_cbranch_scc1 L_pk_204
s_waitcnt vmcnt(5)
L_pk_204:
buffer_load_dwordx4 v[220:223], v0, s[8:11], s24 offen offset:2048 sc1 nt
v_mfma_f32_16x16x32_bf16 v[48:51], v[192:195], v[32:35], 0
v_mfma_f32_16x16x32_bf16 v[48:51], v[200:203], v[36:39], v[48:51]
v_mov_b32 v24, 0xff800000
v_add_f32_dpp v30, v41, v40 quad_perm:[1,1,1,1] row_mask:0xf bank_mask:0xf
v_add_f32_dpp v31, v43, v42 quad_perm:[3,3,3,3] row_mask:0xf bank_mask:0xf
s_waitcnt vmcnt(8)
s_cmpk_gt_i32 s45, 2695
s_cbranch_scc1 L_pk_205
s_waitcnt vmcnt(6)
L_pk_205:
buffer_load_dwordx4 v[228:231], v0, s[8:11], s24 offen offset:2304 sc1 nt
s_memrealtime s[42:43]
s_waitcnt vmcnt(8)
s_waitcnt lgkmcnt(0)
s_sub_u32 s45, s42, s94
s_cmpk_gt_i32 s45, 2669
s_cbranch_scc1 L_pk_206
s_waitcnt vmcnt(5)
L_pk_206:
s_add_u32 s24, s24, 4096
s_add_u32 m0, s33, 2048
s_nop 0
buffer_load_dwordx4 v0, s[8:11], s24 offen offset:0 sc1 nt lds
v_mfma_f32_16x16x32_bf16 v[40:43], v[196:199], v[32:35], 0
v_mfma_f32_16x16x32_bf16 v[40:43], v[204:207], v[36:39], v[40:43]
v_add_f32_dpp v20, v31, v30 quad_perm:[2,2,2,2] row_mask:0xf bank_mask:0x1
v_add_f32_dpp v30, v45, v44 quad_perm:[1,1,1,1] row_mask:0xf bank_mask:0xf
v_add_f32_dpp v31, v47, v46 quad_perm:[3,3,3,3] row_mask:0xf bank_mask:0xf
s_waitcnt vmcnt(8)
ds_read_b128 v[52:55], v2 offset:1024
s_cmpk_gt_i32 s45, 2719
s_cbranch_scc1 L_pk_207
s_waitcnt vmcnt(6)
L_pk_207:
buffer_load_dwordx4 v[232:235], v0, s[8:11], s24 offen offset:256 sc1 nt
s_memrealtime s[42:43]
s_waitcnt vmcnt(8)
s_waitcnt lgkmcnt(0)
s_sub_u32 s45, s42, s94
s_cmpk_gt_i32 s45, 2693
s_cbranch_scc1 L_pk_208
s_waitcnt vmcnt(5)
L_pk_208:
s_add_u32 m0, s33, 5120
s_nop 0
buffer_load_dwordx4 v0, s[8:11], s24 offen offset:2048 sc1 nt lds
v_mfma_f32_16x16x32_bf16 v[44:47], v[52:55], v[32:35], 0
v_mfma_f32_16x16x32_bf16 v[44:47], v[208:211], v[36:39], v[44:47]
v_add_f32_dpp v20, v31, v30 quad_perm:[2,2,2,2] row_mask:0xf bank_mask:0x2
v_add_f32_dpp v30, v49, v48 quad_perm:[1,1,1,1] row_mask:0xf bank_mask:0xf
v_add_f32_dpp v31, v51, v50 quad_perm:[3,3,3,3] row_mask:0xf bank_mask:0xf
s_waitcnt vmcnt(8)
ds_read_b128 v[56:59], v2 offset:6144
s_cmpk_gt_i32 s45, 2743
s_cbranch_scc1 L_pk_209
s_waitcnt vmcnt(6)
L_pk_209:
buffer_load_dwordx4 v[236:239], v0, s[8:11], s24 offen offset:2304 sc1 nt
s_memrealtime s[42:43]
s_waitcnt vmcnt(8)
s_waitcnt lgkmcnt(0)
s_sub_u32 s45, s42, s94
s_cmpk_gt_i32 s45, 2716
s_cbranch_scc1 L_pk_210
s_waitcnt vmcnt(5)
L_pk_210:
s_add_u32 s24, s24, 4096
buffer_load_dwordx4 v[240:243], v0, s[8:11], s24 offen offset:0 sc1 nt
v_mfma_f32_16x16x32_bf16 v[48:51], v[56:59], v[32:35], 0
v_mfma_f32_16x16x32_bf16 v[48:51], v[212:215], v[36:39], v[48:51]
v_add_f32_dpp v20, v31, v30 quad_perm:[2,2,2,2] row_mask:0xf bank_mask:0x4
v_add_f32_dpp v30, v41, v40 quad_perm:[1,1,1,1] row_mask:0xf bank_mask:0xf
v_add_f32_dpp v31, v43, v42 quad_perm:[3,3,3,3] row_mask:0xf bank_mask:0xf
s_waitcnt vmcnt(8)
s_cmpk_gt_i32 s45, 2766
s_cbranch_scc1 L_pk_211
s_waitcnt vmcnt(6)
L_pk_211:
buffer_load_dwordx4 v[248:251], v0, s[8:11], s24 offen offset:256 sc1 nt
s_memrealtime s[42:43]
s_waitcnt vmcnt(8)
s_waitcnt lgkmcnt(0)
s_sub_u32 s45, s42, s94
s_cmpk_gt_i32 s45, 2740
s_cbranch_scc1 L_pk_212
s_waitcnt vmcnt(5)
L_pk_212:
buffer_load_dwordx4 v[244:247], v0, s[8:11], s24 offen offset:2048 sc1 nt
v_mfma_f32_16x16x32_bf16 v[40:43], v[216:219], v[32:35], 0
v_mfma_f32_16x16x32_bf16 v[40:43], v[224:227], v[36:39], v[40:43]
v_add_f32_dpp v20, v31, v30 quad_perm:[2,2,2,2] row_mask:0xf bank_mask:0x8
v_add_f32_dpp v30, v45, v44 quad_perm:[1,1,1,1] row_mask:0xf bank_mask:0xf
v_add_f32_dpp v31, v47, v46 quad_perm:[3,3,3,3] row_mask:0xf bank_mask:0xf
s_waitcnt vmcnt(8)
s_cmpk_gt_i32 s45, 2790
s_cbranch_scc1 L_pk_213
s_waitcnt vmcnt(6)
L_pk_213:
buffer_load_dwordx4 v[252:255], v0, s[8:11], s24 offen offset:2304 sc1 nt
s_memrealtime s[42:43]
s_waitcnt vmcnt(8)
s_waitcnt lgkmcnt(0)
s_sub_u32 s45, s42, s94
s_cmpk_gt_i32 s45, 2764
s_cbranch_scc1 L_pk_214
s_waitcnt vmcnt(5)
L_pk_214:
s_add_u32 s24, s24, 4096
s_add_u32 m0, s33, 3072
s_nop 0
buffer_load_dwordx4 v0, s[8:11], s24 offen offset:0 sc1 nt lds
v_mfma_f32_16x16x32_bf16 v[44:47], v[220:223], v[32:35], 0
v_mfma_f32_16x16x32_bf16 v[44:47], v[228:231], v[36:39], v[44:47]
v_add_f32_dpp v21, v31, v30 quad_perm:[2,2,2,2] row_mask:0xf bank_mask:0x1
v_add_f32_dpp v30, v49, v48 quad_perm:[1,1,1,1] row_mask:0xf bank_mask:0xf
v_add_f32_dpp v31, v51, v50 quad_perm:[3,3,3,3] row_mask:0xf bank_mask:0xf
s_waitcnt vmcnt(8)
ds_read_b128 v[52:55], v2 offset:2048
s_cmpk_gt_i32 s45, 2814
s_cbranch_scc1 L_pk_215
s_waitcnt vmcnt(6)
L_pk_215:
buffer_load_dwordx4 a[0:3], v0, s[8:11], s24 offen offset:256 sc1 nt
s_memrealtime s[42:43]
s_waitcnt vmcnt(8)
s_waitcnt lgkmcnt(0)
s_sub_u32 s45, s42, s94
s_cmpk_gt_i32 s45, 2788
s_cbranch_scc1 L_pk_216
s_waitcnt vmcnt(5)
L_pk_216:
s_add_u32 m0, s33, 6144
s_nop 0
buffer_load_dwordx4 v0, s[8:11], s24 offen offset:2048 sc1 nt lds
v_mfma_f32_16x16x32_bf16 v[48:51], v[52:55], v[32:35], 0
v_mfma_f32_16x16x32_bf16 v[48:51], v[232:235], v[36:39], v[48:51]
v_add_f32_dpp v21, v31, v30 quad_perm:[2,2,2,2] row_mask:0xf bank_mask:0x2
v_add_f32_dpp v30, v41, v40 quad_perm:[1,1,1,1] row_mask:0xf bank_mask:0xf
v_add_f32_dpp v31, v43, v42 quad_perm:[3,3,3,3] row_mask:0xf bank_mask:0xf
s_waitcnt vmcnt(8)
ds_read_b128 v[56:59], v2 offset:7168
s_cmpk_gt_i32 s45, 2838
s_cbranch_scc1 L_pk_217
s_waitcnt vmcnt(6)
L_pk_217:
buffer_load_dwordx4 a[4:7], v0, s[8:11], s24 offen offset:2304 sc1 nt
s_memrealtime s[42:43]
s_waitcnt vmcnt(8)
s_waitcnt lgkmcnt(0)
s_sub_u32 s45, s42, s94
s_cmpk_gt_i32 s45, 2811
s_cbranch_scc1 L_pk_218
s_waitcnt vmcnt(5)
L_pk_218:
s_add_u32 s24, s24, 4096
buffer_load_dwordx4 a[8:11], v0, s[8:11], s24 offen offset:0 sc1 nt
buffer_load_dwordx4 v[12:15], v3, s[16:19], s29 offen sc1
buffer_load_dwordx4 v[16:19], v3, s[16:19], s29 offen offset:256 sc1
v_mfma_f32_16x16x32_bf16 v[40:43], v[56:59], v[32:35], 0
v_mfma_f32_16x16x32_bf16 v[40:43], v[236:239], v[36:39], v[40:43]
v_add_f32_dpp v21, v31, v30 quad_perm:[2,2,2,2] row_mask:0xf bank_mask:0x4
v_add_f32_dpp v30, v45, v44 quad_perm:[1,1,1,1] row_mask:0xf bank_mask:0xf
v_add_f32_dpp v31, v47, v46 quad_perm:[3,3,3,3] row_mask:0xf bank_mask:0xf
s_waitcnt vmcnt(10)
s_cmpk_gt_i32 s45, 2861
s_cbranch_scc1 L_pk_219
s_waitcnt vmcnt(8)
L_pk_219:
buffer_load_dwordx4 a[16:19], v0, s[8:11], s24 offen offset:256 sc1 nt
s_memrealtime s[42:43]
s_waitcnt vmcnt(10)
s_waitcnt lgkmcnt(0)
s_sub_u32 s45, s42, s94
s_cmpk_gt_i32 s45, 2835
s_cbranch_scc1 L_pk_220
s_waitcnt vmcnt(7)
L_pk_220:
buffer_load_dwordx4 a[12:15], v0, s[8:11], s24 offen offset:2048 sc1 nt
v_mfma_f32_16x16x32_bf16 v[44:47], v[240:243], v[32:35], 0
v_mfma_f32_16x16x32_bf16 v[44:47], v[248:251], v[36:39], v[44:47]
v_add_f32_dpp v21, v31, v30 quad_perm:[2,2,2,2] row_mask:0xf bank_mask:0x8
v_add_f32_dpp v30, v49, v48 quad_perm:[1,1,1,1] row_mask:0xf bank_mask:0xf
v_add_f32_dpp v31, v51, v50 quad_perm:[3,3,3,3] row_mask:0xf bank_mask:0xf
s_waitcnt vmcnt(10)
s_cmpk_gt_i32 s45, 2885
s_cbranch_scc1 L_pk_221
s_waitcnt vmcnt(8)
L_pk_221:
buffer_load_dwordx4 a[20:23], v0, s[8:11], s24 offen offset:2304 sc1 nt
s_memrealtime s[42:43]
s_waitcnt vmcnt(10)
s_waitcnt lgkmcnt(0)
s_sub_u32 s45, s42, s94
s_cmpk_gt_i32 s45, 2859
s_cbranch_scc1 L_pk_222
s_waitcnt vmcnt(7)
L_pk_222:
s_add_u32 s24, s24, 4096
s_add_u32 m0, s33, 4096
s_nop 0
buffer_load_dwordx4 v0, s[8:11], s24 offen offset:0 sc1 nt lds
v_mfma_f32_16x16x32_bf16 v[48:51], v[244:247], v[32:35], 0
v_mfma_f32_16x16x32_bf16 v[48:51], v[252:255], v[36:39], v[48:51]
v_add_f32_dpp v22, v31, v30 quad_perm:[2,2,2,2] row_mask:0xf bank_mask:0x1
v_add_f32_dpp v30, v41, v40 quad_perm:[1,1,1,1] row_mask:0xf bank_mask:0xf
v_add_f32_dpp v31, v43, v42 quad_perm:[3,3,3,3] row_mask:0xf bank_mask:0xf
s_waitcnt vmcnt(10)
ds_read_b128 v[52:55], v2 offset:3072
s_cmpk_gt_i32 s45, 2909
s_cbranch_scc1 L_pk_223
s_waitcnt vmcnt(8)
L_pk_223:
buffer_load_dwordx4 a[24:27], v0, s[8:11], s24 offen offset:256 sc1 nt
s_memrealtime s[42:43]
s_waitcnt vmcnt(10)
s_waitcnt lgkmcnt(0)
s_sub_u32 s45, s42, s94
s_cmpk_gt_i32 s45, 2883
s_cbranch_scc1 L_pk_224
s_waitcnt vmcnt(7)
L_pk_224:
s_add_u32 m0, s33, 7168
s_nop 0
buffer_load_dwordx4 v0, s[8:11], s24 offen offset:2048 sc1 nt lds
v_mfma_f32_16x16x32_bf16 v[40:43], v[52:55], v[32:35], 0
ds_read_b128 v[52:55], v2 offset:30720
v_mfma_f32_16x16x32_bf16 v[40:43], a[0:3], v[36:39], v[40:43]
v_add_f32_dpp v22, v31, v30 quad_perm:[2,2,2,2] row_mask:0xf bank_mask:0x2
v_add_f32_dpp v30, v45, v44 quad_perm:[1,1,1,1] row_mask:0xf bank_mask:0xf
v_add_f32_dpp v31, v47, v46 quad_perm:[3,3,3,3] row_mask:0xf bank_mask:0xf
s_waitcnt vmcnt(10)
ds_read_b128 v[56:59], v2 offset:8192
s_cmpk_gt_i32 s45, 2933
s_cbranch_scc1 L_pk_225
s_waitcnt vmcnt(8)
L_pk_225:
buffer_load_dwordx4 a[28:31], v0, s[8:11], s24 offen offset:2304 sc1 nt
s_memrealtime s[42:43]
s_waitcnt vmcnt(10)
s_waitcnt lgkmcnt(0)
s_sub_u32 s45, s42, s94
s_cmpk_gt_i32 s45, 2906
s_cbranch_scc1 L_pk_226
s_waitcnt vmcnt(5)
L_pk_226:
s_add_u32 s24, s24, s26
buffer_load_dwordx4 v[176:179], v0, s[8:11], s24 offen offset:0 sc1 nt
v_mfma_f32_16x16x32_bf16 v[44:47], v[56:59], v[32:35], 0
ds_read_b128 v[56:59], v2 offset:31744
v_mfma_f32_16x16x32_bf16 v[44:47], a[4:7], v[36:39], v[44:47]
v_add_f32_dpp v22, v31, v30 quad_perm:[2,2,2,2] row_mask:0xf bank_mask:0x4
v_add_f32_dpp v30, v49, v48 quad_perm:[1,1,1,1] row_mask:0xf bank_mask:0xf
v_add_f32_dpp v31, v51, v50 quad_perm:[3,3,3,3] row_mask:0xf bank_mask:0xf
s_waitcnt vmcnt(10)
s_cmpk_gt_i32 s45, 2956
s_cbranch_scc1 L_pk_227
s_waitcnt vmcnt(6)
L_pk_227:
buffer_load_dwordx4 v[180:183], v0, s[8:11], s24 offen offset:256 sc1 nt
v_add_f32_dpp v22, v31, v30 quad_perm:[2,2,2,2] row_mask:0xf bank_mask:0x8
v_add_f32_dpp v30, v41, v40 quad_perm:[1,1,1,1] row_mask:0xf bank_mask:0xf
v_add_f32_dpp v31, v43, v42 quad_perm:[3,3,3,3] row_mask:0xf bank_mask:0xf
s_nop 1
v_add_f32_dpp v23, v31, v30 quad_perm:[2,2,2,2] row_mask:0xf bank_mask:0x1
v_add_f32_dpp v30, v45, v44 quad_perm:[1,1,1,1] row_mask:0xf bank_mask:0xf
v_add_f32_dpp v31, v47, v46 quad_perm:[3,3,3,3] row_mask:0xf bank_mask:0xf
s_nop 1
v_add_f32_dpp v23, v31, v30 quad_perm:[2,2,2,2] row_mask:0xf bank_mask:0x2
s_waitcnt vmcnt(9)
v_max_u32 v30, v12, v16
v_cmp_eq_u32 vcc, -1, v30
s_cbranch_vccnz L_q22_s
L_q22_r:
s_add_u32 s28, s28, 8192
s_add_u32 s29, s28, 24576
v_mfma_f32_16x16x32_bf16 v[40:43], a[32:35], v[12:15], 0
v_mfma_f32_16x16x32_bf16 v[40:43], v[52:55], v[16:19], v[40:43]
ds_read_b128 v[52:55], v2 offset:32768
v_mfma_f32_16x16x32_bf16 v[44:47], a[36:39], v[12:15], 0
v_mfma_f32_16x16x32_bf16 v[44:47], a[40:43], v[16:19], v[44:47]
v_mfma_f32_16x16x32_bf16 v[48:51], a[44:47], v[12:15], 0
s_waitcnt lgkmcnt(1)
v_mfma_f32_16x16x32_bf16 v[48:51], v[56:59], v[16:19], v[48:51]
ds_read_b128 v[56:59], v2 offset:33792
v_mov_b32 v29, 0xff800000
v_add_f32_dpp v30, v41, v40 quad_perm:[1,1,1,1] row_mask:0xf bank_mask:0xf
v_add_f32_dpp v31, v43, v42 quad_perm:[3,3,3,3] row_mask:0xf bank_mask:0xf
v_mfma_f32_16x16x32_bf16 v[40:43], a[48:51], v[12:15], 0
v_mfma_f32_16x16x32_bf16 v[40:43], a[52:55], v[16:19], v[40:43]
v_add_f32_dpp v25, v31, v30 quad_perm:[2,2,2,2] row_mask:0xf bank_mask:0x1
v_add_f32_dpp v30, v45, v44 quad_perm:[1,1,1,1] row_mask:0xf bank_mask:0xf
v_add_f32_dpp v31, v47, v46 quad_perm:[3,3,3,3] row_mask:0xf bank_mask:0xf
s_waitcnt vmcnt(8)
s_cmpk_gt_i32 s45, 2906
s_cbranch_scc1 L_pk_228
s_waitcnt vmcnt(5)
L_pk_228:
s_mov_b32 s24, 100663296
buffer_load_dwordx4 a[32:35], v0, s[8:11], s24 offen offset:0 sc1 nt
v_mfma_f32_16x16x32_bf16 v[44:47], a[56:59], v[12:15], 0
s_waitcnt lgkmcnt(1)
v_mfma_f32_16x16x32_bf16 v[44:47], v[52:55], v[16:19], v[44:47]
ds_read_b128 v[52:55], v2 offset:34816
v_add_f32_dpp v25, v31, v30 quad_perm:[2,2,2,2] row_mask:0xf bank_mask:0x2
v_add_f32_dpp v30, v49, v48 quad_perm:[1,1,1,1] row_mask:0xf bank_mask:0xf
v_add_f32_dpp v31, v51, v50 quad_perm:[3,3,3,3] row_mask:0xf bank_mask:0xf
v_mfma_f32_16x16x32_bf16 v[48:51], a[60:63], v[12:15], 0
v_mfma_f32_16x16x32_bf16 v[48:51], a[64:67], v[16:19], v[48:51]
v_add_f32_dpp v25, v31, v30 quad_perm:[2,2,2,2] row_mask:0xf bank_mask:0x4
v_add_f32_dpp v30, v41, v40 quad_perm:[1,1,1,1] row_mask:0xf bank_mask:0xf
v_add_f32_dpp v31, v43, v42 quad_perm:[3,3,3,3] row_mask:0xf bank_mask:0xf
v_mfma_f32_16x16x32_bf16 v[40:43], a[68:71], v[12:15], 0
s_waitcnt lgkmcnt(1)
v_mfma_f32_16x16x32_bf16 v[40:43], v[56:59], v[16:19], v[40:43]
ds_read_b128 v[56:59], v2 offset:35840
v_add_f32_dpp v25, v31, v30 quad_perm:[2,2,2,2] row_mask:0xf bank_mask:0x8
v_add_f32_dpp v30, v45, v44 quad_perm:[1,1,1,1] row_mask:0xf bank_mask:0xf
v_add_f32_dpp v31, v47, v46 quad_perm:[3,3,3,3] row_mask:0xf bank_mask:0xf
v_mfma_f32_16x16x32_bf16 v[44:47], a[72:75], v[12:15], 0
v_mfma_f32_16x16x32_bf16 v[44:47], a[76:79], v[16:19], v[44:47]
v_add_f32_dpp v26, v31, v30 quad_perm:[2,2,2,2] row_mask:0xf bank_mask:0x1
v_add_f32_dpp v30, v49, v48 quad_perm:[1,1,1,1] row_mask:0xf bank_mask:0xf
v_add_f32_dpp v31, v51, v50 quad_perm:[3,3,3,3] row_mask:0xf bank_mask:0xf
s_waitcnt vmcnt(8)
s_cmpk_gt_i32 s45, 2956
s_cbranch_scc1 L_pk_229
s_waitcnt vmcnt(6)
L_pk_229:
s_add_u32 m0, s33, 30464
s_nop 0
buffer_load_dwordx4 v0, s[8:11], s24 offen offset:256 sc1 nt lds
v_mfma_f32_16x16x32_bf16 v[48:51], a[80:83], v[12:15], 0
s_waitcnt lgkmcnt(1)
v_mfma_f32_16x16x32_bf16 v[48:51], v[52:55], v[16:19], v[48:51]
ds_read_b128 v[52:55], v2 offset:36864
v_add_f32_dpp v26, v31, v30 quad_perm:[2,2,2,2] row_mask:0xf bank_mask:0x2
v_add_f32_dpp v30, v41, v40 quad_perm:[1,1,1,1] row_mask:0xf bank_mask:0xf
v_add_f32_dpp v31, v43, v42 quad_perm:[3,3,3,3] row_mask:0xf bank_mask:0xf
v_mfma_f32_16x16x32_bf16 v[40:43], a[84:87], v[12:15], 0
v_mfma_f32_16x16x32_bf16 v[40:43], a[88:91], v[16:19], v[40:43]
v_add_f32_dpp v26, v31, v30 quad_perm:[2,2,2,2] row_mask:0xf bank_mask:0x4
v_add_f32_dpp v30, v45, v44 quad_perm:[1,1,1,1] row_mask:0xf bank_mask:0xf
v_add_f32_dpp v31, v47, v46 quad_perm:[3,3,3,3] row_mask:0xf bank_mask:0xf
v_mfma_f32_16x16x32_bf16 v[44:47], a[92:95], v[12:15], 0
s_waitcnt lgkmcnt(1)
v_mfma_f32_16x16x32_bf16 v[44:47], v[56:59], v[16:19], v[44:47]
ds_read_b128 v[56:59], v2 offset:37888
v_add_f32_dpp v26, v31, v30 quad_perm:[2,2,2,2] row_mask:0xf bank_mask:0x8
v_add_f32_dpp v30, v49, v48 quad_perm:[1,1,1,1] row_mask:0xf bank_mask:0xf
v_add_f32_dpp v31, v51, v50 quad_perm:[3,3,3,3] row_mask:0xf bank_mask:0xf
v_mfma_f32_16x16x32_bf16 v[48:51], a[96:99], v[12:15], 0
v_mfma_f32_16x16x32_bf16 v[48:51], a[100:103], v[16:19], v[48:51]
v_add_f32_dpp v27, v31, v30 quad_perm:[2,2,2,2] row_mask:0xf bank_mask:0x1
v_add_f32_dpp v30, v41, v40 quad_perm:[1,1,1,1] row_mask:0xf bank_mask:0xf
v_add_f32_dpp v31, v43, v42 quad_perm:[3,3,3,3] row_mask:0xf bank_mask:0xf
s_waitcnt vmcnt(8)
s_cmpk_gt_i32 s45, 2906
s_cbranch_scc1 L_pk_230
s_waitcnt vmcnt(5)
L_pk_230:
buffer_load_dwordx4 a[36:39], v0, s[8:11], s24 offen offset:2048 sc1 nt
v_mfma_f32_16x16x32_bf16 v[40:43], a[104:107], v[12:15], 0
s_waitcnt lgkmcnt(1)
v_mfma_f32_16x16x32_bf16 v[40:43], v[52:55], v[16:19], v[40:43]
ds_read_b128 v[52:55], v2 offset:38912
v_add_f32_dpp v27, v31, v30 quad_perm:[2,2,2,2] row_mask:0xf bank_mask:0x2
v_add_f32_dpp v30, v45, v44 quad_perm:[1,1,1,1] row_mask:0xf bank_mask:0xf
v_add_f32_dpp v31, v47, v46 quad_perm:[3,3,3,3] row_mask:0xf bank_mask:0xf
v_mfma_f32_16x16x32_bf16 v[44:47], a[108:111], v[12:15], 0
v_mfma_f32_16x16x32_bf16 v[44:47], a[112:115], v[16:19], v[44:47]
v_add_f32_dpp v27, v31, v30 quad_perm:[2,2,2,2] row_mask:0xf bank_mask:0x4
v_add_f32_dpp v30, v49, v48 quad_perm:[1,1,1,1] row_mask:0xf bank_mask:0xf
v_add_f32_dpp v31, v51, v50 quad_perm:[3,3,3,3] row_mask:0xf bank_mask:0xf
v_mfma_f32_16x16x32_bf16 v[48:51], a[116:119], v[12:15], 0
s_waitcnt lgkmcnt(1)
v_mfma_f32_16x16x32_bf16 v[48:51], v[56:59], v[16:19], v[48:51]
ds_read_b128 v[56:59], v2 offset:39936
v_add_f32_dpp v27, v31, v30 quad_perm:[2,2,2,2] row_mask:0xf bank_mask:0x8
v_add_f32_dpp v30, v41, v40 quad_perm:[1,1,1,1] row_mask:0xf bank_mask:0xf
v_add_f32_dpp v31, v43, v42 quad_perm:[3,3,3,3] row_mask:0xf bank_mask:0xf
v_mfma_f32_16x16x32_bf16 v[40:43], a[120:123], v[12:15], 0
v_mfma_f32_16x16x32_bf16 v[40:43], a[124:127], v[16:19], v[40:43]
v_add_f32_dpp v28, v31, v30 quad_perm:[2,2,2,2] row_mask:0xf bank_mask:0x1
v_add_f32_dpp v30, v45, v44 quad_perm:[1,1,1,1] row_mask:0xf bank_mask:0xf
v_add_f32_dpp v31, v47, v46 quad_perm:[3,3,3,3] row_mask:0xf bank_mask:0xf
s_waitcnt vmcnt(8)
s_cmpk_gt_i32 s45, 2956
s_cbranch_scc1 L_pk_231
s_waitcnt vmcnt(6)
L_pk_231:
buffer_load_dwordx4 a[40:43], v0, s[8:11], s24 offen offset:2304 sc1 nt
v_mfma_f32_16x16x32_bf16 v[44:47], a[128:131], v[12:15], 0
s_waitcnt lgkmcnt(1)
v_mfma_f32_16x16x32_bf16 v[44:47], v[52:55], v[16:19], v[44:47]
ds_read_b128 v[52:55], v2 offset:4096
v_add_f32_dpp v28, v31, v30 quad_perm:[2,2,2,2] row_mask:0xf bank_mask:0x2
v_add_f32_dpp v30, v49, v48 quad_perm:[1,1,1,1] row_mask:0xf bank_mask:0xf
v_add_f32_dpp v31, v51, v50 quad_perm:[3,3,3,3] row_mask:0xf bank_mask:0xf
v_mfma_f32_16x16x32_bf16 v[48:51], a[132:135], v[12:15], 0
v_mfma_f32_16x16x32_bf16 v[48:51], a[136:139], v[16:19], v[48:51]
v_add_f32_dpp v28, v31, v30 quad_perm:[2,2,2,2] row_mask:0xf bank_mask:0x4
v_add_f32_dpp v30, v41, v40 quad_perm:[1,1,1,1] row_mask:0xf bank_mask:0xf
v_add_f32_dpp v31, v43, v42 quad_perm:[3,3,3,3] row_mask:0xf bank_mask:0xf
v_mfma_f32_16x16x32_bf16 v[40:43], a[140:143], v[12:15], 0
s_waitcnt lgkmcnt(1)
v_mfma_f32_16x16x32_bf16 v[40:43], v[56:59], v[16:19], v[40:43]
v_add_f32_dpp v28, v31, v30 quad_perm:[2,2,2,2] row_mask:0xf bank_mask:0x8
v_add_f32_dpp v30, v45, v44 quad_perm:[1,1,1,1] row_mask:0xf bank_mask:0xf
v_add_f32_dpp v31, v47, v46 quad_perm:[3,3,3,3] row_mask:0xf bank_mask:0xf
s_nop 1
v_add_f32_dpp v29, v31, v30 quad_perm:[2,2,2,2] row_mask:0xf bank_mask:0x1
v_add_f32_dpp v30, v49, v48 quad_perm:[1,1,1,1] row_mask:0xf bank_mask:0xf
v_add_f32_dpp v31, v51, v50 quad_perm:[3,3,3,3] row_mask:0xf bank_mask:0xf
s_waitcnt vmcnt(8)
s_cmpk_gt_i32 s45, 2906
s_cbranch_scc1 L_pk_232
s_waitcnt vmcnt(5)
L_pk_232:
s_add_u32 s24, s24, 4096
buffer_load_dwordx4 a[44:47], v0, s[8:11], s24 offen offset:0 sc1 nt
v_add_f32_dpp v29, v31, v30 quad_perm:[2,2,2,2] row_mask:0xf bank_mask:0x2
v_add_f32_dpp v30, v41, v40 quad_perm:[1,1,1,1] row_mask:0xf bank_mask:0xf
v_add_f32_dpp v31, v43, v42 quad_perm:[3,3,3,3] row_mask:0xf bank_mask:0xf
v_add_f32 v30, s27, v30
s_nop 1
v_add_f32_dpp v29, v31, v30 quad_perm:[2,2,2,2] row_mask:0xf bank_mask:0x4
s_waitcnt vmcnt(8)
ds_read_b128 v[56:59], v2 offset:9216
s_cmpk_gt_i32 s45, 2956
s_cbranch_scc1 L_pk_233
s_waitcnt vmcnt(6)
L_pk_233:
s_add_u32 m0, s33, 31488
s_nop 0
buffer_load_dwordx4 v0, s[8:11], s24 offen offset:256 sc1 nt lds
v_mfma_f32_16x16x32_bf16 v[48:51], a[8:11], v[32:35], 0
v_mfma_f32_16x16x32_bf16 v[48:51], a[16:19], v[36:39], v[48:51]
v_mfma_f32_16x16x32_bf16 v[40:43], a[12:15], v[32:35], 0
v_mfma_f32_16x16x32_bf16 v[40:43], a[20:23], v[36:39], v[40:43]
s_waitcnt lgkmcnt(1)
v_mfma_f32_16x16x32_bf16 v[44:47], v[52:55], v[32:35], 0
ds_read_b128 v[52:55], v2 offset:10240
v_mfma_f32_16x16x32_bf16 v[44:47], a[24:27], v[36:39], v[44:47]
s_nop 1
v_add_f32_dpp v30, v49, v48 quad_perm:[1,1,1,1] row_mask:0xf bank_mask:0xf
v_add_f32_dpp v31, v51, v50 quad_perm:[3,3,3,3] row_mask:0xf bank_mask:0xf
s_waitcnt lgkmcnt(1)
v_mfma_f32_16x16x32_bf16 v[48:51], v[56:59], v[32:35], 0
ds_read_b128 v[56:59], v2 offset:11264
s_waitcnt vmcnt(8)
v_mfma_f32_16x16x32_bf16 v[48:51], a[28:31], v[36:39], v[48:51]
v_add_f32_dpp v23, v31, v30 quad_perm:[2,2,2,2] row_mask:0xf bank_mask:0x4
v_add_f32_dpp v30, v41, v40 quad_perm:[1,1,1,1] row_mask:0xf bank_mask:0xf
v_add_f32_dpp v31, v43, v42 quad_perm:[3,3,3,3] row_mask:0xf bank_mask:0xf
s_cmpk_gt_i32 s45, 2906
s_cbranch_scc1 L_pk_234
s_waitcnt vmcnt(5)
L_pk_234:
buffer_load_dwordx4 a[48:51], v0, s[8:11], s24 offen offset:2048 sc1 nt
s_waitcnt vmcnt(8)
s_cmpk_gt_i32 s45, 2956
s_cbranch_scc1 L_pk_235
s_waitcnt vmcnt(6)
L_pk_235:
buffer_load_dwordx4 a[52:55], v0, s[8:11], s24 offen offset:2304 sc1 nt
v_mfma_f32_16x16x32_bf16 v[40:43], v[176:179], v[32:35], 0
s_waitcnt vmcnt(8)
v_mfma_f32_16x16x32_bf16 v[40:43], v[180:183], v[36:39], v[40:43]
v_add_f32_dpp v23, v31, v30 quad_perm:[2,2,2,2] row_mask:0xf bank_mask:0x8
v_add_f32_dpp v30, v45, v44 quad_perm:[1,1,1,1] row_mask:0xf bank_mask:0xf
v_add_f32_dpp v31, v47, v46 quad_perm:[3,3,3,3] row_mask:0xf bank_mask:0xf
s_nop 1
v_add_f32_dpp v24, v31, v30 quad_perm:[2,2,2,2] row_mask:0xf bank_mask:0x1
v_add_f32_dpp v30, v49, v48 quad_perm:[1,1,1,1] row_mask:0xf bank_mask:0xf
v_add_f32_dpp v31, v51, v50 quad_perm:[3,3,3,3] row_mask:0xf bank_mask:0xf
s_nop 1
v_add_f32_dpp v24, v31, v30 quad_perm:[2,2,2,2] row_mask:0xf bank_mask:0x2
v_add_f32_dpp v30, v41, v40 quad_perm:[1,1,1,1] row_mask:0xf bank_mask:0xf
v_add_f32_dpp v31, v43, v42 quad_perm:[3,3,3,3] row_mask:0xf bank_mask:0xf
v_add_f32 v30, s27, v30
s_nop 1
v_add_f32_dpp v24, v31, v30 quad_perm:[2,2,2,2] row_mask:0xf bank_mask:0x4
v_max3_f32 v6, v20, v21, v22
v_max3_f32 v6, v6, v23, v24
s_nop 1
v_max_f32_dpp v6, v6, v6 row_ror:4 row_mask:0xf bank_mask:0xf
s_nop 1
v_max_f32_dpp v6, v6, v6 row_ror:8 row_mask:0xf bank_mask:0xf
v_mov_b32 v30, v6
s_nop 1
v_permlane16_swap_b32 v6, v30
v_max_f32 v6, v6, v30
v_mov_b32 v30, v6
s_nop 1
v_permlane32_swap_b32 v6, v30
v_max_f32 v6, v6, v30
v_mul_f32 v6, s35, v6
v_fma_f32 v20, v20, s35, -v6
v_fma_f32 v21, v21, s35, -v6
v_fma_f32 v22, v22, s35, -v6
v_fma_f32 v23, v23, s35, -v6
v_fma_f32 v24, v24, s35, -v6
v_exp_f32 v20, v20
v_exp_f32 v21, v21
v_exp_f32 v22, v22
v_exp_f32 v23, v23
v_exp_f32 v24, v24
v_add_f32 v7, v20, v21
v_cvt_pk_bf16_f32 v20, v20, v20
v_add_f32 v31, v22, v23
v_cvt_pk_bf16_f32 v21, v21, v21
v_add_f32 v7, v7, v24
v_cvt_pk_bf16_f32 v22, v22, v22
v_add_f32 v7, v7, v31
v_cvt_pk_bf16_f32 v23, v23, v23
v_cvt_pk_bf16_f32 v24, v24, v24
v_and_b32_dpp v40, v20, v8 row_newbcast:0 row_mask:0xf bank_mask:0xf
v_and_b32_dpp v41, v20, v9 row_newbcast:0 row_mask:0xf bank_mask:0xf
v_and_b32_dpp v42, v20, v10 row_newbcast:0 row_mask:0xf bank_mask:0xf
v_and_b32_dpp v43, v20, v11 row_newbcast:0 row_mask:0xf bank_mask:0xf
s_cmpk_gt_i32 s45, 2906
s_cbranch_scc1 L_pk_236
s_waitcnt vmcnt(5)
L_pk_236:
s_add_u32 s24, s24, 4096
buffer_load_dwordx4 a[56:59], v0, s[8:11], s24 offen offset:0 sc1 nt
v_and_b32_dpp v44, v20, v8 row_newbcast:4 row_mask:0xf bank_mask:0xf
v_and_b32_dpp v45, v20, v9 row_newbcast:4 row_mask:0xf bank_mask:0xf
v_mfma_f32_16x16x32_bf16 v[32:35], v[40:43], v[64:67], 0
v_and_b32_dpp v46, v20, v10 row_newbcast:4 row_mask:0xf bank_mask:0xf
v_and_b32_dpp v47, v20, v11 row_newbcast:4 row_mask:0xf bank_mask:0xf
s_waitcnt lgkmcnt(1)
v_mfma_f32_16x16x32_bf16 v[36:39], v[40:43], v[52:55], 0
ds_read_b128 v[52:55], v2 offset:12288
v_and_b32_dpp v40, v20, v8 row_newbcast:8 row_mask:0xf bank_mask:0xf
v_and_b32_dpp v41, v20, v9 row_newbcast:8 row_mask:0xf bank_mask:0xf
v_mfma_f32_16x16x32_bf16 v[32:35], v[44:47], v[68:71], v[32:35]
v_and_b32_dpp v42, v20, v10 row_newbcast:8 row_mask:0xf bank_mask:0xf
v_and_b32_dpp v43, v20, v11 row_newbcast:8 row_mask:0xf bank_mask:0xf
v_mfma_f32_16x16x32_bf16 v[36:39], v[44:47], v[72:75], v[36:39]
v_and_b32_dpp v44, v20, v8 row_newbcast:12 row_mask:0xf bank_mask:0xf
v_and_b32_dpp v45, v20, v9 row_newbcast:12 row_mask:0xf bank_mask:0xf
v_mfma_f32_16x16x32_bf16 v[32:35], v[40:43], v[76:79], v[32:35]
v_and_b32_dpp v46, v20, v10 row_newbcast:12 row_mask:0xf bank_mask:0xf
v_and_b32_dpp v47, v20, v11 row_newbcast:12 row_mask:0xf bank_mask:0xf
s_waitcnt lgkmcnt(1)
v_mfma_f32_16x16x32_bf16 v[36:39], v[40:43], v[56:59], v[36:39]
ds_read_b128 v[56:59], v2 offset:13312
v_and_b32_dpp v40, v21, v8 row_newbcast:0 row_mask:0xf bank_mask:0xf
v_and_b32_dpp v41, v21, v9 row_newbcast:0 row_mask:0xf bank_mask:0xf
v_mfma_f32_16x16x32_bf16 v[32:35], v[44:47], v[80:83], v[32:35]
v_and_b32_dpp v42, v21, v10 row_newbcast:0 row_mask:0xf bank_mask:0xf
v_and_b32_dpp v43, v21, v11 row_newbcast:0 row_mask:0xf bank_mask:0xf
v_mfma_f32_16x16x32_bf16 v[36:39], v[44:47], v[84:87], v[36:39]
v_and_b32_dpp v44, v21, v8 row_newbcast:4 row_mask:0xf bank_mask:0xf
v_and_b32_dpp v45, v21, v9 row_newbcast:4 row_mask:0xf bank_mask:0xf
v_mfma_f32_16x16x32_bf16 v[32:35], v[40:43], v[88:91], v[32:35]
v_and_b32_dpp v46, v21, v10 row_newbcast:4 row_mask:0xf bank_mask:0xf
v_and_b32_dpp v47, v21, v11 row_newbcast:4 row_mask:0xf bank_mask:0xf
s_waitcnt lgkmcnt(1)
v_mfma_f32_16x16x32_bf16 v[36:39], v[40:43], v[52:55], v[36:39]
ds_read_b128 v[52:55], v2 offset:14336
v_add_f32_dpp v7, v7, v7 row_ror:4 row_mask:0xf bank_mask:0xf
s_nop 1
v_add_f32_dpp v7, v7, v7 row_ror:8 row_mask:0xf bank_mask:0xf
v_mov_b32 v30, v7
s_nop 1
v_permlane16_swap_b32 v7, v30
v_add_f32 v7, v7, v30
v_mov_b32 v30, v7
s_nop 1
v_permlane32_swap_b32 v7, v30
v_add_f32 v7, v7, v30
s_waitcnt vmcnt(8)
s_cmpk_gt_i32 s45, 2956
s_cbranch_scc1 L_pk_237
s_waitcnt vmcnt(6)
L_pk_237:
s_add_u32 m0, s33, 32512
s_nop 0
buffer_load_dwordx4 v0, s[8:11], s24 offen offset:256 sc1 nt lds
v_and_b32_dpp v40, v21, v8 row_newbcast:8 row_mask:0xf bank_mask:0xf
v_and_b32_dpp v41, v21, v9 row_newbcast:8 row_mask:0xf bank_mask:0xf
v_mfma_f32_16x16x32_bf16 v[32:35], v[44:47], v[92:95], v[32:35]
v_and_b32_dpp v42, v21, v10 row_newbcast:8 row_mask:0xf bank_mask:0xf
v_and_b32_dpp v43, v21, v11 row_newbcast:8 row_mask:0xf bank_mask:0xf
v_mfma_f32_16x16x32_bf16 v[36:39], v[44:47], v[96:99], v[36:39]
v_and_b32_dpp v44, v21, v8 row_newbcast:12 row_mask:0xf bank_mask:0xf
v_and_b32_dpp v45, v21, v9 row_newbcast:12 row_mask:0xf bank_mask:0xf
v_mfma_f32_16x16x32_bf16 v[32:35], v[40:43], v[100:103], v[32:35]
v_and_b32_dpp v46, v21, v10 row_newbcast:12 row_mask:0xf bank_mask:0xf
v_and_b32_dpp v47, v21, v11 row_newbcast:12 row_mask:0xf bank_mask:0xf
s_waitcnt lgkmcnt(1)
v_mfma_f32_16x16x32_bf16 v[36:39], v[40:43], v[56:59], v[36:39]
ds_read_b128 v[56:59], v2 offset:15360
v_and_b32_dpp v40, v22, v8 row_newbcast:0 row_mask:0xf bank_mask:0xf
v_and_b32_dpp v41, v22, v9 row_newbcast:0 row_mask:0xf bank_mask:0xf
v_mfma_f32_16x16x32_bf16 v[32:35], v[44:47], v[104:107], v[32:35]
v_and_b32_dpp v42, v22, v10 row_newbcast:0 row_mask:0xf bank_mask:0xf
v_and_b32_dpp v43, v22, v11 row_newbcast:0 row_mask:0xf bank_mask:0xf
v_mfma_f32_16x16x32_bf16 v[36:39], v[44:47], v[108:111], v[36:39]
v_and_b32_dpp v44, v22, v8 row_newbcast:4 row_mask:0xf bank_mask:0xf
v_and_b32_dpp v45, v22, v9 row_newbcast:4 row_mask:0xf bank_mask:0xf
v_mfma_f32_16x16x32_bf16 v[32:35], v[40:43], v[112:115], v[32:35]
v_and_b32_dpp v46, v22, v10 row_newbcast:4 row_mask:0xf bank_mask:0xf
v_and_b32_dpp v47, v22, v11 row_newbcast:4 row_mask:0xf bank_mask:0xf
s_waitcnt lgkmcnt(1)
v_mfma_f32_16x16x32_bf16 v[36:39], v[40:43], v[52:55], v[36:39]
ds_read_b128 v[52:55], v2 offset:16384
v_and_b32_dpp v40, v22, v8 row_newbcast:8 row_mask:0xf bank_mask:0xf
v_and_b32_dpp v41, v22, v9 row_newbcast:8 row_mask:0xf bank_mask:0xf
v_mfma_f32_16x16x32_bf16 v[32:35], v[44:47], v[116:119], v[32:35]
v_and_b32_dpp v42, v22, v10 row_newbcast:8 row_mask:0xf bank_mask:0xf
v_and_b32_dpp v43, v22, v11 row_newbcast:8 row_mask:0xf bank_mask:0xf
v_mfma_f32_16x16x32_bf16 v[36:39], v[44:47], v[120:123], v[36:39]
s_waitcnt vmcnt(8)
s_cmpk_gt_i32 s45, 2906
s_cbranch_scc1 L_pk_238
s_waitcnt vmcnt(5)
L_pk_238:
buffer_load_dwordx4 a[60:63], v0, s[8:11], s24 offen offset:2048 sc1 nt
v_and_b32_dpp v44, v22, v8 row_newbcast:12 row_mask:0xf bank_mask:0xf
v_and_b32_dpp v45, v22, v9 row_newbcast:12 row_mask:0xf bank_mask:0xf
v_mfma_f32_16x16x32_bf16 v[32:35], v[40:43], v[124:127], v[32:35]
v_and_b32_dpp v46, v22, v10 row_newbcast:12 row_mask:0xf bank_mask:0xf
v_and_b32_dpp v47, v22, v11 row_newbcast:12 row_mask:0xf bank_mask:0xf
s_waitcnt lgkmcnt(1)
v_mfma_f32_16x16x32_bf16 v[36:39], v[40:43], v[56:59], v[36:39]
ds_read_b128 v[56:59], v2 offset:17408
v_and_b32_dpp v40, v23, v8 row_newbcast:0 row_mask:0xf bank_mask:0xf
v_and_b32_dpp v41, v23, v9 row_newbcast:0 row_mask:0xf bank_mask:0xf
v_mfma_f32_16x16x32_bf16 v[32:35], v[44:47], v[128:131], v[32:35]
v_and_b32_dpp v42, v23, v10 row_newbcast:0 row_mask:0xf bank_mask:0xf
v_and_b32_dpp v43, v23, v11 row_newbcast:0 row_mask:0xf bank_mask:0xf
v_mfma_f32_16x16x32_bf16 v[36:39], v[44:47], v[132:135], v[36:39]
v_and_b32_dpp v44, v23, v8 row_newbcast:4 row_mask:0xf bank_mask:0xf
v_and_b32_dpp v45, v23, v9 row_newbcast:4 row_mask:0xf bank_mask:0xf
v_mfma_f32_16x16x32_bf16 v[32:35], v[40:43], v[136:139], v[32:35]
v_and_b32_dpp v46, v23, v10 row_newbcast:4 row_mask:0xf bank_mask:0xf
v_and_b32_dpp v47, v23, v11 row_newbcast:4 row_mask:0xf bank_mask:0xf
s_waitcnt lgkmcnt(1)
v_mfma_f32_16x16x32_bf16 v[36:39], v[40:43], v[52:55], v[36:39]
ds_read_b128 v[52:55], v2 offset:18432
v_and_b32_dpp v40, v23, v8 row_newbcast:8 row_mask:0xf bank_mask:0xf
v_and_b32_dpp v41, v23, v9 row_newbcast:8 row_mask:0xf bank_mask:0xf
v_mfma_f32_16x16x32_bf16 v[32:35], v[44:47], v[140:143], v[32:35]
v_and_b32_dpp v42, v23, v10 row_newbcast:8 row_mask:0xf bank_mask:0xf
v_and_b32_dpp v43, v23, v11 row_newbcast:8 row_mask:0xf bank_mask:0xf
v_mfma_f32_16x16x32_bf16 v[36:39], v[44:47], v[144:147], v[36:39]
v_and_b32_dpp v44, v23, v8 row_newbcast:12 row_mask:0xf bank_mask:0xf
v_and_b32_dpp v45, v23, v9 row_newbcast:12 row_mask:0xf bank_mask:0xf
v_mfma_f32_16x16x32_bf16 v[32:35], v[40:43], v[148:151], v[32:35]
v_and_b32_dpp v46, v23, v10 row_newbcast:12 row_mask:0xf bank_mask:0xf
v_and_b32_dpp v47, v23, v11 row_newbcast:12 row_mask:0xf bank_mask:0xf
s_waitcnt lgkmcnt(1)
v_mfma_f32_16x16x32_bf16 v[36:39], v[40:43], v[56:59], v[36:39]
ds_read_b128 v[56:59], v2 offset:19456
s_waitcnt vmcnt(8)
s_cmpk_gt_i32 s45, 2956
s_cbranch_scc1 L_pk_239
s_waitcnt vmcnt(6)
L_pk_239:
buffer_load_dwordx4 a[64:67], v0, s[8:11], s24 offen offset:2304 sc1 nt
v_and_b32_dpp v40, v24, v8 row_newbcast:0 row_mask:0xf bank_mask:0xf
v_and_b32_dpp v41, v24, v9 row_newbcast:0 row_mask:0xf bank_mask:0xf
v_mfma_f32_16x16x32_bf16 v[32:35], v[44:47], v[152:155], v[32:35]
v_and_b32_dpp v42, v24, v10 row_newbcast:0 row_mask:0xf bank_mask:0xf
v_and_b32_dpp v43, v24, v11 row_newbcast:0 row_mask:0xf bank_mask:0xf
v_mfma_f32_16x16x32_bf16 v[36:39], v[44:47], v[156:159], v[36:39]
v_and_b32_dpp v44, v24, v8 row_newbcast:4 row_mask:0xf bank_mask:0xf
v_and_b32_dpp v45, v24, v9 row_newbcast:4 row_mask:0xf bank_mask:0xf
v_mfma_f32_16x16x32_bf16 v[32:35], v[40:43], v[160:163], v[32:35]
v_and_b32_dpp v46, v24, v10 row_newbcast:4 row_mask:0xf bank_mask:0xf
v_and_b32_dpp v47, v24, v11 row_newbcast:4 row_mask:0xf bank_mask:0xf
s_waitcnt lgkmcnt(1)
v_mfma_f32_16x16x32_bf16 v[36:39], v[40:43], v[52:55], v[36:39]
ds_read_b128 v[52:55], v2 offset:20480
v_and_b32_dpp v40, v24, v8 row_newbcast:8 row_mask:0xf bank_mask:0xf
v_and_b32_dpp v41, v24, v9 row_newbcast:8 row_mask:0xf bank_mask:0xf
v_mfma_f32_16x16x32_bf16 v[32:35], v[44:47], v[164:167], v[32:35]
v_and_b32_dpp v42, v24, v10 row_newbcast:8 row_mask:0xf bank_mask:0xf
v_and_b32_dpp v43, v24, v11 row_newbcast:8 row_mask:0xf bank_mask:0xf
v_mfma_f32_16x16x32_bf16 v[36:39], v[44:47], v[168:171], v[36:39]
s_nop 0
v_mfma_f32_16x16x32_bf16 v[32:35], v[40:43], v[172:175], v[32:35]
s_waitcnt lgkmcnt(1)
v_mfma_f32_16x16x32_bf16 v[36:39], v[40:43], v[56:59], v[36:39]
ds_read_b128 v[56:59], v2 offset:25600
s_nop 4
v_cvt_pk_bf16_f32 v32, v32, v33
v_cvt_pk_bf16_f32 v33, v34, v35
v_cvt_pk_bf16_f32 v34, v36, v37
v_cvt_pk_bf16_f32 v35, v38, v39
v_mov_b32_dpp v32, v6 quad_perm:[0,0,0,0] row_mask:0xc bank_mask:0xf
v_mov_b32_dpp v33, v7 quad_perm:[0,0,0,0] row_mask:0xc bank_mask:0xf
ds_write_b128 v2, v[32:35] offset:39936
v_subrev_u32 v24, s33, v2
v_lshrrev_b32 v60, 8, v24
v_mul_u32_u24 v60, 40704, v60
v_add_u32 v24, v24, v60
s_cmp_lg_u32 s3, 0
s_waitcnt lgkmcnt(0)
s_barrier
s_cbranch_scc1 L_np13
L_np13_e:
ds_read_b64 v[6:7], v24 offset:40448
ds_read_b128 v[32:35], v24 offset:39936
ds_read_b128 v[36:39], v24 offset:40192
s_waitcnt lgkmcnt(2)
v_mov_b32 v60, v6
v_mov_b32 v61, v6
s_nop 1
v_permlane16_swap_b32 v60, v61
v_max_f32 v60, v60, v61
v_mov_b32 v61, v60
s_nop 1
v_permlane32_swap_b32 v60, v61
v_max_f32 v24, v60, v61
v_sub_f32 v6, v6, v24
v_exp_f32 v6, v6
s_nop 0
v_cvt_pk_bf16_f32 v60, v6, v6
v_and_b32 v20, v60, v8
v_and_b32 v21, v60, v9
v_and_b32 v22, v60, v10
v_and_b32 v23, v60, v11
s_cmp_lg_u32 s37, 0
v_mul_f32 v7, v7, v6
v_mov_b32 v6, v7
s_waitcnt lgkmcnt(1)
v_mfma_f32_16x16x32_bf16 v[60:63], v[20:23], v[32:35], 0
s_waitcnt lgkmcnt(0)
v_mfma_f32_16x16x32_bf16 v[32:35], v[20:23], v[36:39], 0
v_permlane16_swap_b32 v7, v6
v_add_f32 v7, v7, v6
v_mov_b32 v6, v7
s_nop 1
v_permlane32_swap_b32 v7, v6
v_add_f32 v7, v7, v6
v_and_b32 v6, -2, v4
v_xor_b32 v4, 1, v4
v_cvt_pk_bf16_f32 v60, v60, v61
v_cvt_pk_bf16_f32 v61, v62, v63
v_cvt_pk_bf16_f32 v62, v32, v33
v_cvt_pk_bf16_f32 v63, v34, v35
v_mov_b32_dpp v60, v7 quad_perm:[0,1,2,3] row_mask:0xc bank_mask:0xf
v_mov_b32_dpp v61, v24 quad_perm:[0,1,2,3] row_mask:0xc bank_mask:0xf
v_bfi_b32 v60, 1, v4, v60
s_cbranch_scc1 L_np13_g
buffer_store_dwordx4 v[60:63], v6, s[16:19], s30 offen
s_nop 1
L_np13:
s_waitcnt vmcnt(8)
s_cmpk_gt_i32 s45, 2906
s_cbranch_scc1 L_pk_240
s_waitcnt vmcnt(5)
L_pk_240:
s_add_u32 s24, s24, 4096
buffer_load_dwordx4 a[68:71], v0, s[8:11], s24 offen offset:0 sc1 nt
v_max3_f32 v48, v25, v26, v27
v_max3_f32 v48, v48, v28, v29
s_nop 1
v_max_f32_dpp v48, v48, v48 row_ror:4 row_mask:0xf bank_mask:0xf
s_nop 1
v_max_f32_dpp v48, v48, v48 row_ror:8 row_mask:0xf bank_mask:0xf
v_mov_b32 v30, v48
s_nop 1
v_permlane16_swap_b32 v48, v30
v_max_f32 v48, v48, v30
v_mov_b32 v30, v48
s_nop 1
v_permlane32_swap_b32 v48, v30
v_max_f32 v48, v48, v30
v_mul_f32 v48, s35, v48
v_fma_f32 v25, v25, s35, -v48
v_fma_f32 v26, v26, s35, -v48
v_fma_f32 v27, v27, s35, -v48
v_fma_f32 v28, v28, s35, -v48
v_fma_f32 v29, v29, s35, -v48
v_exp_f32 v25, v25
v_exp_f32 v26, v26
v_exp_f32 v27, v27
v_exp_f32 v28, v28
v_exp_f32 v29, v29
v_add_f32 v49, v25, v26
v_cvt_pk_bf16_f32 v25, v25, v25
v_add_f32 v31, v27, v28
v_cvt_pk_bf16_f32 v26, v26, v26
v_add_f32 v49, v49, v29
v_cvt_pk_bf16_f32 v27, v27, v27
v_add_f32 v49, v49, v31
v_cvt_pk_bf16_f32 v28, v28, v28
v_cvt_pk_bf16_f32 v29, v29, v29
s_waitcnt vmcnt(8)
s_cmpk_gt_i32 s45, 2956
s_cbranch_scc1 L_pk_241
s_waitcnt vmcnt(6)
L_pk_241:
s_add_u32 m0, s33, 33536
s_nop 0
buffer_load_dwordx4 v0, s[8:11], s24 offen offset:256 sc1 nt lds
v_and_b32_dpp v12, v25, v8 row_newbcast:0 row_mask:0xf bank_mask:0xf
v_and_b32_dpp v13, v25, v9 row_newbcast:0 row_mask:0xf bank_mask:0xf
v_and_b32_dpp v14, v25, v10 row_newbcast:0 row_mask:0xf bank_mask:0xf
v_and_b32_dpp v15, v25, v11 row_newbcast:0 row_mask:0xf bank_mask:0xf
v_and_b32_dpp v16, v25, v8 row_newbcast:4 row_mask:0xf bank_mask:0xf
v_and_b32_dpp v17, v25, v9 row_newbcast:4 row_mask:0xf bank_mask:0xf
v_mfma_f32_16x16x32_bf16 v[40:43], v[12:15], v[52:55], 0
ds_read_b128 v[52:55], v2 offset:21504
v_and_b32_dpp v18, v25, v10 row_newbcast:4 row_mask:0xf bank_mask:0xf
v_and_b32_dpp v19, v25, v11 row_newbcast:4 row_mask:0xf bank_mask:0xf
v_mfma_f32_16x16x32_bf16 v[44:47], v[12:15], a[152:155], 0
v_and_b32_dpp v12, v25, v8 row_newbcast:8 row_mask:0xf bank_mask:0xf
v_and_b32_dpp v13, v25, v9 row_newbcast:8 row_mask:0xf bank_mask:0xf
v_mfma_f32_16x16x32_bf16 v[40:43], v[16:19], v[56:59], v[40:43]
ds_read_b128 v[56:59], v2 offset:26624
v_and_b32_dpp v14, v25, v10 row_newbcast:8 row_mask:0xf bank_mask:0xf
v_and_b32_dpp v15, v25, v11 row_newbcast:8 row_mask:0xf bank_mask:0xf
v_mfma_f32_16x16x32_bf16 v[44:47], v[16:19], a[156:159], v[44:47]
v_and_b32_dpp v16, v25, v8 row_newbcast:12 row_mask:0xf bank_mask:0xf
v_and_b32_dpp v17, v25, v9 row_newbcast:12 row_mask:0xf bank_mask:0xf
v_mfma_f32_16x16x32_bf16 v[40:43], v[12:15], a[160:163], v[40:43]
v_and_b32_dpp v18, v25, v10 row_newbcast:12 row_mask:0xf bank_mask:0xf
v_and_b32_dpp v19, v25, v11 row_newbcast:12 row_mask:0xf bank_mask:0xf
v_mfma_f32_16x16x32_bf16 v[44:47], v[12:15], a[168:171], v[44:47]
v_add_f32_dpp v49, v49, v49 row_ror:4 row_mask:0xf bank_mask:0xf
s_nop 1
v_add_f32_dpp v49, v49, v49 row_ror:8 row_mask:0xf bank_mask:0xf
v_mov_b32 v30, v49
s_nop 1
v_permlane16_swap_b32 v49, v30
v_add_f32 v49, v49, v30
v_mov_b32 v30, v49
s_nop 1
v_permlane32_swap_b32 v49, v30
v_add_f32 v49, v49, v30
s_waitcnt vmcnt(8)
s_cmpk_gt_i32 s45, 2906
s_cbranch_scc1 L_pk_242
s_waitcnt vmcnt(5)
L_pk_242:
buffer_load_dwordx4 a[72:75], v0, s[8:11], s24 offen offset:2048 sc1 nt
v_and_b32_dpp v12, v26, v8 row_newbcast:0 row_mask:0xf bank_mask:0xf
v_and_b32_dpp v13, v26, v9 row_newbcast:0 row_mask:0xf bank_mask:0xf
v_mfma_f32_16x16x32_bf16 v[40:43], v[16:19], a[164:167], v[40:43]
v_and_b32_dpp v14, v26, v10 row_newbcast:0 row_mask:0xf bank_mask:0xf
v_and_b32_dpp v15, v26, v11 row_newbcast:0 row_mask:0xf bank_mask:0xf
v_mfma_f32_16x16x32_bf16 v[44:47], v[16:19], a[172:175], v[44:47]
v_and_b32_dpp v16, v26, v8 row_newbcast:4 row_mask:0xf bank_mask:0xf
v_and_b32_dpp v17, v26, v9 row_newbcast:4 row_mask:0xf bank_mask:0xf
s_waitcnt lgkmcnt(1)
v_mfma_f32_16x16x32_bf16 v[40:43], v[12:15], v[52:55], v[40:43]
ds_read_b128 v[52:55], v2 offset:22528
v_and_b32_dpp v18, v26, v10 row_newbcast:4 row_mask:0xf bank_mask:0xf
v_and_b32_dpp v19, v26, v11 row_newbcast:4 row_mask:0xf bank_mask:0xf
v_mfma_f32_16x16x32_bf16 v[44:47], v[12:15], a[176:179], v[44:47]
v_and_b32_dpp v12, v26, v8 row_newbcast:8 row_mask:0xf bank_mask:0xf
v_and_b32_dpp v13, v26, v9 row_newbcast:8 row_mask:0xf bank_mask:0xf
s_waitcnt lgkmcnt(1)
v_mfma_f32_16x16x32_bf16 v[40:43], v[16:19], v[56:59], v[40:43]
ds_read_b128 v[56:59], v2 offset:27648
v_and_b32_dpp v14, v26, v10 row_newbcast:8 row_mask:0xf bank_mask:0xf
v_and_b32_dpp v15, v26, v11 row_newbcast:8 row_mask:0xf bank_mask:0xf
v_mfma_f32_16x16x32_bf16 v[44:47], v[16:19], a[180:183], v[44:47]
v_and_b32_dpp v16, v26, v8 row_newbcast:12 row_mask:0xf bank_mask:0xf
v_and_b32_dpp v17, v26, v9 row_newbcast:12 row_mask:0xf bank_mask:0xf
v_mfma_f32_16x16x32_bf16 v[40:43], v[12:15], a[184:187], v[40:43]
v_and_b32_dpp v18, v26, v10 row_newbcast:12 row_mask:0xf bank_mask:0xf
v_and_b32_dpp v19, v26, v11 row_newbcast:12 row_mask:0xf bank_mask:0xf
v_mfma_f32_16x16x32_bf16 v[44:47], v[12:15], a[192:195], v[44:47]
s_waitcnt vmcnt(8)
s_cmpk_gt_i32 s45, 2956
s_cbranch_scc1 L_pk_243
s_waitcnt vmcnt(6)
L_pk_243:
buffer_load_dwordx4 a[76:79], v0, s[8:11], s24 offen offset:2304 sc1 nt
v_and_b32_dpp v12, v27, v8 row_newbcast:0 row_mask:0xf bank_mask:0xf
v_and_b32_dpp v13, v27, v9 row_newbcast:0 row_mask:0xf bank_mask:0xf
v_mfma_f32_16x16x32_bf16 v[40:43], v[16:19], a[188:191], v[40:43]
v_and_b32_dpp v14, v27, v10 row_newbcast:0 row_mask:0xf bank_mask:0xf
v_and_b32_dpp v15, v27, v11 row_newbcast:0 row_mask:0xf bank_mask:0xf
v_mfma_f32_16x16x32_bf16 v[44:47], v[16:19], a[196:199], v[44:47]
v_and_b32_dpp v16, v27, v8 row_newbcast:4 row_mask:0xf bank_mask:0xf
v_and_b32_dpp v17, v27, v9 row_newbcast:4 row_mask:0xf bank_mask:0xf
s_waitcnt lgkmcnt(1)
v_mfma_f32_16x16x32_bf16 v[40:43], v[12:15], v[52:55], v[40:43]
ds_read_b128 v[52:55], v2 offset:23552
v_and_b32_dpp v18, v27, v10 row_newbcast:4 row_mask:0xf bank_mask:0xf
v_and_b32_dpp v19, v27, v11 row_newbcast:4 row_mask:0xf bank_mask:0xf
v_mfma_f32_16x16x32_bf16 v[44:47], v[12:15], a[200:203], v[44:47]
v_and_b32_dpp v12, v27, v8 row_newbcast:8 row_mask:0xf bank_mask:0xf
v_and_b32_dpp v13, v27, v9 row_newbcast:8 row_mask:0xf bank_mask:0xf
s_waitcnt lgkmcnt(1)
v_mfma_f32_16x16x32_bf16 v[40:43], v[16:19], v[56:59], v[40:43]
ds_read_b128 v[56:59], v2 offset:28672
v_and_b32_dpp v14, v27, v10 row_newbcast:8 row_mask:0xf bank_mask:0xf
v_and_b32_dpp v15, v27, v11 row_newbcast:8 row_mask:0xf bank_mask:0xf
v_mfma_f32_16x16x32_bf16 v[44:47], v[16:19], a[204:207], v[44:47]
v_and_b32_dpp v16, v27, v8 row_newbcast:12 row_mask:0xf bank_mask:0xf
v_and_b32_dpp v17, v27, v9 row_newbcast:12 row_mask:0xf bank_mask:0xf
v_mfma_f32_16x16x32_bf16 v[40:43], v[12:15], a[208:211], v[40:43]
v_and_b32_dpp v18, v27, v10 row_newbcast:12 row_mask:0xf bank_mask:0xf
v_and_b32_dpp v19, v27, v11 row_newbcast:12 row_mask:0xf bank_mask:0xf
v_mfma_f32_16x16x32_bf16 v[44:47], v[12:15], a[216:219], v[44:47]
s_memrealtime s[42:43]
s_waitcnt vmcnt(8)
s_waitcnt lgkmcnt(0)
s_sub_u32 s45, s42, s94
s_cmpk_gt_i32 s45, 3120
s_cbranch_scc1 L_pk_244
s_waitcnt vmcnt(5)
L_pk_244:
s_add_u32 s24, s24, 4096
buffer_load_dwordx4 a[80:83], v0, s[8:11], s24 offen offset:0 sc1 nt
v_and_b32_dpp v12, v28, v8 row_newbcast:0 row_mask:0xf bank_mask:0xf
v_and_b32_dpp v13, v28, v9 row_newbcast:0 row_mask:0xf bank_mask:0xf
v_mfma_f32_16x16x32_bf16 v[40:43], v[16:19], a[212:215], v[40:43]
v_and_b32_dpp v14, v28, v10 row_newbcast:0 row_mask:0xf bank_mask:0xf
v_and_b32_dpp v15, v28, v11 row_newbcast:0 row_mask:0xf bank_mask:0xf
v_mfma_f32_16x16x32_bf16 v[44:47], v[16:19], a[220:223], v[44:47]
v_and_b32_dpp v16, v28, v8 row_newbcast:4 row_mask:0xf bank_mask:0xf
v_and_b32_dpp v17, v28, v9 row_newbcast:4 row_mask:0xf bank_mask:0xf
v_mfma_f32_16x16x32_bf16 v[40:43], v[12:15], v[52:55], v[40:43]
ds_read_b128 v[52:55], v2 offset:24576
v_and_b32_dpp v18, v28, v10 row_newbcast:4 row_mask:0xf bank_mask:0xf
v_and_b32_dpp v19, v28, v11 row_newbcast:4 row_mask:0xf bank_mask:0xf
v_mfma_f32_16x16x32_bf16 v[44:47], v[12:15], a[224:227], v[44:47]
v_and_b32_dpp v12, v28, v8 row_newbcast:8 row_mask:0xf bank_mask:0xf
v_and_b32_dpp v13, v28, v9 row_newbcast:8 row_mask:0xf bank_mask:0xf
v_mfma_f32_16x16x32_bf16 v[40:43], v[16:19], v[56:59], v[40:43]
ds_read_b128 v[56:59], v2 offset:29696
v_and_b32_dpp v14, v28, v10 row_newbcast:8 row_mask:0xf bank_mask:0xf
v_and_b32_dpp v15, v28, v11 row_newbcast:8 row_mask:0xf bank_mask:0xf
v_mfma_f32_16x16x32_bf16 v[44:47], v[16:19], a[228:231], v[44:47]
v_and_b32_dpp v16, v28, v8 row_newbcast:12 row_mask:0xf bank_mask:0xf
v_and_b32_dpp v17, v28, v9 row_newbcast:12 row_mask:0xf bank_mask:0xf
v_mfma_f32_16x16x32_bf16 v[40:43], v[12:15], a[232:235], v[40:43]
v_and_b32_dpp v18, v28, v10 row_newbcast:12 row_mask:0xf bank_mask:0xf
v_and_b32_dpp v19, v28, v11 row_newbcast:12 row_mask:0xf bank_mask:0xf
v_mfma_f32_16x16x32_bf16 v[44:47], v[12:15], a[240:243], v[44:47]
s_waitcnt vmcnt(8)
s_cmpk_gt_i32 s45, 3170
s_cbranch_scc1 L_pk_245
s_waitcnt vmcnt(6)
L_pk_245:
s_add_u32 m0, s33, 34560
s_nop 0
buffer_load_dwordx4 v0, s[8:11], s24 offen offset:256 sc1 nt lds
v_and_b32_dpp v12, v29, v8 row_newbcast:0 row_mask:0xf bank_mask:0xf
v_and_b32_dpp v13, v29, v9 row_newbcast:0 row_mask:0xf bank_mask:0xf
v_mfma_f32_16x16x32_bf16 v[40:43], v[16:19], a[236:239], v[40:43]
v_and_b32_dpp v14, v29, v10 row_newbcast:0 row_mask:0xf bank_mask:0xf
v_and_b32_dpp v15, v29, v11 row_newbcast:0 row_mask:0xf bank_mask:0xf
v_mfma_f32_16x16x32_bf16 v[44:47], v[16:19], a[244:247], v[44:47]
v_and_b32_dpp v16, v29, v8 row_newbcast:4 row_mask:0xf bank_mask:0xf
v_and_b32_dpp v17, v29, v9 row_newbcast:4 row_mask:0xf bank_mask:0xf
s_waitcnt lgkmcnt(1)
v_mfma_f32_16x16x32_bf16 v[40:43], v[12:15], v[52:55], v[40:43]
ds_read_b128 v[52:55], v2 offset:30720
v_and_b32_dpp v18, v29, v10 row_newbcast:4 row_mask:0xf bank_mask:0xf
v_and_b32_dpp v19, v29, v11 row_newbcast:4 row_mask:0xf bank_mask:0xf
v_mfma_f32_16x16x32_bf16 v[44:47], v[12:15], a[248:251], v[44:47]
v_and_b32_dpp v12, v29, v8 row_newbcast:8 row_mask:0xf bank_mask:0xf
v_and_b32_dpp v13, v29, v9 row_newbcast:8 row_mask:0xf bank_mask:0xf
s_waitcnt lgkmcnt(1)
v_mfma_f32_16x16x32_bf16 v[40:43], v[16:19], v[56:59], v[40:43]
ds_read_b128 v[56:59], v2 offset:31744
v_and_b32_dpp v14, v29, v10 row_newbcast:8 row_mask:0xf bank_mask:0xf
v_and_b32_dpp v15, v29, v11 row_newbcast:8 row_mask:0xf bank_mask:0xf
v_mfma_f32_16x16x32_bf16 v[44:47], v[16:19], a[252:255], v[44:47]
s_nop 0
v_mfma_f32_16x16x32_bf16 v[40:43], v[12:15], a[144:147], v[40:43]
v_mfma_f32_16x16x32_bf16 v[44:47], v[12:15], a[148:151], v[44:47]
s_nop 6
v_cvt_pk_bf16_f32 v40, v40, v41
v_cvt_pk_bf16_f32 v41, v42, v43
v_cvt_pk_bf16_f32 v42, v44, v45
v_cvt_pk_bf16_f32 v43, v46, v47
v_mov_b32_dpp v40, v48 quad_perm:[0,0,0,0] row_mask:0xc bank_mask:0xf
v_mov_b32_dpp v41, v49 quad_perm:[0,0,0,0] row_mask:0xc bank_mask:0xf
ds_write_b128 v2, v[40:43] offset:38912
v_subrev_u32 v16, s33, v2
v_lshrrev_b32 v60, 8, v16
v_mul_u32_u24 v60, 40704, v60
v_add_u32 v16, v16, v60
s_cmp_lg_u32 s3, 1
s_waitcnt lgkmcnt(0)
s_barrier
s_cbranch_scc1 L_np23
L_np23_e:
ds_read_b64 v[48:49], v16 offset:39424
ds_read_b128 v[40:43], v16 offset:38912
ds_read_b128 v[44:47], v16 offset:39168
s_waitcnt lgkmcnt(2)
v_mov_b32 v60, v48
v_mov_b32 v61, v48
s_nop 1
v_permlane16_swap_b32 v60, v61
v_max_f32 v60, v60, v61
v_mov_b32 v61, v60
s_nop 1
v_permlane32_swap_b32 v60, v61
v_max_f32 v16, v60, v61
v_sub_f32 v48, v48, v16
v_exp_f32 v48, v48
s_nop 0
v_cvt_pk_bf16_f32 v60, v48, v48
v_and_b32 v12, v60, v8
v_and_b32 v13, v60, v9
v_and_b32 v14, v60, v10
v_and_b32 v15, v60, v11
s_cmp_lg_u32 s37, 0
v_mul_f32 v49, v49, v48
v_mov_b32 v48, v49
s_waitcnt lgkmcnt(1)
v_mfma_f32_16x16x32_bf16 v[60:63], v[12:15], v[40:43], 0
s_waitcnt lgkmcnt(0)
v_mfma_f32_16x16x32_bf16 v[40:43], v[12:15], v[44:47], 0
v_permlane16_swap_b32 v49, v48
v_add_f32 v49, v49, v48
v_mov_b32 v48, v49
s_nop 1
v_permlane32_swap_b32 v49, v48
v_add_f32 v49, v49, v48
v_and_b32 v48, -2, v4
v_xor_b32 v4, 1, v4
v_cvt_pk_bf16_f32 v60, v60, v61
v_cvt_pk_bf16_f32 v61, v62, v63
v_cvt_pk_bf16_f32 v62, v40, v41
v_cvt_pk_bf16_f32 v63, v42, v43
v_mov_b32_dpp v60, v49 quad_perm:[0,1,2,3] row_mask:0xc bank_mask:0xf
v_mov_b32_dpp v61, v16 quad_perm:[0,1,2,3] row_mask:0xc bank_mask:0xf
v_bfi_b32 v60, 1, v4, v60
s_cbranch_scc1 L_np23_g
buffer_store_dwordx4 v[60:63], v48, s[16:19], s31 offen
s_nop 1
L_np23:
s_memrealtime s[42:43]
s_waitcnt vmcnt(8)
s_waitcnt lgkmcnt(0)
s_sub_u32 s45, s42, s94
s_cmpk_gt_i32 s45, 3144
s_cbranch_scc1 L_pk_246
s_waitcnt vmcnt(5)
L_pk_246:
buffer_load_dwordx4 a[84:87], v0, s[8:11], s24 offen offset:2048 sc1 nt
s_waitcnt vmcnt(8)
s_cmpk_gt_i32 s45, 3194
s_cbranch_scc1 L_pk_247
s_waitcnt vmcnt(6)
L_pk_247:
buffer_load_dwordx4 a[88:91], v0, s[8:11], s24 offen offset:2304 sc1 nt
s_memrealtime s[42:43]
s_waitcnt vmcnt(8)
s_waitcnt lgkmcnt(0)
s_sub_u32 s45, s42, s94
s_cmpk_gt_i32 s45, 3168
s_cbranch_scc1 L_pk_248
s_waitcnt vmcnt(5)
L_pk_248:
s_add_u32 s24, s24, 4096
buffer_load_dwordx4 a[92:95], v0, s[8:11], s24 offen offset:0 sc1 nt
s_waitcnt vmcnt(8)
s_cmpk_gt_i32 s45, 3218
s_cbranch_scc1 L_pk_249
s_waitcnt vmcnt(6)
L_pk_249:
s_add_u32 m0, s33, 35584
s_nop 0
buffer_load_dwordx4 v0, s[8:11], s24 offen offset:256 sc1 nt lds
s_memrealtime s[42:43]
s_waitcnt vmcnt(8)
s_waitcnt lgkmcnt(0)
s_sub_u32 s45, s42, s94
s_cmpk_gt_i32 s45, 3191
s_cbranch_scc1 L_pk_250
s_waitcnt vmcnt(5)
L_pk_250:
buffer_load_dwordx4 a[96:99], v0, s[8:11], s24 offen offset:2048 sc1 nt
s_waitcnt vmcnt(8)
s_cmpk_gt_i32 s45, 3241
s_cbranch_scc1 L_pk_251
s_waitcnt vmcnt(6)
L_pk_251:
buffer_load_dwordx4 a[100:103], v0, s[8:11], s24 offen offset:2304 sc1 nt
s_memrealtime s[42:43]
s_waitcnt vmcnt(8)
s_waitcnt lgkmcnt(0)
s_sub_u32 s45, s42, s94
s_cmpk_gt_i32 s45, 3215
s_cbranch_scc1 L_pk_252
s_waitcnt vmcnt(5)
L_pk_252:
s_add_u32 s24, s24, 4096
buffer_load_dwordx4 a[104:107], v0, s[8:11], s24 offen offset:0 sc1 nt
s_barrier
s_waitcnt vmcnt(8)
s_cmpk_gt_i32 s45, 3265
s_cbranch_scc1 L_pk_253
s_waitcnt vmcnt(6)
L_pk_253:
s_add_u32 m0, s33, 36608
s_nop 0
buffer_load_dwordx4 v0, s[8:11], s24 offen offset:256 sc1 nt lds
s_memrealtime s[42:43]
s_waitcnt vmcnt(8)
s_waitcnt lgkmcnt(0)
s_sub_u32 s45, s42, s94
s_cmpk_gt_i32 s45, 3239
s_cbranch_scc1 L_pk_254
s_waitcnt vmcnt(5)
L_pk_254:
buffer_load_dwordx4 a[108:111], v0, s[8:11], s24 offen offset:2048 sc1 nt
s_waitcnt vmcnt(8)
s_cmpk_gt_i32 s45, 3289
s_cbranch_scc1 L_pk_255
s_waitcnt vmcnt(6)
L_pk_255:
buffer_load_dwordx4 a[112:115], v0, s[8:11], s24 offen offset:2304 sc1 nt
s_memrealtime s[42:43]
s_waitcnt vmcnt(8)
s_waitcnt lgkmcnt(0)
s_sub_u32 s45, s42, s94
s_cmpk_gt_i32 s45, 3263
s_cbranch_scc1 L_pk_256
s_waitcnt vmcnt(5)
L_pk_256:
s_add_u32 s24, s24, 4096
buffer_load_dwordx4 a[116:119], v0, s[8:11], s24 offen offset:0 sc1 nt
s_waitcnt vmcnt(8)
s_cmpk_gt_i32 s45, 3313
s_cbranch_scc1 L_pk_257
s_waitcnt vmcnt(6)
L_pk_257:
s_add_u32 m0, s33, 37632
s_nop 0
buffer_load_dwordx4 v0, s[8:11], s24 offen offset:256 sc1 nt lds
s_memrealtime s[42:43]
s_waitcnt vmcnt(8)
s_waitcnt lgkmcnt(0)
s_sub_u32 s45, s42, s94
s_cmpk_gt_i32 s45, 3286
s_cbranch_scc1 L_pk_258
s_waitcnt vmcnt(5)
L_pk_258:
buffer_load_dwordx4 a[120:123], v0, s[8:11], s24 offen offset:2048 sc1 nt
s_waitcnt vmcnt(8)
s_cmpk_gt_i32 s45, 3336
s_cbranch_scc1 L_pk_259
s_waitcnt vmcnt(6)
L_pk_259:
buffer_load_dwordx4 a[124:127], v0, s[8:11], s24 offen offset:2304 sc1 nt
s_memrealtime s[42:43]
s_waitcnt vmcnt(8)
s_waitcnt lgkmcnt(0)
s_sub_u32 s45, s42, s94
s_cmpk_gt_i32 s45, 3310
s_cbranch_scc1 L_pk_260
s_waitcnt vmcnt(5)
L_pk_260:
s_add_u32 s24, s24, 4096
buffer_load_dwordx4 a[128:131], v0, s[8:11], s24 offen offset:0 sc1 nt
s_waitcnt vmcnt(8)
s_cmpk_gt_i32 s45, 3360
s_cbranch_scc1 L_pk_261
s_waitcnt vmcnt(6)
L_pk_261:
s_add_u32 m0, s33, 38656
s_nop 0
buffer_load_dwordx4 v0, s[8:11], s24 offen offset:256 sc1 nt lds
s_memrealtime s[42:43]
s_waitcnt vmcnt(8)
s_waitcnt lgkmcnt(0)
s_sub_u32 s45, s42, s94
s_cmpk_gt_i32 s45, 3334
s_cbranch_scc1 L_pk_262
s_waitcnt vmcnt(5)
L_pk_262:
buffer_load_dwordx4 a[132:135], v0, s[8:11], s24 offen offset:2048 sc1 nt
s_waitcnt vmcnt(8)
s_cmpk_gt_i32 s45, 3384
s_cbranch_scc1 L_pk_263
s_waitcnt vmcnt(6)
L_pk_263:
buffer_load_dwordx4 a[136:139], v0, s[8:11], s24 offen offset:2304 sc1 nt
s_memrealtime s[42:43]
s_waitcnt vmcnt(8)
s_waitcnt lgkmcnt(0)
s_sub_u32 s45, s42, s94
s_cmpk_gt_i32 s45, 3358
s_cbranch_scc1 L_pk_264
s_waitcnt vmcnt(5)
L_pk_264:
s_add_u32 s24, s24, s26
buffer_load_dwordx4 a[140:143], v0, s[8:11], s24 offen offset:0 sc1 nt
s_waitcnt vmcnt(8)
s_cmpk_gt_i32 s45, 3408
s_cbranch_scc1 L_pk_265
s_waitcnt vmcnt(6)
L_pk_265:
s_add_u32 m0, s33, 39680
s_nop 0
buffer_load_dwordx4 v0, s[8:11], s24 offen offset:256 sc1 nt lds
s_memrealtime s[42:43]
s_waitcnt vmcnt(8)
s_waitcnt lgkmcnt(0)
s_sub_u32 s45, s42, s94
s_cmpk_gt_i32 s45, 3361
s_cbranch_scc1 L_pk_266
s_waitcnt vmcnt(4)
L_pk_266:
s_mov_b32 s24, 100663296
s_add_u32 m0, s33, 20480
s_nop 0
buffer_load_dwordx4 v1, s[12:15], s24 offen offset:0 sc1 nt lds
s_waitcnt vmcnt(8)
s_cmpk_gt_i32 s45, 3421
s_cbranch_scc1 L_pk_267
s_waitcnt vmcnt(5)
L_pk_267:
buffer_load_dwordx4 a[152:155], v1, s[12:15], s24 offen offset:256 sc1 nt
s_memrealtime s[42:43]
s_waitcnt vmcnt(8)
s_waitcnt lgkmcnt(0)
s_sub_u32 s45, s42, s94
s_cmpk_gt_i32 s45, 3385
s_cbranch_scc1 L_pk_268
s_waitcnt vmcnt(4)
L_pk_268:
s_add_u32 m0, s33, 23552
s_nop 0
buffer_load_dwordx4 v1, s[12:15], s24 offen offset:2048 sc1 nt lds
buffer_load_dwordx4 v[12:15], v3, s[16:19], s28 offen sc1
buffer_load_dwordx4 v[16:19], v3, s[16:19], s28 offen offset:256 sc1
s_waitcnt vmcnt(10)
s_cmpk_gt_i32 s45, 3445
s_cbranch_scc1 L_pk_269
s_waitcnt vmcnt(7)
L_pk_269:
buffer_load_dwordx4 a[156:159], v1, s[12:15], s24 offen offset:2304 sc1 nt
s_memrealtime s[42:43]
s_waitcnt vmcnt(10)
s_waitcnt lgkmcnt(0)
s_sub_u32 s45, s42, s94
s_cmpk_gt_i32 s45, 3409
s_cbranch_scc1 L_pk_270
s_waitcnt vmcnt(6)
L_pk_270:
s_add_u32 s24, s24, 4096
buffer_load_dwordx4 a[160:163], v1, s[12:15], s24 offen offset:0 sc1 nt
s_waitcnt vmcnt(10)
s_cmpk_gt_i32 s45, 3469
s_cbranch_scc1 L_pk_271
s_waitcnt vmcnt(7)
L_pk_271:
buffer_load_dwordx4 a[168:171], v1, s[12:15], s24 offen offset:256 sc1 nt
s_memrealtime s[42:43]
s_waitcnt vmcnt(10)
s_waitcnt lgkmcnt(0)
s_sub_u32 s45, s42, s94
s_cmpk_gt_i32 s45, 3433
s_cbranch_scc1 L_pk_272
s_waitcnt vmcnt(6)
L_pk_272:
buffer_load_dwordx4 a[164:167], v1, s[12:15], s24 offen offset:2048 sc1 nt
s_waitcnt vmcnt(10)
s_cmpk_gt_i32 s45, 3493
s_cbranch_scc1 L_pk_273
s_waitcnt vmcnt(7)
L_pk_273:
buffer_load_dwordx4 a[172:175], v1, s[12:15], s24 offen offset:2304 sc1 nt
s_memrealtime s[42:43]
s_waitcnt vmcnt(10)
s_waitcnt lgkmcnt(0)
s_sub_u32 s45, s42, s94
s_cmpk_gt_i32 s45, 3456
s_cbranch_scc1 L_pk_274
s_waitcnt vmcnt(4)
L_pk_274:
s_add_u32 s24, s24, 4096
s_add_u32 m0, s33, 21504
s_nop 0
buffer_load_dwordx4 v1, s[12:15], s24 offen offset:0 sc1 nt lds
s_waitcnt vmcnt(10)
s_cmpk_gt_i32 s45, 3516
s_cbranch_scc1 L_pk_275
s_waitcnt vmcnt(5)
L_pk_275:
buffer_load_dwordx4 a[176:179], v1, s[12:15], s24 offen offset:256 sc1 nt
s_memrealtime s[42:43]
s_waitcnt vmcnt(10)
s_waitcnt lgkmcnt(0)
s_sub_u32 s45, s42, s94
s_cmpk_gt_i32 s45, 3480
s_cbranch_scc1 L_pk_276
s_waitcnt vmcnt(4)
L_pk_276:
s_add_u32 m0, s33, 24576
s_nop 0
buffer_load_dwordx4 v1, s[12:15], s24 offen offset:2048 sc1 nt lds
s_waitcnt vmcnt(10)
s_cmpk_gt_i32 s45, 3540
s_cbranch_scc1 L_pk_277
s_waitcnt vmcnt(5)
L_pk_277:
buffer_load_dwordx4 a[180:183], v1, s[12:15], s24 offen offset:2304 sc1 nt
s_waitcnt vmcnt(9)
v_max_u32 v30, v12, v16
v_cmp_eq_u32 vcc, -1, v30
s_cbranch_vccnz L_q13_s
L_q13_r:
v_mfma_f32_16x16x32_bf16 v[40:43], a[32:35], v[12:15], 0
v_mfma_f32_16x16x32_bf16 v[40:43], v[52:55], v[16:19], v[40:43]
ds_read_b128 v[52:55], v2 offset:32768
v_mfma_f32_16x16x32_bf16 v[44:47], a[36:39], v[12:15], 0
v_mfma_f32_16x16x32_bf16 v[44:47], a[40:43], v[16:19], v[44:47]
v_mfma_f32_16x16x32_bf16 v[48:51], a[44:47], v[12:15], 0
v_mfma_f32_16x16x32_bf16 v[48:51], v[56:59], v[16:19], v[48:51]
ds_read_b128 v[56:59], v2 offset:33792
v_mov_b32 v24, 0xff800000
s_nop 0
v_add_f32_dpp v30, v41, v40 quad_perm:[1,1,1,1] row_mask:0xf bank_mask:0xf
v_add_f32_dpp v31, v43, v42 quad_perm:[3,3,3,3] row_mask:0xf bank_mask:0xf
v_mfma_f32_16x16x32_bf16 v[40:43], a[48:51], v[12:15], 0
v_mfma_f32_16x16x32_bf16 v[40:43], a[52:55], v[16:19], v[40:43]
v_add_f32_dpp v20, v31, v30 quad_perm:[2,2,2,2] row_mask:0xf bank_mask:0x1
v_add_f32_dpp v30, v45, v44 quad_perm:[1,1,1,1] row_mask:0xf bank_mask:0xf
v_add_f32_dpp v31, v47, v46 quad_perm:[3,3,3,3] row_mask:0xf bank_mask:0xf
s_memrealtime s[42:43]
s_waitcnt vmcnt(8)
s_waitcnt lgkmcnt(0)
s_sub_u32 s45, s42, s94
s_cmpk_gt_i32 s45, 3524
s_cbranch_scc1 L_pk_278
s_waitcnt vmcnt(5)
L_pk_278:
s_add_u32 s24, s24, 4096
buffer_load_dwordx4 a[184:187], v1, s[12:15], s24 offen offset:0 sc1 nt
v_mfma_f32_16x16x32_bf16 v[44:47], a[56:59], v[12:15], 0
v_mfma_f32_16x16x32_bf16 v[44:47], v[52:55], v[16:19], v[44:47]
ds_read_b128 v[52:55], v2 offset:34816
v_add_f32_dpp v20, v31, v30 quad_perm:[2,2,2,2] row_mask:0xf bank_mask:0x2
v_add_f32_dpp v30, v49, v48 quad_perm:[1,1,1,1] row_mask:0xf bank_mask:0xf
v_add_f32_dpp v31, v51, v50 quad_perm:[3,3,3,3] row_mask:0xf bank_mask:0xf
v_mfma_f32_16x16x32_bf16 v[48:51], a[60:63], v[12:15], 0
v_mfma_f32_16x16x32_bf16 v[48:51], a[64:67], v[16:19], v[48:51]
v_add_f32_dpp v20, v31, v30 quad_perm:[2,2,2,2] row_mask:0xf bank_mask:0x4
v_add_f32_dpp v30, v41, v40 quad_perm:[1,1,1,1] row_mask:0xf bank_mask:0xf
v_add_f32_dpp v31, v43, v42 quad_perm:[3,3,3,3] row_mask:0xf bank_mask:0xf
v_mfma_f32_16x16x32_bf16 v[40:43], a[68:71], v[12:15], 0
v_mfma_f32_16x16x32_bf16 v[40:43], v[56:59], v[16:19], v[40:43]
ds_read_b128 v[56:59], v2 offset:35840
v_add_f32_dpp v20, v31, v30 quad_perm:[2,2,2,2] row_mask:0xf bank_mask:0x8
v_add_f32_dpp v30, v45, v44 quad_perm:[1,1,1,1] row_mask:0xf bank_mask:0xf
v_add_f32_dpp v31, v47, v46 quad_perm:[3,3,3,3] row_mask:0xf bank_mask:0xf
v_mfma_f32_16x16x32_bf16 v[44:47], a[72:75], v[12:15], 0
v_mfma_f32_16x16x32_bf16 v[44:47], a[76:79], v[16:19], v[44:47]
v_add_f32_dpp v21, v31, v30 quad_perm:[2,2,2,2] row_mask:0xf bank_mask:0x1
v_add_f32_dpp v30, v49, v48 quad_perm:[1,1,1,1] row_mask:0xf bank_mask:0xf
v_add_f32_dpp v31, v51, v50 quad_perm:[3,3,3,3] row_mask:0xf bank_mask:0xf
s_waitcnt vmcnt(8)
s_cmpk_gt_i32 s45, 3574
s_cbranch_scc1 L_pk_279
s_waitcnt vmcnt(6)
L_pk_279:
buffer_load_dwordx4 a[192:195], v1, s[12:15], s24 offen offset:256 sc1 nt
v_mfma_f32_16x16x32_bf16 v[48:51], a[80:83], v[12:15], 0
s_waitcnt lgkmcnt(1)
v_mfma_f32_16x16x32_bf16 v[48:51], v[52:55], v[16:19], v[48:51]
ds_read_b128 v[52:55], v2 offset:36864
v_add_f32_dpp v21, v31, v30 quad_perm:[2,2,2,2] row_mask:0xf bank_mask:0x2
v_add_f32_dpp v30, v41, v40 quad_perm:[1,1,1,1] row_mask:0xf bank_mask:0xf
v_add_f32_dpp v31, v43, v42 quad_perm:[3,3,3,3] row_mask:0xf bank_mask:0xf
v_mfma_f32_16x16x32_bf16 v[40:43], a[84:87], v[12:15], 0
v_mfma_f32_16x16x32_bf16 v[40:43], a[88:91], v[16:19], v[40:43]
v_add_f32_dpp v21, v31, v30 quad_perm:[2,2,2,2] row_mask:0xf bank_mask:0x4
v_add_f32_dpp v30, v45, v44 quad_perm:[1,1,1,1] row_mask:0xf bank_mask:0xf
v_add_f32_dpp v31, v47, v46 quad_perm:[3,3,3,3] row_mask:0xf bank_mask:0xf
v_mfma_f32_16x16x32_bf16 v[44:47], a[92:95], v[12:15], 0
s_waitcnt lgkmcnt(1)
v_mfma_f32_16x16x32_bf16 v[44:47], v[56:59], v[16:19], v[44:47]
ds_read_b128 v[56:59], v2 offset:37888
v_add_f32_dpp v21, v31, v30 quad_perm:[2,2,2,2] row_mask:0xf bank_mask:0x8
v_add_f32_dpp v30, v49, v48 quad_perm:[1,1,1,1] row_mask:0xf bank_mask:0xf
v_add_f32_dpp v31, v51, v50 quad_perm:[3,3,3,3] row_mask:0xf bank_mask:0xf
v_mfma_f32_16x16x32_bf16 v[48:51], a[96:99], v[12:15], 0
v_mfma_f32_16x16x32_bf16 v[48:51], a[100:103], v[16:19], v[48:51]
v_add_f32_dpp v22, v31, v30 quad_perm:[2,2,2,2] row_mask:0xf bank_mask:0x1
v_add_f32_dpp v30, v41, v40 quad_perm:[1,1,1,1] row_mask:0xf bank_mask:0xf
v_add_f32_dpp v31, v43, v42 quad_perm:[3,3,3,3] row_mask:0xf bank_mask:0xf
s_memrealtime s[42:43]
s_waitcnt vmcnt(8)
s_waitcnt lgkmcnt(0)
s_sub_u32 s45, s42, s94
s_cmpk_gt_i32 s45, 3548
s_cbranch_scc1 L_pk_280
s_waitcnt vmcnt(5)
L_pk_280:
buffer_load_dwordx4 a[188:191], v1, s[12:15], s24 offen offset:2048 sc1 nt
v_mfma_f32_16x16x32_bf16 v[40:43], a[104:107], v[12:15], 0
v_mfma_f32_16x16x32_bf16 v[40:43], v[52:55], v[16:19], v[40:43]
ds_read_b128 v[52:55], v2 offset:38912
v_add_f32_dpp v22, v31, v30 quad_perm:[2,2,2,2] row_mask:0xf bank_mask:0x2
v_add_f32_dpp v30, v45, v44 quad_perm:[1,1,1,1] row_mask:0xf bank_mask:0xf
v_add_f32_dpp v31, v47, v46 quad_perm:[3,3,3,3] row_mask:0xf bank_mask:0xf
v_mfma_f32_16x16x32_bf16 v[44:47], a[108:111], v[12:15], 0
v_mfma_f32_16x16x32_bf16 v[44:47], a[112:115], v[16:19], v[44:47]
v_add_f32_dpp v22, v31, v30 quad_perm:[2,2,2,2] row_mask:0xf bank_mask:0x4
v_add_f32_dpp v30, v49, v48 quad_perm:[1,1,1,1] row_mask:0xf bank_mask:0xf
v_add_f32_dpp v31, v51, v50 quad_perm:[3,3,3,3] row_mask:0xf bank_mask:0xf
v_mfma_f32_16x16x32_bf16 v[48:51], a[116:119], v[12:15], 0
v_mfma_f32_16x16x32_bf16 v[48:51], v[56:59], v[16:19], v[48:51]
ds_read_b128 v[56:59], v2 offset:39936
v_add_f32_dpp v22, v31, v30 quad_perm:[2,2,2,2] row_mask:0xf bank_mask:0x8
v_add_f32_dpp v30, v41, v40 quad_perm:[1,1,1,1] row_mask:0xf bank_mask:0xf
v_add_f32_dpp v31, v43, v42 quad_perm:[3,3,3,3] row_mask:0xf bank_mask:0xf
v_mfma_f32_16x16x32_bf16 v[40:43], a[120:123], v[12:15], 0
v_mfma_f32_16x16x32_bf16 v[40:43], a[124:127], v[16:19], v[40:43]
v_add_f32_dpp v23, v31, v30 quad_perm:[2,2,2,2] row_mask:0xf bank_mask:0x1
v_add_f32_dpp v30, v45, v44 quad_perm:[1,1,1,1] row_mask:0xf bank_mask:0xf
v_add_f32_dpp v31, v47, v46 quad_perm:[3,3,3,3] row_mask:0xf bank_mask:0xf
s_waitcnt vmcnt(8)
s_cmpk_gt_i32 s45, 3598
s_cbranch_scc1 L_pk_281
s_waitcnt vmcnt(6)
L_pk_281:
buffer_load_dwordx4 a[196:199], v1, s[12:15], s24 offen offset:2304 sc1 nt
v_mfma_f32_16x16x32_bf16 v[44:47], a[128:131], v[12:15], 0
s_waitcnt lgkmcnt(1)
v_mfma_f32_16x16x32_bf16 v[44:47], v[52:55], v[16:19], v[44:47]
ds_read_b128 v[52:55], v2 offset:20480
v_add_f32_dpp v23, v31, v30 quad_perm:[2,2,2,2] row_mask:0xf bank_mask:0x2
v_add_f32_dpp v30, v49, v48 quad_perm:[1,1,1,1] row_mask:0xf bank_mask:0xf
v_add_f32_dpp v31, v51, v50 quad_perm:[3,3,3,3] row_mask:0xf bank_mask:0xf
v_mfma_f32_16x16x32_bf16 v[48:51], a[132:135], v[12:15], 0
v_mfma_f32_16x16x32_bf16 v[48:51], a[136:139], v[16:19], v[48:51]
v_add_f32_dpp v23, v31, v30 quad_perm:[2,2,2,2] row_mask:0xf bank_mask:0x4
v_add_f32_dpp v30, v41, v40 quad_perm:[1,1,1,1] row_mask:0xf bank_mask:0xf
v_add_f32_dpp v31, v43, v42 quad_perm:[3,3,3,3] row_mask:0xf bank_mask:0xf
v_mfma_f32_16x16x32_bf16 v[40:43], a[140:143], v[12:15], 0
s_waitcnt lgkmcnt(1)
v_mfma_f32_16x16x32_bf16 v[40:43], v[56:59], v[16:19], v[40:43]
ds_read_b128 v[56:59], v2 offset:25600
v_add_f32_dpp v23, v31, v30 quad_perm:[2,2,2,2] row_mask:0xf bank_mask:0x8
v_add_f32_dpp v30, v45, v44 quad_perm:[1,1,1,1] row_mask:0xf bank_mask:0xf
v_add_f32_dpp v31, v47, v46 quad_perm:[3,3,3,3] row_mask:0xf bank_mask:0xf
s_nop 1
v_add_f32_dpp v24, v31, v30 quad_perm:[2,2,2,2] row_mask:0xf bank_mask:0x1
v_add_f32_dpp v30, v49, v48 quad_perm:[1,1,1,1] row_mask:0xf bank_mask:0xf
v_add_f32_dpp v31, v51, v50 quad_perm:[3,3,3,3] row_mask:0xf bank_mask:0xf
s_memrealtime s[42:43]
s_waitcnt vmcnt(8)
s_waitcnt lgkmcnt(0)
s_sub_u32 s45, s42, s94
s_cmpk_gt_i32 s45, 3571
s_cbranch_scc1 L_pk_282
s_waitcnt vmcnt(5)
L_pk_282:
s_add_u32 s24, s24, 4096
s_add_u32 m0, s33, 22528
s_nop 0
buffer_load_dwordx4 v1, s[12:15], s24 offen offset:0 sc1 nt lds
v_add_f32_dpp v24, v31, v30 quad_perm:[2,2,2,2] row_mask:0xf bank_mask:0x2
v_add_f32_dpp v30, v41, v40 quad_perm:[1,1,1,1] row_mask:0xf bank_mask:0xf
v_add_f32_dpp v31, v43, v42 quad_perm:[3,3,3,3] row_mask:0xf bank_mask:0xf
v_add_f32 v30, s27, v30
s_nop 1
v_add_f32_dpp v24, v31, v30 quad_perm:[2,2,2,2] row_mask:0xf bank_mask:0x4
s_waitcnt vmcnt(8)
s_cmpk_gt_i32 s45, 3621
s_cbranch_scc1 L_pk_283
s_waitcnt vmcnt(6)
L_pk_283:
buffer_load_dwordx4 a[200:203], v1, s[12:15], s24 offen offset:256 sc1 nt
v_max3_f32 v6, v20, v21, v22
v_max3_f32 v6, v6, v23, v24
s_nop 1
v_max_f32_dpp v6, v6, v6 row_ror:4 row_mask:0xf bank_mask:0xf
s_nop 1
v_max_f32_dpp v6, v6, v6 row_ror:8 row_mask:0xf bank_mask:0xf
v_mov_b32 v30, v6
s_nop 1
v_permlane16_swap_b32 v6, v30
v_max_f32 v6, v6, v30
v_mov_b32 v30, v6
s_nop 1
v_permlane32_swap_b32 v6, v30
v_max_f32 v6, v6, v30
v_mul_f32 v6, s35, v6
v_fma_f32 v20, v20, s35, -v6
v_fma_f32 v21, v21, s35, -v6
v_fma_f32 v22, v22, s35, -v6
v_fma_f32 v23, v23, s35, -v6
v_fma_f32 v24, v24, s35, -v6
v_exp_f32 v20, v20
v_exp_f32 v21, v21
v_exp_f32 v22, v22
v_exp_f32 v23, v23
v_exp_f32 v24, v24
v_add_f32 v7, v20, v21
v_cvt_pk_bf16_f32 v20, v20, v20
v_add_f32 v31, v22, v23
v_cvt_pk_bf16_f32 v21, v21, v21
v_add_f32 v7, v7, v24
v_cvt_pk_bf16_f32 v22, v22, v22
v_add_f32 v7, v7, v31
v_cvt_pk_bf16_f32 v23, v23, v23
v_cvt_pk_bf16_f32 v24, v24, v24
v_add_f32_dpp v7, v7, v7 row_ror:4 row_mask:0xf bank_mask:0xf
s_nop 1
v_add_f32_dpp v7, v7, v7 row_ror:8 row_mask:0xf bank_mask:0xf
v_mov_b32 v30, v7
s_nop 1
v_permlane16_swap_b32 v7, v30
v_add_f32 v7, v7, v30
v_mov_b32 v30, v7
s_nop 1
v_permlane32_swap_b32 v7, v30
v_add_f32 v7, v7, v30
v_and_b32_dpp v40, v20, v8 row_newbcast:0 row_mask:0xf bank_mask:0xf
v_and_b32_dpp v41, v20, v9 row_newbcast:0 row_mask:0xf bank_mask:0xf
v_and_b32_dpp v42, v20, v10 row_newbcast:0 row_mask:0xf bank_mask:0xf
v_and_b32_dpp v43, v20, v11 row_newbcast:0 row_mask:0xf bank_mask:0xf
s_memrealtime s[42:43]
s_waitcnt vmcnt(8)
s_waitcnt lgkmcnt(0)
s_sub_u32 s45, s42, s94
s_cmpk_gt_i32 s45, 3595
s_cbranch_scc1 L_pk_284
s_waitcnt vmcnt(5)
L_pk_284:
s_add_u32 m0, s33, 25600
s_nop 0
buffer_load_dwordx4 v1, s[12:15], s24 offen offset:2048 sc1 nt lds
v_and_b32_dpp v44, v20, v8 row_newbcast:4 row_mask:0xf bank_mask:0xf
v_and_b32_dpp v45, v20, v9 row_newbcast:4 row_mask:0xf bank_mask:0xf
v_mfma_f32_16x16x32_bf16 v[32:35], v[40:43], v[52:55], 0
ds_read_b128 v[52:55], v2 offset:21504
v_and_b32_dpp v46, v20, v10 row_newbcast:4 row_mask:0xf bank_mask:0xf
v_and_b32_dpp v47, v20, v11 row_newbcast:4 row_mask:0xf bank_mask:0xf
v_mfma_f32_16x16x32_bf16 v[36:39], v[40:43], a[152:155], 0
v_and_b32_dpp v40, v20, v8 row_newbcast:8 row_mask:0xf bank_mask:0xf
v_and_b32_dpp v41, v20, v9 row_newbcast:8 row_mask:0xf bank_mask:0xf
v_mfma_f32_16x16x32_bf16 v[32:35], v[44:47], v[56:59], v[32:35]
v_and_b32_dpp v42, v20, v10 row_newbcast:8 row_mask:0xf bank_mask:0xf
v_and_b32_dpp v43, v20, v11 row_newbcast:8 row_mask:0xf bank_mask:0xf
v_mfma_f32_16x16x32_bf16 v[36:39], v[44:47], a[156:159], v[36:39]
v_and_b32_dpp v44, v20, v8 row_newbcast:12 row_mask:0xf bank_mask:0xf
v_and_b32_dpp v45, v20, v9 row_newbcast:12 row_mask:0xf bank_mask:0xf
v_mfma_f32_16x16x32_bf16 v[32:35], v[40:43], a[160:163], v[32:35]
v_and_b32_dpp v46, v20, v10 row_newbcast:12 row_mask:0xf bank_mask:0xf
v_and_b32_dpp v47, v20, v11 row_newbcast:12 row_mask:0xf bank_mask:0xf
v_mfma_f32_16x16x32_bf16 v[36:39], v[40:43], a[168:171], v[36:39]
v_and_b32_dpp v40, v21, v8 row_newbcast:0 row_mask:0xf bank_mask:0xf
v_and_b32_dpp v41, v21, v9 row_newbcast:0 row_mask:0xf bank_mask:0xf
v_mfma_f32_16x16x32_bf16 v[32:35], v[44:47], a[164:167], v[32:35]
v_and_b32_dpp v42, v21, v10 row_newbcast:0 row_mask:0xf bank_mask:0xf
v_and_b32_dpp v43, v21, v11 row_newbcast:0 row_mask:0xf bank_mask:0xf
v_mfma_f32_16x16x32_bf16 v[36:39], v[44:47], a[172:175], v[36:39]
s_waitcnt vmcnt(8)
ds_read_b128 v[56:59], v2 offset:26624
s_cmpk_gt_i32 s45, 3645
s_cbranch_scc1 L_pk_285
s_waitcnt vmcnt(6)
L_pk_285:
buffer_load_dwordx4 a[204:207], v1, s[12:15], s24 offen offset:2304 sc1 nt
v_and_b32_dpp v44, v21, v8 row_newbcast:4 row_mask:0xf bank_mask:0xf
v_and_b32_dpp v45, v21, v9 row_newbcast:4 row_mask:0xf bank_mask:0xf
s_waitcnt lgkmcnt(1)
v_mfma_f32_16x16x32_bf16 v[32:35], v[40:43], v[52:55], v[32:35]
v_and_b32_dpp v46, v21, v10 row_newbcast:4 row_mask:0xf bank_mask:0xf
v_and_b32_dpp v47, v21, v11 row_newbcast:4 row_mask:0xf bank_mask:0xf
v_mfma_f32_16x16x32_bf16 v[36:39], v[40:43], a[176:179], v[36:39]
s_memrealtime s[42:43]
s_waitcnt vmcnt(8)
s_waitcnt lgkmcnt(0)
s_sub_u32 s45, s42, s94
s_cmpk_gt_i32 s45, 3619
s_cbranch_scc1 L_pk_286
s_waitcnt vmcnt(5)
L_pk_286:
s_add_u32 s24, s24, 4096
buffer_load_dwordx4 a[208:211], v1, s[12:15], s24 offen offset:0 sc1 nt
v_and_b32_dpp v40, v21, v8 row_newbcast:8 row_mask:0xf bank_mask:0xf
v_and_b32_dpp v41, v21, v9 row_newbcast:8 row_mask:0xf bank_mask:0xf
v_mfma_f32_16x16x32_bf16 v[32:35], v[44:47], v[56:59], v[32:35]
v_and_b32_dpp v42, v21, v10 row_newbcast:8 row_mask:0xf bank_mask:0xf
v_and_b32_dpp v43, v21, v11 row_newbcast:8 row_mask:0xf bank_mask:0xf
v_mfma_f32_16x16x32_bf16 v[36:39], v[44:47], a[180:183], v[36:39]
s_waitcnt vmcnt(8)
s_cmpk_gt_i32 s45, 3669
s_cbranch_scc1 L_pk_287
s_waitcnt vmcnt(6)
L_pk_287:
buffer_load_dwordx4 a[216:219], v1, s[12:15], s24 offen offset:256 sc1 nt
s_memrealtime s[42:43]
s_waitcnt vmcnt(8)
s_waitcnt lgkmcnt(0)
s_sub_u32 s45, s42, s94
s_cmpk_gt_i32 s45, 3643
s_cbranch_scc1 L_pk_288
s_waitcnt vmcnt(5)
L_pk_288:
buffer_load_dwordx4 a[212:215], v1, s[12:15], s24 offen offset:2048 sc1 nt
v_and_b32_dpp v44, v21, v8 row_newbcast:12 row_mask:0xf bank_mask:0xf
v_and_b32_dpp v45, v21, v9 row_newbcast:12 row_mask:0xf bank_mask:0xf
v_mfma_f32_16x16x32_bf16 v[32:35], v[40:43], a[184:187], v[32:35]
v_and_b32_dpp v46, v21, v10 row_newbcast:12 row_mask:0xf bank_mask:0xf
v_and_b32_dpp v47, v21, v11 row_newbcast:12 row_mask:0xf bank_mask:0xf
v_mfma_f32_16x16x32_bf16 v[36:39], v[40:43], a[192:195], v[36:39]
s_waitcnt vmcnt(8)
s_cmpk_gt_i32 s45, 3693
s_cbranch_scc1 L_pk_289
s_waitcnt vmcnt(6)
L_pk_289:
buffer_load_dwordx4 a[220:223], v1, s[12:15], s24 offen offset:2304 sc1 nt
s_memrealtime s[42:43]
s_waitcnt vmcnt(8)
s_waitcnt lgkmcnt(0)
s_sub_u32 s45, s42, s94
s_cmpk_gt_i32 s45, 3666
s_cbranch_scc1 L_pk_290
s_waitcnt vmcnt(5)
L_pk_290:
s_add_u32 s24, s24, 4096
s_add_u32 m0, s33, 23552
s_nop 0
buffer_load_dwordx4 v1, s[12:15], s24 offen offset:0 sc1 nt lds
v_and_b32_dpp v40, v22, v8 row_newbcast:0 row_mask:0xf bank_mask:0xf
v_and_b32_dpp v41, v22, v9 row_newbcast:0 row_mask:0xf bank_mask:0xf
v_mfma_f32_16x16x32_bf16 v[32:35], v[44:47], a[188:191], v[32:35]
v_and_b32_dpp v42, v22, v10 row_newbcast:0 row_mask:0xf bank_mask:0xf
v_and_b32_dpp v43, v22, v11 row_newbcast:0 row_mask:0xf bank_mask:0xf
v_mfma_f32_16x16x32_bf16 v[36:39], v[44:47], a[196:199], v[36:39]
s_waitcnt vmcnt(8)
ds_read_b128 v[52:55], v2 offset:22528
s_cmpk_gt_i32 s45, 3716
s_cbranch_scc1 L_pk_291
s_waitcnt vmcnt(6)
L_pk_291:
buffer_load_dwordx4 a[224:227], v1, s[12:15], s24 offen offset:256 sc1 nt
s_memrealtime s[42:43]
s_waitcnt vmcnt(8)
s_waitcnt lgkmcnt(0)
s_sub_u32 s45, s42, s94
s_cmpk_gt_i32 s45, 3690
s_cbranch_scc1 L_pk_292
s_waitcnt vmcnt(5)
L_pk_292:
s_add_u32 m0, s33, 26624
s_nop 0
buffer_load_dwordx4 v1, s[12:15], s24 offen offset:2048 sc1 nt lds
v_and_b32_dpp v44, v22, v8 row_newbcast:4 row_mask:0xf bank_mask:0xf
v_and_b32_dpp v45, v22, v9 row_newbcast:4 row_mask:0xf bank_mask:0xf
v_mfma_f32_16x16x32_bf16 v[32:35], v[40:43], v[52:55], v[32:35]
v_and_b32_dpp v46, v22, v10 row_newbcast:4 row_mask:0xf bank_mask:0xf
v_and_b32_dpp v47, v22, v11 row_newbcast:4 row_mask:0xf bank_mask:0xf
v_mfma_f32_16x16x32_bf16 v[36:39], v[40:43], a[200:203], v[36:39]
s_waitcnt vmcnt(8)
ds_read_b128 v[56:59], v2 offset:27648
s_cmpk_gt_i32 s45, 3740
s_cbranch_scc1 L_pk_293
s_waitcnt vmcnt(6)
L_pk_293:
buffer_load_dwordx4 a[228:231], v1, s[12:15], s24 offen offset:2304 sc1 nt
s_memrealtime s[42:43]
s_waitcnt vmcnt(8)
s_waitcnt lgkmcnt(0)
s_sub_u32 s45, s42, s94
s_cmpk_gt_i32 s45, 3714
s_cbranch_scc1 L_pk_294
s_waitcnt vmcnt(5)
L_pk_294:
s_add_u32 s24, s24, 4096
buffer_load_dwordx4 a[232:235], v1, s[12:15], s24 offen offset:0 sc1 nt
buffer_load_dwordx4 v[12:15], v3, s[16:19], s29 offen sc1
buffer_load_dwordx4 v[16:19], v3, s[16:19], s29 offen offset:256 sc1
v_and_b32_dpp v40, v22, v8 row_newbcast:8 row_mask:0xf bank_mask:0xf
v_and_b32_dpp v41, v22, v9 row_newbcast:8 row_mask:0xf bank_mask:0xf
v_mfma_f32_16x16x32_bf16 v[32:35], v[44:47], v[56:59], v[32:35]
v_and_b32_dpp v42, v22, v10 row_newbcast:8 row_mask:0xf bank_mask:0xf
v_and_b32_dpp v43, v22, v11 row_newbcast:8 row_mask:0xf bank_mask:0xf
v_mfma_f32_16x16x32_bf16 v[36:39], v[44:47], a[204:207], v[36:39]
s_waitcnt vmcnt(10)
s_cmpk_gt_i32 s45, 3764
s_cbranch_scc1 L_pk_295
s_waitcnt vmcnt(8)
L_pk_295:
buffer_load_dwordx4 a[240:243], v1, s[12:15], s24 offen offset:256 sc1 nt
s_memrealtime s[42:43]
s_waitcnt vmcnt(10)
s_waitcnt lgkmcnt(0)
s_sub_u32 s45, s42, s94
s_cmpk_gt_i32 s45, 3738
s_cbranch_scc1 L_pk_296
s_waitcnt vmcnt(7)
L_pk_296:
buffer_load_dwordx4 a[236:239], v1, s[12:15], s24 offen offset:2048 sc1 nt
v_and_b32_dpp v44, v22, v8 row_newbcast:12 row_mask:0xf bank_mask:0xf
v_and_b32_dpp v45, v22, v9 row_newbcast:12 row_mask:0xf bank_mask:0xf
v_mfma_f32_16x16x32_bf16 v[32:35], v[40:43], a[208:211], v[32:35]
v_and_b32_dpp v46, v22, v10 row_newbcast:12 row_mask:0xf bank_mask:0xf
v_and_b32_dpp v47, v22, v11 row_newbcast:12 row_mask:0xf bank_mask:0xf
v_mfma_f32_16x16x32_bf16 v[36:39], v[40:43], a[216:219], v[36:39]
s_waitcnt vmcnt(10)
s_cmpk_gt_i32 s45, 3788
s_cbranch_scc1 L_pk_297
s_waitcnt vmcnt(8)
L_pk_297:
buffer_load_dwordx4 a[244:247], v1, s[12:15], s24 offen offset:2304 sc1 nt
s_memrealtime s[42:43]
s_waitcnt vmcnt(10)
s_waitcnt lgkmcnt(0)
s_sub_u32 s45, s42, s94
s_cmpk_gt_i32 s45, 3761
s_cbranch_scc1 L_pk_298
s_waitcnt vmcnt(7)
L_pk_298:
s_add_u32 s24, s24, 4096
s_add_u32 m0, s33, 24576
s_nop 0
buffer_load_dwordx4 v1, s[12:15], s24 offen offset:0 sc1 nt lds
v_and_b32_dpp v40, v23, v8 row_newbcast:0 row_mask:0xf bank_mask:0xf
v_and_b32_dpp v41, v23, v9 row_newbcast:0 row_mask:0xf bank_mask:0xf
v_mfma_f32_16x16x32_bf16 v[32:35], v[44:47], a[212:215], v[32:35]
v_and_b32_dpp v42, v23, v10 row_newbcast:0 row_mask:0xf bank_mask:0xf
v_and_b32_dpp v43, v23, v11 row_newbcast:0 row_mask:0xf bank_mask:0xf
v_mfma_f32_16x16x32_bf16 v[36:39], v[44:47], a[220:223], v[36:39]
s_waitcnt vmcnt(10)
ds_read_b128 v[52:55], v2 offset:23552
s_cmpk_gt_i32 s45, 3811
s_cbranch_scc1 L_pk_299
s_waitcnt vmcnt(8)
L_pk_299:
s_add_u32 m0, s33, 27648
s_nop 0
buffer_load_dwordx4 v1, s[12:15], s24 offen offset:2048 sc1 nt lds
s_memrealtime s[42:43]
s_waitcnt vmcnt(10)
s_waitcnt lgkmcnt(0)
s_sub_u32 s45, s42, s94
s_cmpk_gt_i32 s45, 3785
s_cbranch_scc1 L_pk_300
s_waitcnt vmcnt(7)
L_pk_300:
buffer_load_dwordx4 a[248:251], v1, s[12:15], s24 offen offset:256 sc1 nt
v_and_b32_dpp v44, v23, v8 row_newbcast:4 row_mask:0xf bank_mask:0xf
v_and_b32_dpp v45, v23, v9 row_newbcast:4 row_mask:0xf bank_mask:0xf
v_mfma_f32_16x16x32_bf16 v[32:35], v[40:43], v[52:55], v[32:35]
v_and_b32_dpp v46, v23, v10 row_newbcast:4 row_mask:0xf bank_mask:0xf
v_and_b32_dpp v47, v23, v11 row_newbcast:4 row_mask:0xf bank_mask:0xf
v_mfma_f32_16x16x32_bf16 v[36:39], v[40:43], a[224:227], v[36:39]
s_waitcnt vmcnt(10)
ds_read_b128 v[56:59], v2 offset:28672
s_cmpk_gt_i32 s45, 3835
s_cbranch_scc1 L_pk_301
s_waitcnt vmcnt(8)
L_pk_301:
buffer_load_dwordx4 a[252:255], v1, s[12:15], s24 offen offset:2304 sc1 nt
s_memrealtime s[42:43]
s_waitcnt vmcnt(10)
s_waitcnt lgkmcnt(0)
s_sub_u32 s45, s42, s94
s_cmpk_gt_i32 s45, 3809
s_cbranch_scc1 L_pk_302
s_waitcnt vmcnt(5)
L_pk_302:
s_add_u32 s24, s24, s26
buffer_load_dwordx4 a[144:147], v1, s[12:15], s24 offen offset:0 sc1 nt
v_mfma_f32_16x16x32_bf16 v[32:35], v[44:47], v[56:59], v[32:35]
v_mfma_f32_16x16x32_bf16 v[36:39], v[44:47], a[228:231], v[36:39]
s_waitcnt vmcnt(10)
s_cmpk_gt_i32 s45, 3859
s_cbranch_scc1 L_pk_303
s_waitcnt vmcnt(6)
L_pk_303:
buffer_load_dwordx4 a[148:151], v1, s[12:15], s24 offen offset:256 sc1 nt
L_final:
ds_read_b128 v[56:59], v2 offset:9216
s_waitcnt vmcnt(9)
v_max_u32 v30, v12, v16
v_cmp_eq_u32 vcc, -1, v30
s_cbranch_vccnz L_q2f_s
L_q2f_r:
v_mov_b32_dpp v60, v6 quad_perm:[0,0,0,0] row_mask:0xf bank_mask:0xf
v_mov_b32_dpp v61, v7 quad_perm:[0,0,0,0] row_mask:0xf bank_mask:0xf
ds_write_b64 v2, v[60:61] offset:9216
v_subrev_u32 v25, s33, v2
v_lshrrev_b32 v62, 8, v25
v_mul_u32_u24 v62, 40704, v62
v_add_u32 v25, v25, v62
s_cmp_eq_u32 s3, 0
s_cselect_b32 s45, s30, 1073741824
v_and_b32 v30, -2, v4
s_waitcnt lgkmcnt(0)
s_barrier
ds_read_b64 v[6:7], v25 offset:9728
s_waitcnt lgkmcnt(0)
v_mov_b32 v62, v6
v_mov_b32 v63, v6
s_nop 1
v_permlane16_swap_b32 v62, v63
v_max_f32 v62, v62, v63
v_mov_b32 v63, v62
s_nop 1
v_permlane32_swap_b32 v62, v63
v_max_f32 v61, v62, v63
v_sub_f32 v6, v6, v61
v_exp_f32 v6, v6
v_xor_b32 v63, 1, v4
v_cvt_pk_bf16_f32 v62, v6, v6
v_mul_f32 v7, v7, v6
v_mov_b32 v6, v7
v_and_b32 v26, v62, v8
v_and_b32 v27, v62, v9
v_permlane16_swap_b32 v7, v6
v_add_f32 v7, v7, v6
v_mov_b32 v6, v7
v_and_b32 v28, v62, v10
v_and_b32 v29, v62, v11
v_permlane32_swap_b32 v7, v6
v_add_f32 v7, v7, v6
s_cmp_lg_u32 s37, 0
v_bfi_b32 v60, 1, v63, v7
s_mov_b32 exec_lo, 0
s_cbranch_scc1 L_npe1_g
buffer_store_dwordx4 v[60:63], v30, s[16:19], s45 offen
s_nop 1
L_npe1:
s_mov_b32 exec_lo, -1
v_and_b32_dpp v40, v23, v8 row_newbcast:8 row_mask:0xf bank_mask:0xf
v_and_b32_dpp v41, v23, v9 row_newbcast:8 row_mask:0xf bank_mask:0xf
v_and_b32_dpp v42, v23, v10 row_newbcast:8 row_mask:0xf bank_mask:0xf
v_and_b32_dpp v43, v23, v11 row_newbcast:8 row_mask:0xf bank_mask:0xf
v_and_b32_dpp v44, v23, v8 row_newbcast:12 row_mask:0xf bank_mask:0xf
v_and_b32_dpp v45, v23, v9 row_newbcast:12 row_mask:0xf bank_mask:0xf
v_mfma_f32_16x16x32_bf16 v[32:35], v[40:43], a[232:235], v[32:35]
v_and_b32_dpp v46, v23, v10 row_newbcast:12 row_mask:0xf bank_mask:0xf
v_and_b32_dpp v47, v23, v11 row_newbcast:12 row_mask:0xf bank_mask:0xf
s_waitcnt vmcnt(9)
v_mfma_f32_16x16x32_bf16 v[36:39], v[40:43], a[240:243], v[36:39]
v_and_b32_dpp v40, v24, v8 row_newbcast:0 row_mask:0xf bank_mask:0xf
v_and_b32_dpp v41, v24, v9 row_newbcast:0 row_mask:0xf bank_mask:0xf
s_waitcnt vmcnt(8)
v_mfma_f32_16x16x32_bf16 v[32:35], v[44:47], a[236:239], v[32:35]
s_waitcnt vmcnt(6)
ds_read_b128 v[52:55], v2 offset:24576
v_and_b32_dpp v42, v24, v10 row_newbcast:0 row_mask:0xf bank_mask:0xf
v_and_b32_dpp v43, v24, v11 row_newbcast:0 row_mask:0xf bank_mask:0xf
v_mfma_f32_16x16x32_bf16 v[36:39], v[44:47], a[244:247], v[36:39]
v_and_b32_dpp v44, v24, v8 row_newbcast:4 row_mask:0xf bank_mask:0xf
v_and_b32_dpp v45, v24, v9 row_newbcast:4 row_mask:0xf bank_mask:0xf
s_waitcnt lgkmcnt(0)
v_mfma_f32_16x16x32_bf16 v[32:35], v[40:43], v[52:55], v[32:35]
s_waitcnt vmcnt(5)
ds_read_b128 v[48:51], v2 offset:29696
v_and_b32_dpp v46, v24, v10 row_newbcast:4 row_mask:0xf bank_mask:0xf
v_and_b32_dpp v47, v24, v11 row_newbcast:4 row_mask:0xf bank_mask:0xf
s_waitcnt vmcnt(4)
v_mfma_f32_16x16x32_bf16 v[36:39], v[40:43], a[248:251], v[36:39]
v_and_b32_dpp v40, v24, v8 row_newbcast:8 row_mask:0xf bank_mask:0xf
v_and_b32_dpp v41, v24, v9 row_newbcast:8 row_mask:0xf bank_mask:0xf
s_waitcnt lgkmcnt(0)
v_mfma_f32_16x16x32_bf16 v[32:35], v[44:47], v[48:51], v[32:35]
v_and_b32_dpp v42, v24, v10 row_newbcast:8 row_mask:0xf bank_mask:0xf
v_and_b32_dpp v43, v24, v11 row_newbcast:8 row_mask:0xf bank_mask:0xf
s_waitcnt vmcnt(3)
v_mfma_f32_16x16x32_bf16 v[36:39], v[44:47], a[252:255], v[36:39]
s_waitcnt vmcnt(2)
v_mfma_f32_16x16x32_bf16 v[32:35], v[40:43], a[144:147], v[32:35]
s_waitcnt vmcnt(1)
v_mfma_f32_16x16x32_bf16 v[36:39], v[40:43], a[148:151], v[36:39]
s_mov_b32 exec_hi, 0
s_nop 4
v_cvt_pk_bf16_f32 v32, v32, v33
v_cvt_pk_bf16_f32 v33, v34, v35
v_cvt_pk_bf16_f32 v34, v36, v37
v_cvt_pk_bf16_f32 v35, v38, v39
ds_write_b128 v2, v[32:35] offset:9216
s_mov_b32 exec_hi, -1
s_cmp_lg_u32 s3, 0
s_waitcnt lgkmcnt(0)
s_barrier
s_cbranch_scc1 L_npf1
ds_read_b128 v[32:35], v25 offset:9216
ds_read_b128 v[36:39], v25 offset:9472
v_xor_b32 v4, 1, v4
s_cmp_lg_u32 s37, 0
s_waitcnt lgkmcnt(1)
v_mfma_f32_16x16x32_bf16 v[60:63], v[26:29], v[32:35], 0
s_waitcnt lgkmcnt(0)
v_mfma_f32_16x16x32_bf16 v[32:35], v[26:29], v[36:39], 0
s_mov_b32 exec_hi, 0
s_nop 4
v_cvt_pk_bf16_f32 v60, v60, v61
v_cvt_pk_bf16_f32 v61, v62, v63
v_bfi_b32 v60, 1, v4, v60
v_cvt_pk_bf16_f32 v62, v32, v33
v_cvt_pk_bf16_f32 v63, v34, v35
s_cbranch_scc1 L_npf1_g
buffer_store_dwordx4 v[60:63], v30, s[16:19], s30 offen
s_nop 1
L_npf1:
s_mov_b32 exec_hi, -1
v_lshrrev_b32 v0, 2, v2
s_cmp_lg_u32 s3, 0
s_cbranch_scc1 L_nmk
ds_write_b32 v0, v4 offset:9216
L_nmk:
s_add_u32 s29, s29, 8192
ds_read_b128 v[52:55], v2 offset:0
ds_read_b128 v[60:63], v2 offset:5120
s_waitcnt lgkmcnt(1)
v_mfma_f32_16x16x32_bf16 v[40:43], v[52:55], v[12:15], 0
ds_read_b128 v[52:55], v2 offset:1024
v_mfma_f32_16x16x32_bf16 v[40:43], v[184:187], v[16:19], v[40:43]
s_waitcnt lgkmcnt(1)
v_mfma_f32_16x16x32_bf16 v[44:47], v[60:63], v[12:15], 0
ds_read_b128 v[60:63], v2 offset:6144
v_mfma_f32_16x16x32_bf16 v[44:47], v[188:191], v[16:19], v[44:47]
v_mfma_f32_16x16x32_bf16 v[48:51], v[192:195], v[12:15], 0
v_mfma_f32_16x16x32_bf16 v[48:51], v[200:203], v[16:19], v[48:51]
v_mov_b32 v29, 0xff800000
s_nop 0
v_add_f32_dpp v30, v41, v40 quad_perm:[1,1,1,1] row_mask:0xf bank_mask:0xf
v_add_f32_dpp v31, v43, v42 quad_perm:[3,3,3,3] row_mask:0xf bank_mask:0xf
v_mfma_f32_16x16x32_bf16 v[40:43], v[196:199], v[12:15], 0
v_mfma_f32_16x16x32_bf16 v[40:43], v[204:207], v[16:19], v[40:43]
v_add_f32_dpp v25, v31, v30 quad_perm:[2,2,2,2] row_mask:0xf bank_mask:0x1
v_add_f32_dpp v30, v45, v44 quad_perm:[1,1,1,1] row_mask:0xf bank_mask:0xf
v_add_f32_dpp v31, v47, v46 quad_perm:[3,3,3,3] row_mask:0xf bank_mask:0xf
s_waitcnt lgkmcnt(1)
v_mfma_f32_16x16x32_bf16 v[44:47], v[52:55], v[12:15], 0
ds_read_b128 v[52:55], v2 offset:2048
v_mfma_f32_16x16x32_bf16 v[44:47], v[208:211], v[16:19], v[44:47]
v_add_f32_dpp v25, v31, v30 quad_perm:[2,2,2,2] row_mask:0xf bank_mask:0x2
v_add_f32_dpp v30, v49, v48 quad_perm:[1,1,1,1] row_mask:0xf bank_mask:0xf
v_add_f32_dpp v31, v51, v50 quad_perm:[3,3,3,3] row_mask:0xf bank_mask:0xf
s_waitcnt lgkmcnt(1)
v_mfma_f32_16x16x32_bf16 v[48:51], v[60:63], v[12:15], 0
ds_read_b128 v[60:63], v2 offset:7168
v_mfma_f32_16x16x32_bf16 v[48:51], v[212:215], v[16:19], v[48:51]
v_add_f32_dpp v25, v31, v30 quad_perm:[2,2,2,2] row_mask:0xf bank_mask:0x4
v_add_f32_dpp v30, v41, v40 quad_perm:[1,1,1,1] row_mask:0xf bank_mask:0xf
v_add_f32_dpp v31, v43, v42 quad_perm:[3,3,3,3] row_mask:0xf bank_mask:0xf
v_mfma_f32_16x16x32_bf16 v[40:43], v[216:219], v[12:15], 0
v_mfma_f32_16x16x32_bf16 v[40:43], v[224:227], v[16:19], v[40:43]
v_add_f32_dpp v25, v31, v30 quad_perm:[2,2,2,2] row_mask:0xf bank_mask:0x8
v_add_f32_dpp v30, v45, v44 quad_perm:[1,1,1,1] row_mask:0xf bank_mask:0xf
v_add_f32_dpp v31, v47, v46 quad_perm:[3,3,3,3] row_mask:0xf bank_mask:0xf
v_mfma_f32_16x16x32_bf16 v[44:47], v[220:223], v[12:15], 0
v_mfma_f32_16x16x32_bf16 v[44:47], v[228:231], v[16:19], v[44:47]
v_add_f32_dpp v26, v31, v30 quad_perm:[2,2,2,2] row_mask:0xf bank_mask:0x1
v_add_f32_dpp v30, v49, v48 quad_perm:[1,1,1,1] row_mask:0xf bank_mask:0xf
v_add_f32_dpp v31, v51, v50 quad_perm:[3,3,3,3] row_mask:0xf bank_mask:0xf
s_waitcnt lgkmcnt(1)
v_mfma_f32_16x16x32_bf16 v[48:51], v[52:55], v[12:15], 0
ds_read_b128 v[52:55], v2 offset:3072
v_mfma_f32_16x16x32_bf16 v[48:51], v[232:235], v[16:19], v[48:51]
v_add_f32_dpp v26, v31, v30 quad_perm:[2,2,2,2] row_mask:0xf bank_mask:0x2
v_add_f32_dpp v30, v41, v40 quad_perm:[1,1,1,1] row_mask:0xf bank_mask:0xf
v_add_f32_dpp v31, v43, v42 quad_perm:[3,3,3,3] row_mask:0xf bank_mask:0xf
s_waitcnt lgkmcnt(1)
v_mfma_f32_16x16x32_bf16 v[40:43], v[60:63], v[12:15], 0
ds_read_b128 v[60:63], v2 offset:8192
v_mfma_f32_16x16x32_bf16 v[40:43], v[236:239], v[16:19], v[40:43]
v_add_f32_dpp v26, v31, v30 quad_perm:[2,2,2,2] row_mask:0xf bank_mask:0x4
v_add_f32_dpp v30, v45, v44 quad_perm:[1,1,1,1] row_mask:0xf bank_mask:0xf
v_add_f32_dpp v31, v47, v46 quad_perm:[3,3,3,3] row_mask:0xf bank_mask:0xf
v_mfma_f32_16x16x32_bf16 v[44:47], v[240:243], v[12:15], 0
v_mfma_f32_16x16x32_bf16 v[44:47], v[248:251], v[16:19], v[44:47]
v_add_f32_dpp v26, v31, v30 quad_perm:[2,2,2,2] row_mask:0xf bank_mask:0x8
v_add_f32_dpp v30, v49, v48 quad_perm:[1,1,1,1] row_mask:0xf bank_mask:0xf
v_add_f32_dpp v31, v51, v50 quad_perm:[3,3,3,3] row_mask:0xf bank_mask:0xf
v_mfma_f32_16x16x32_bf16 v[48:51], v[244:247], v[12:15], 0
v_mfma_f32_16x16x32_bf16 v[48:51], v[252:255], v[16:19], v[48:51]
v_add_f32_dpp v27, v31, v30 quad_perm:[2,2,2,2] row_mask:0xf bank_mask:0x1
v_add_f32_dpp v30, v41, v40 quad_perm:[1,1,1,1] row_mask:0xf bank_mask:0xf
v_add_f32_dpp v31, v43, v42 quad_perm:[3,3,3,3] row_mask:0xf bank_mask:0xf
s_waitcnt lgkmcnt(1)
v_mfma_f32_16x16x32_bf16 v[40:43], v[52:55], v[12:15], 0
ds_read_b128 v[52:55], v2 offset:4096
v_mfma_f32_16x16x32_bf16 v[40:43], a[0:3], v[16:19], v[40:43]
v_add_f32_dpp v27, v31, v30 quad_perm:[2,2,2,2] row_mask:0xf bank_mask:0x2
v_add_f32_dpp v30, v45, v44 quad_perm:[1,1,1,1] row_mask:0xf bank_mask:0xf
v_add_f32_dpp v31, v47, v46 quad_perm:[3,3,3,3] row_mask:0xf bank_mask:0xf
s_waitcnt lgkmcnt(1)
v_mfma_f32_16x16x32_bf16 v[44:47], v[60:63], v[12:15], 0
v_mfma_f32_16x16x32_bf16 v[44:47], a[4:7], v[16:19], v[44:47]
v_add_f32_dpp v27, v31, v30 quad_perm:[2,2,2,2] row_mask:0xf bank_mask:0x4
v_add_f32_dpp v30, v49, v48 quad_perm:[1,1,1,1] row_mask:0xf bank_mask:0xf
v_add_f32_dpp v31, v51, v50 quad_perm:[3,3,3,3] row_mask:0xf bank_mask:0xf
v_mfma_f32_16x16x32_bf16 v[48:51], a[8:11], v[12:15], 0
v_mfma_f32_16x16x32_bf16 v[48:51], a[16:19], v[16:19], v[48:51]
v_add_f32_dpp v27, v31, v30 quad_perm:[2,2,2,2] row_mask:0xf bank_mask:0x8
v_add_f32_dpp v30, v41, v40 quad_perm:[1,1,1,1] row_mask:0xf bank_mask:0xf
v_add_f32_dpp v31, v43, v42 quad_perm:[3,3,3,3] row_mask:0xf bank_mask:0xf
v_mfma_f32_16x16x32_bf16 v[40:43], a[12:15], v[12:15], 0
v_mfma_f32_16x16x32_bf16 v[40:43], a[20:23], v[16:19], v[40:43]
v_add_f32_dpp v28, v31, v30 quad_perm:[2,2,2,2] row_mask:0xf bank_mask:0x1
v_add_f32_dpp v30, v45, v44 quad_perm:[1,1,1,1] row_mask:0xf bank_mask:0xf
v_add_f32_dpp v31, v47, v46 quad_perm:[3,3,3,3] row_mask:0xf bank_mask:0xf
s_waitcnt lgkmcnt(0)
v_mfma_f32_16x16x32_bf16 v[44:47], v[52:55], v[12:15], 0
v_mfma_f32_16x16x32_bf16 v[44:47], a[24:27], v[16:19], v[44:47]
v_add_f32_dpp v28, v31, v30 quad_perm:[2,2,2,2] row_mask:0xf bank_mask:0x2
v_add_f32_dpp v30, v49, v48 quad_perm:[1,1,1,1] row_mask:0xf bank_mask:0xf
v_add_f32_dpp v31, v51, v50 quad_perm:[3,3,3,3] row_mask:0xf bank_mask:0xf
v_mfma_f32_16x16x32_bf16 v[48:51], v[56:59], v[12:15], 0
v_mfma_f32_16x16x32_bf16 v[48:51], a[28:31], v[16:19], v[48:51]
v_add_f32_dpp v28, v31, v30 quad_perm:[2,2,2,2] row_mask:0xf bank_mask:0x4
v_add_f32_dpp v30, v41, v40 quad_perm:[1,1,1,1] row_mask:0xf bank_mask:0xf
v_add_f32_dpp v31, v43, v42 quad_perm:[3,3,3,3] row_mask:0xf bank_mask:0xf
v_mfma_f32_16x16x32_bf16 v[40:43], v[176:179], v[12:15], 0
v_mfma_f32_16x16x32_bf16 v[40:43], v[180:183], v[16:19], v[40:43]
v_add_f32_dpp v28, v31, v30 quad_perm:[2,2,2,2] row_mask:0xf bank_mask:0x8
v_add_f32_dpp v30, v45, v44 quad_perm:[1,1,1,1] row_mask:0xf bank_mask:0xf
v_add_f32_dpp v31, v47, v46 quad_perm:[3,3,3,3] row_mask:0xf bank_mask:0xf
s_nop 1
v_add_f32_dpp v29, v31, v30 quad_perm:[2,2,2,2] row_mask:0xf bank_mask:0x1
v_add_f32_dpp v30, v49, v48 quad_perm:[1,1,1,1] row_mask:0xf bank_mask:0xf
v_add_f32_dpp v31, v51, v50 quad_perm:[3,3,3,3] row_mask:0xf bank_mask:0xf
s_nop 1
v_add_f32_dpp v29, v31, v30 quad_perm:[2,2,2,2] row_mask:0xf bank_mask:0x2
v_add_f32_dpp v30, v41, v40 quad_perm:[1,1,1,1] row_mask:0xf bank_mask:0xf
v_add_f32_dpp v31, v43, v42 quad_perm:[3,3,3,3] row_mask:0xf bank_mask:0xf
v_add_f32 v30, s27, v30
s_nop 1
v_add_f32_dpp v29, v31, v30 quad_perm:[2,2,2,2] row_mask:0xf bank_mask:0x4
ds_read_b128 v[52:55], v2 offset:10240
ds_read_b128 v[56:59], v2 offset:11264
v_max3_f32 v48, v25, v26, v27
v_max3_f32 v48, v48, v28, v29
s_nop 1
v_max_f32_dpp v48, v48, v48 row_ror:4 row_mask:0xf bank_mask:0xf
s_nop 1
v_max_f32_dpp v48, v48, v48 row_ror:8 row_mask:0xf bank_mask:0xf
v_mov_b32 v30, v48
s_nop 1
v_permlane16_swap_b32 v48, v30
v_max_f32 v48, v48, v30
v_mov_b32 v30, v48
s_nop 1
v_permlane32_swap_b32 v48, v30
v_max_f32 v48, v48, v30
v_mul_f32 v48, s35, v48
v_fma_f32 v25, v25, s35, -v48
v_fma_f32 v26, v26, s35, -v48
v_fma_f32 v27, v27, s35, -v48
v_fma_f32 v28, v28, s35, -v48
v_fma_f32 v29, v29, s35, -v48
v_exp_f32 v25, v25
v_exp_f32 v26, v26
v_exp_f32 v27, v27
v_exp_f32 v28, v28
v_exp_f32 v29, v29
v_add_f32 v49, v25, v26
v_cvt_pk_bf16_f32 v25, v25, v25
v_add_f32 v31, v27, v28
v_cvt_pk_bf16_f32 v26, v26, v26
v_add_f32 v49, v49, v29
v_cvt_pk_bf16_f32 v27, v27, v27
v_add_f32 v49, v49, v31
v_cvt_pk_bf16_f32 v28, v28, v28
v_cvt_pk_bf16_f32 v29, v29, v29
v_and_b32_dpp v12, v25, v8 row_newbcast:0 row_mask:0xf bank_mask:0xf
v_and_b32_dpp v13, v25, v9 row_newbcast:0 row_mask:0xf bank_mask:0xf
v_and_b32_dpp v14, v25, v10 row_newbcast:0 row_mask:0xf bank_mask:0xf
v_and_b32_dpp v15, v25, v11 row_newbcast:0 row_mask:0xf bank_mask:0xf
v_and_b32_dpp v16, v25, v8 row_newbcast:4 row_mask:0xf bank_mask:0xf
v_and_b32_dpp v17, v25, v9 row_newbcast:4 row_mask:0xf bank_mask:0xf
v_mfma_f32_16x16x32_bf16 v[40:43], v[12:15], v[64:67], 0
v_and_b32_dpp v18, v25, v10 row_newbcast:4 row_mask:0xf bank_mask:0xf
v_and_b32_dpp v19, v25, v11 row_newbcast:4 row_mask:0xf bank_mask:0xf
s_waitcnt lgkmcnt(1)
v_mfma_f32_16x16x32_bf16 v[44:47], v[12:15], v[52:55], 0
ds_read_b128 v[52:55], v2 offset:12288
v_and_b32_dpp v12, v25, v8 row_newbcast:8 row_mask:0xf bank_mask:0xf
v_and_b32_dpp v13, v25, v9 row_newbcast:8 row_mask:0xf bank_mask:0xf
v_mfma_f32_16x16x32_bf16 v[40:43], v[16:19], v[68:71], v[40:43]
v_and_b32_dpp v14, v25, v10 row_newbcast:8 row_mask:0xf bank_mask:0xf
v_and_b32_dpp v15, v25, v11 row_newbcast:8 row_mask:0xf bank_mask:0xf
v_mfma_f32_16x16x32_bf16 v[44:47], v[16:19], v[72:75], v[44:47]
v_and_b32_dpp v16, v25, v8 row_newbcast:12 row_mask:0xf bank_mask:0xf
v_and_b32_dpp v17, v25, v9 row_newbcast:12 row_mask:0xf bank_mask:0xf
v_mfma_f32_16x16x32_bf16 v[40:43], v[12:15], v[76:79], v[40:43]
v_and_b32_dpp v18, v25, v10 row_newbcast:12 row_mask:0xf bank_mask:0xf
v_and_b32_dpp v19, v25, v11 row_newbcast:12 row_mask:0xf bank_mask:0xf
s_waitcnt lgkmcnt(1)
v_mfma_f32_16x16x32_bf16 v[44:47], v[12:15], v[56:59], v[44:47]
ds_read_b128 v[56:59], v2 offset:13312
v_add_f32_dpp v49, v49, v49 row_ror:4 row_mask:0xf bank_mask:0xf
s_nop 1
v_add_f32_dpp v49, v49, v49 row_ror:8 row_mask:0xf bank_mask:0xf
v_mov_b32 v30, v49
s_nop 1
v_permlane16_swap_b32 v49, v30
v_add_f32 v49, v49, v30
v_mov_b32 v30, v49
s_nop 1
v_permlane32_swap_b32 v49, v30
v_add_f32 v49, v49, v30
v_and_b32_dpp v12, v26, v8 row_newbcast:0 row_mask:0xf bank_mask:0xf
v_and_b32_dpp v13, v26, v9 row_newbcast:0 row_mask:0xf bank_mask:0xf
v_mfma_f32_16x16x32_bf16 v[40:43], v[16:19], v[80:83], v[40:43]
v_and_b32_dpp v14, v26, v10 row_newbcast:0 row_mask:0xf bank_mask:0xf
v_and_b32_dpp v15, v26, v11 row_newbcast:0 row_mask:0xf bank_mask:0xf
v_mfma_f32_16x16x32_bf16 v[44:47], v[16:19], v[84:87], v[44:47]
v_and_b32_dpp v16, v26, v8 row_newbcast:4 row_mask:0xf bank_mask:0xf
v_and_b32_dpp v17, v26, v9 row_newbcast:4 row_mask:0xf bank_mask:0xf
v_mfma_f32_16x16x32_bf16 v[40:43], v[12:15], v[88:91], v[40:43]
v_and_b32_dpp v18, v26, v10 row_newbcast:4 row_mask:0xf bank_mask:0xf
v_and_b32_dpp v19, v26, v11 row_newbcast:4 row_mask:0xf bank_mask:0xf
s_waitcnt lgkmcnt(1)
v_mfma_f32_16x16x32_bf16 v[44:47], v[12:15], v[52:55], v[44:47]
ds_read_b128 v[52:55], v2 offset:14336
v_and_b32_dpp v12, v26, v8 row_newbcast:8 row_mask:0xf bank_mask:0xf
v_and_b32_dpp v13, v26, v9 row_newbcast:8 row_mask:0xf bank_mask:0xf
v_mfma_f32_16x16x32_bf16 v[40:43], v[16:19], v[92:95], v[40:43]
v_and_b32_dpp v14, v26, v10 row_newbcast:8 row_mask:0xf bank_mask:0xf
v_and_b32_dpp v15, v26, v11 row_newbcast:8 row_mask:0xf bank_mask:0xf
v_mfma_f32_16x16x32_bf16 v[44:47], v[16:19], v[96:99], v[44:47]
v_and_b32_dpp v16, v26, v8 row_newbcast:12 row_mask:0xf bank_mask:0xf
v_and_b32_dpp v17, v26, v9 row_newbcast:12 row_mask:0xf bank_mask:0xf
v_mfma_f32_16x16x32_bf16 v[40:43], v[12:15], v[100:103], v[40:43]
v_and_b32_dpp v18, v26, v10 row_newbcast:12 row_mask:0xf bank_mask:0xf
v_and_b32_dpp v19, v26, v11 row_newbcast:12 row_mask:0xf bank_mask:0xf
s_waitcnt lgkmcnt(1)
v_mfma_f32_16x16x32_bf16 v[44:47], v[12:15], v[56:59], v[44:47]
ds_read_b128 v[56:59], v2 offset:15360
v_and_b32_dpp v12, v27, v8 row_newbcast:0 row_mask:0xf bank_mask:0xf
v_and_b32_dpp v13, v27, v9 row_newbcast:0 row_mask:0xf bank_mask:0xf
v_mfma_f32_16x16x32_bf16 v[40:43], v[16:19], v[104:107], v[40:43]
v_and_b32_dpp v14, v27, v10 row_newbcast:0 row_mask:0xf bank_mask:0xf
v_and_b32_dpp v15, v27, v11 row_newbcast:0 row_mask:0xf bank_mask:0xf
v_mfma_f32_16x16x32_bf16 v[44:47], v[16:19], v[108:111], v[44:47]
v_and_b32_dpp v16, v27, v8 row_newbcast:4 row_mask:0xf bank_mask:0xf
v_and_b32_dpp v17, v27, v9 row_newbcast:4 row_mask:0xf bank_mask:0xf
v_mfma_f32_16x16x32_bf16 v[40:43], v[12:15], v[112:115], v[40:43]
v_and_b32_dpp v18, v27, v10 row_newbcast:4 row_mask:0xf bank_mask:0xf
v_and_b32_dpp v19, v27, v11 row_newbcast:4 row_mask:0xf bank_mask:0xf
s_waitcnt lgkmcnt(1)
v_mfma_f32_16x16x32_bf16 v[44:47], v[12:15], v[52:55], v[44:47]
ds_read_b128 v[52:55], v2 offset:16384
v_and_b32_dpp v12, v27, v8 row_newbcast:8 row_mask:0xf bank_mask:0xf
v_and_b32_dpp v13, v27, v9 row_newbcast:8 row_mask:0xf bank_mask:0xf
v_mfma_f32_16x16x32_bf16 v[40:43], v[16:19], v[116:119], v[40:43]
v_and_b32_dpp v14, v27, v10 row_newbcast:8 row_mask:0xf bank_mask:0xf
v_and_b32_dpp v15, v27, v11 row_newbcast:8 row_mask:0xf bank_mask:0xf
v_mfma_f32_16x16x32_bf16 v[44:47], v[16:19], v[120:123], v[44:47]
v_and_b32_dpp v16, v27, v8 row_newbcast:12 row_mask:0xf bank_mask:0xf
v_and_b32_dpp v17, v27, v9 row_newbcast:12 row_mask:0xf bank_mask:0xf
v_mfma_f32_16x16x32_bf16 v[40:43], v[12:15], v[124:127], v[40:43]
v_and_b32_dpp v18, v27, v10 row_newbcast:12 row_mask:0xf bank_mask:0xf
v_and_b32_dpp v19, v27, v11 row_newbcast:12 row_mask:0xf bank_mask:0xf
s_waitcnt lgkmcnt(1)
v_mfma_f32_16x16x32_bf16 v[44:47], v[12:15], v[56:59], v[44:47]
ds_read_b128 v[56:59], v2 offset:17408
v_and_b32_dpp v12, v28, v8 row_newbcast:0 row_mask:0xf bank_mask:0xf
v_and_b32_dpp v13, v28, v9 row_newbcast:0 row_mask:0xf bank_mask:0xf
v_mfma_f32_16x16x32_bf16 v[40:43], v[16:19], v[128:131], v[40:43]
v_and_b32_dpp v14, v28, v10 row_newbcast:0 row_mask:0xf bank_mask:0xf
v_and_b32_dpp v15, v28, v11 row_newbcast:0 row_mask:0xf bank_mask:0xf
v_mfma_f32_16x16x32_bf16 v[44:47], v[16:19], v[132:135], v[44:47]
v_and_b32_dpp v16, v28, v8 row_newbcast:4 row_mask:0xf bank_mask:0xf
v_and_b32_dpp v17, v28, v9 row_newbcast:4 row_mask:0xf bank_mask:0xf
v_mfma_f32_16x16x32_bf16 v[40:43], v[12:15], v[136:139], v[40:43]
v_and_b32_dpp v18, v28, v10 row_newbcast:4 row_mask:0xf bank_mask:0xf
v_and_b32_dpp v19, v28, v11 row_newbcast:4 row_mask:0xf bank_mask:0xf
s_waitcnt lgkmcnt(1)
v_mfma_f32_16x16x32_bf16 v[44:47], v[12:15], v[52:55], v[44:47]
ds_read_b128 v[52:55], v2 offset:18432
v_and_b32_dpp v12, v28, v8 row_newbcast:8 row_mask:0xf bank_mask:0xf
v_and_b32_dpp v13, v28, v9 row_newbcast:8 row_mask:0xf bank_mask:0xf
v_mfma_f32_16x16x32_bf16 v[40:43], v[16:19], v[140:143], v[40:43]
v_and_b32_dpp v14, v28, v10 row_newbcast:8 row_mask:0xf bank_mask:0xf
v_and_b32_dpp v15, v28, v11 row_newbcast:8 row_mask:0xf bank_mask:0xf
v_mfma_f32_16x16x32_bf16 v[44:47], v[16:19], v[144:147], v[44:47]
v_and_b32_dpp v16, v28, v8 row_newbcast:12 row_mask:0xf bank_mask:0xf
v_and_b32_dpp v17, v28, v9 row_newbcast:12 row_mask:0xf bank_mask:0xf
v_mfma_f32_16x16x32_bf16 v[40:43], v[12:15], v[148:151], v[40:43]
v_and_b32_dpp v18, v28, v10 row_newbcast:12 row_mask:0xf bank_mask:0xf
v_and_b32_dpp v19, v28, v11 row_newbcast:12 row_mask:0xf bank_mask:0xf
s_waitcnt lgkmcnt(1)
v_mfma_f32_16x16x32_bf16 v[44:47], v[12:15], v[56:59], v[44:47]
ds_read_b128 v[56:59], v2 offset:19456
v_and_b32_dpp v12, v29, v8 row_newbcast:0 row_mask:0xf bank_mask:0xf
v_and_b32_dpp v13, v29, v9 row_newbcast:0 row_mask:0xf bank_mask:0xf
v_mfma_f32_16x16x32_bf16 v[40:43], v[16:19], v[152:155], v[40:43]
v_and_b32_dpp v14, v29, v10 row_newbcast:0 row_mask:0xf bank_mask:0xf
v_and_b32_dpp v15, v29, v11 row_newbcast:0 row_mask:0xf bank_mask:0xf
v_mfma_f32_16x16x32_bf16 v[44:47], v[16:19], v[156:159], v[44:47]
v_and_b32_dpp v16, v29, v8 row_newbcast:4 row_mask:0xf bank_mask:0xf
v_and_b32_dpp v17, v29, v9 row_newbcast:4 row_mask:0xf bank_mask:0xf
v_mfma_f32_16x16x32_bf16 v[40:43], v[12:15], v[160:163], v[40:43]
v_and_b32_dpp v18, v29, v10 row_newbcast:4 row_mask:0xf bank_mask:0xf
v_and_b32_dpp v19, v29, v11 row_newbcast:4 row_mask:0xf bank_mask:0xf
s_waitcnt lgkmcnt(1)
v_mfma_f32_16x16x32_bf16 v[44:47], v[12:15], v[52:55], v[44:47]
v_and_b32_dpp v12, v29, v8 row_newbcast:8 row_mask:0xf bank_mask:0xf
v_and_b32_dpp v13, v29, v9 row_newbcast:8 row_mask:0xf bank_mask:0xf
v_mfma_f32_16x16x32_bf16 v[40:43], v[16:19], v[164:167], v[40:43]
v_and_b32_dpp v14, v29, v10 row_newbcast:8 row_mask:0xf bank_mask:0xf
v_and_b32_dpp v15, v29, v11 row_newbcast:8 row_mask:0xf bank_mask:0xf
v_mfma_f32_16x16x32_bf16 v[44:47], v[16:19], v[168:171], v[44:47]
s_nop 0
v_mfma_f32_16x16x32_bf16 v[40:43], v[12:15], v[172:175], v[40:43]
s_waitcnt lgkmcnt(0)
v_mfma_f32_16x16x32_bf16 v[44:47], v[12:15], v[56:59], v[44:47]
s_nop 5
v_cvt_pk_bf16_f32 v40, v40, v41
v_cvt_pk_bf16_f32 v41, v42, v43
v_cvt_pk_bf16_f32 v42, v44, v45
v_cvt_pk_bf16_f32 v43, v46, v47
v_mov_b32_dpp v40, v48 quad_perm:[0,0,0,0] row_mask:0xc bank_mask:0xf
v_mov_b32_dpp v41, v49 quad_perm:[0,0,0,0] row_mask:0xc bank_mask:0xf
ds_write_b128 v2, v[40:43] offset:4096
v_subrev_u32 v16, s33, v2
v_lshrrev_b32 v60, 8, v16
v_mul_u32_u24 v60, 40704, v60
v_add_u32 v16, v16, v60
s_cmp_lg_u32 s3, 1
s_waitcnt lgkmcnt(0)
s_barrier
s_cbranch_scc1 L_npf2
L_npf2_e:
ds_read_b64 v[48:49], v16 offset:4608
ds_read_b128 v[40:43], v16 offset:4096
ds_read_b128 v[44:47], v16 offset:4352
s_waitcnt lgkmcnt(2)
v_mov_b32 v60, v48
v_mov_b32 v61, v48
s_nop 1
v_permlane16_swap_b32 v60, v61
v_max_f32 v60, v60, v61
v_mov_b32 v61, v60
s_nop 1
v_permlane32_swap_b32 v60, v61
v_max_f32 v16, v60, v61
v_sub_f32 v48, v48, v16
v_exp_f32 v48, v48
s_nop 0
v_cvt_pk_bf16_f32 v60, v48, v48
v_and_b32 v12, v60, v8
v_and_b32 v13, v60, v9
v_and_b32 v14, v60, v10
v_and_b32 v15, v60, v11
s_cmp_lg_u32 s37, 0
v_mul_f32 v49, v49, v48
v_mov_b32 v48, v49
s_waitcnt lgkmcnt(1)
v_mfma_f32_16x16x32_bf16 v[60:63], v[12:15], v[40:43], 0
s_waitcnt lgkmcnt(0)
v_mfma_f32_16x16x32_bf16 v[40:43], v[12:15], v[44:47], 0
v_permlane16_swap_b32 v49, v48
v_add_f32 v49, v49, v48
v_mov_b32 v48, v49
s_nop 1
v_permlane32_swap_b32 v49, v48
v_add_f32 v49, v49, v48
v_and_b32 v48, -2, v4
v_xor_b32 v4, 1, v4
v_cvt_pk_bf16_f32 v60, v60, v61
v_cvt_pk_bf16_f32 v61, v62, v63
v_cvt_pk_bf16_f32 v62, v40, v41
v_cvt_pk_bf16_f32 v63, v42, v43
v_mov_b32_dpp v60, v49 quad_perm:[0,1,2,3] row_mask:0xc bank_mask:0xf
v_mov_b32_dpp v61, v16 quad_perm:[0,1,2,3] row_mask:0xc bank_mask:0xf
v_bfi_b32 v60, 1, v4, v60
s_cbranch_scc1 L_npf2_g
buffer_store_dwordx4 v[60:63], v48, s[16:19], s31 offen
s_nop 1
L_npf2:
v_subrev_u32 v0, s33, v2
v_lshrrev_b32 v0, 2, v0
ds_read_b32 v0, v0 offset:9216
s_waitcnt lgkmcnt(0)
v_bfi_b32 v4, 1, v0, v4
L_tail0:
s_waitcnt lgkmcnt(0)
s_barrier
ds_write_b128 v2, a[32:35] offset:0
ds_write_b128 v2, a[36:39] offset:2048
ds_write_b128 v2, a[40:43] offset:3072
ds_write_b128 v2, a[44:47] offset:4112
ds_write_b128 v2, a[48:51] offset:6160
ds_write_b128 v2, a[52:55] offset:7184
ds_write_b128 v2, a[56:59] offset:8224
ds_write_b128 v2, a[60:63] offset:10272
ds_write_b128 v2, a[64:67] offset:11296
ds_write_b128 v2, a[68:71] offset:12336
ds_write_b128 v2, a[72:75] offset:14384
ds_write_b128 v2, a[76:79] offset:15408
ds_write_b128 v2, a[80:83] offset:16512
ds_write_b128 v2, a[84:87] offset:18560
ds_read_b128 v[64:67], v2 offset:30720
ds_read_b128 v[68:71], v2 offset:31744
ds_read_b128 v[72:75], v2 offset:32768
ds_read_b128 v[76:79], v2 offset:33792
ds_read_b128 v[80:83], v2 offset:34816
ds_read_b128 v[84:87], v2 offset:35840
ds_read_b128 v[88:91], v2 offset:36864
ds_read_b128 v[92:95], v2 offset:37888
ds_read_b128 v[96:99], v2 offset:38912
ds_read_b128 v[100:103], v2 offset:39936
v_subrev_u32 v39, s33, v2
v_lshrrev_b32 v39, 4, v39
v_and_b32 v40, 15, v39
v_lshrrev_b32 v41, 4, v39
v_lshrrev_b32 v30, 1, v41
v_lshlrev_b32 v36, 8, v30
v_and_b32 v31, 1, v41
v_lshl_add_u32 v36, v31, 3, v36
v_and_b32 v38, 0xfffffe00, v3
v_lshl_add_u32 v38, v30, 6, v38
v_lshl_add_u32 v38, v31, 5, v38
v_and_b32 v31, 1, v40
v_lshl_add_u32 v38, v31, 4, v38
v_lshl_add_u32 v36, v31, 6, v36
v_add_u32 v36, s33, v36
v_mul_u32_u24 v32, 0xaaaa, v31
v_add_u32 v32, 0x4444, v32
v_and_b32 v33, 3, v40
v_mul_u32_u24 v33, 0x5555, v33
v_lshrrev_b32 v30, 1, v40
v_mul_u32_u24 v34, 4112, v30
v_add_u32 v34, v34, v36
v_lshrrev_b32 v30, 3, v40
v_lshl_add_u32 v34, v30, 6, v34
v_add_u32 v35, 2048, v34
v_and_b32 v30, 2, v40
v_lshrrev_b32 v31, 3, v40
v_add_u32 v30, v30, v31
v_mov_b32 v31, s27
v_cmp_eq_u32 vcc, 2, v30
s_nop 1
v_cndmask_b32 v37, 0, v31, vcc
v_mov_b32 v31, 0xff800000
v_cmp_eq_u32 vcc, 3, v30
s_nop 1
v_cndmask_b32 v37, v37, v31, vcc
v_min_u32 v30, 2, v30
v_lshl_add_u32 v36, v30, 11, v36
v_lshrrev_b32 v30, 1, v30
v_lshl_add_u32 v36, v30, 4, v36
v_bfe_u32 v30, v40, 2, 1
v_lshl_add_u32 v36, v30, 7, v36
v_add_u32 v36, 33024, v36
s_waitcnt lgkmcnt(0)
ds_read_b128 a[32:35], v2 offset:20480
ds_read_b128 a[36:39], v2 offset:25600
ds_read_b128 a[40:43], v2 offset:21504
ds_read_b128 a[44:47], v2 offset:26624
ds_read_b128 a[48:51], v2 offset:22528
ds_read_b128 a[52:55], v2 offset:27648
ds_read_b128 a[56:59], v2 offset:23552
ds_read_b128 a[60:63], v2 offset:28672
ds_read_b128 a[64:67], v2 offset:24576
ds_read_b128 a[68:71], v2 offset:29696
s_waitcnt lgkmcnt(0)
ds_write_b128 v2, a[88:91] offset:19584
ds_write_b128 v2, a[92:95] offset:20624
ds_write_b128 v2, a[96:99] offset:22672
ds_write_b128 v2, a[100:103] offset:23696
ds_write_b128 v2, a[104:107] offset:24736
ds_write_b128 v2, a[108:111] offset:26784
ds_write_b128 v2, a[112:115] offset:27808
ds_write_b128 v2, a[116:119] offset:28848
ds_write_b128 v2, a[120:123] offset:30896
ds_write_b128 v2, a[124:127] offset:31920
ds_write_b128 v2, a[128:131] offset:33024
ds_write_b128 v2, a[132:135] offset:35072
ds_write_b128 v2, a[136:139] offset:36096
ds_write_b128 v2, a[140:143] offset:37136
ds_write_b128 v2, v[64:67] offset:1024
ds_write_b128 v2, v[68:71] offset:5136
ds_write_b128 v2, v[72:75] offset:9248
ds_write_b128 v2, v[76:79] offset:13360
ds_write_b128 v2, v[80:83] offset:17536
ds_write_b128 v2, v[84:87] offset:21648
ds_write_b128 v2, v[88:91] offset:25760
ds_write_b128 v2, v[92:95] offset:29872
ds_write_b128 v2, v[96:99] offset:34048
ds_write_b128 v2, v[100:103] offset:38160
s_waitcnt lgkmcnt(0)
ds_read_b64 v[64:65], v34 offset:0
ds_read_b64 v[66:67], v34 offset:16
ds_read_b64 v[68:69], v34 offset:512
ds_read_b64 v[70:71], v34 offset:528
ds_read_b64 v[72:73], v34 offset:32
ds_read_b64 v[74:75], v34 offset:48
ds_read_b64 v[76:77], v34 offset:544
ds_read_b64 v[78:79], v34 offset:560
ds_read_b64 v[80:81], v34 offset:1024
ds_read_b64 v[82:83], v34 offset:1040
ds_read_b64 v[84:85], v34 offset:1536
ds_read_b64 v[86:87], v34 offset:1552
ds_read_b64 v[88:89], v34 offset:1056
ds_read_b64 v[90:91], v34 offset:1072
s_waitcnt lgkmcnt(12)
v_swap_b32 v65, v66
ds_read_b64 v[92:93], v34 offset:1568
ds_read_b64 v[94:95], v34 offset:1584
s_waitcnt lgkmcnt(12)
v_swap_b32 v69, v70
ds_read_b64 v[96:97], v34 offset:128
ds_read_b64 v[98:99], v34 offset:144
s_waitcnt lgkmcnt(12)
v_swap_b32 v73, v74
ds_read_b64 v[100:101], v34 offset:640
ds_read_b64 v[102:103], v34 offset:656
s_waitcnt lgkmcnt(12)
v_swap_b32 v77, v78
ds_read_b64 v[104:105], v34 offset:160
ds_read_b64 v[106:107], v34 offset:176
s_waitcnt lgkmcnt(12)
v_swap_b32 v81, v82
ds_read_b64 v[108:109], v34 offset:672
ds_read_b64 v[110:111], v34 offset:688
s_waitcnt lgkmcnt(12)
v_swap_b32 v85, v86
ds_read_b64 v[112:113], v34 offset:1152
ds_read_b64 v[114:115], v34 offset:1168
s_waitcnt lgkmcnt(12)
v_swap_b32 v89, v90
ds_read_b64 v[116:117], v34 offset:1664
ds_read_b64 v[118:119], v34 offset:1680
s_waitcnt lgkmcnt(12)
v_swap_b32 v93, v94
ds_read_b64 v[120:121], v34 offset:1184
ds_read_b64 v[122:123], v34 offset:1200
s_waitcnt lgkmcnt(12)
v_swap_b32 v97, v98
ds_read_b64 v[124:125], v34 offset:1696
ds_read_b64 v[126:127], v34 offset:1712
s_waitcnt lgkmcnt(12)
v_swap_b32 v101, v102
ds_read_b64 v[128:129], v35 offset:0
ds_read_b64 v[130:131], v35 offset:16
s_waitcnt lgkmcnt(12)
v_swap_b32 v105, v106
ds_read_b64 v[132:133], v35 offset:512
ds_read_b64 v[134:135], v35 offset:528
s_waitcnt lgkmcnt(12)
v_swap_b32 v109, v110
ds_read_b64 v[136:137], v35 offset:32
ds_read_b64 v[138:139], v35 offset:48
s_waitcnt lgkmcnt(12)
v_swap_b32 v113, v114
ds_read_b64 v[140:141], v35 offset:544
ds_read_b64 v[142:143], v35 offset:560
s_waitcnt lgkmcnt(12)
v_swap_b32 v117, v118
ds_read_b64 v[144:145], v35 offset:1024
ds_read_b64 v[146:147], v35 offset:1040
s_waitcnt lgkmcnt(12)
v_swap_b32 v121, v122
ds_read_b64 v[148:149], v35 offset:1536
ds_read_b64 v[150:151], v35 offset:1552
s_waitcnt lgkmcnt(12)
v_swap_b32 v125, v126
ds_read_b64 v[152:153], v35 offset:1056
ds_read_b64 v[154:155], v35 offset:1072
s_waitcnt lgkmcnt(12)
v_swap_b32 v129, v130
ds_read_b64 v[156:157], v35 offset:1568
ds_read_b64 v[158:159], v35 offset:1584
s_waitcnt lgkmcnt(12)
v_swap_b32 v133, v134
ds_read_b64 v[160:161], v35 offset:128
ds_read_b64 v[162:163], v35 offset:144
s_waitcnt lgkmcnt(12)
v_swap_b32 v137, v138
ds_read_b64 v[164:165], v35 offset:640
ds_read_b64 v[166:167], v35 offset:656
s_waitcnt lgkmcnt(12)
v_swap_b32 v141, v142
ds_read_b64 v[168:169], v35 offset:160
ds_read_b64 v[170:171], v35 offset:176
s_waitcnt lgkmcnt(12)
v_swap_b32 v145, v146
ds_read_b64 v[172:173], v35 offset:672
ds_read_b64 v[174:175], v35 offset:688
s_waitcnt lgkmcnt(12)
v_swap_b32 v149, v150
ds_read_b64 v[176:177], v35 offset:1152
ds_read_b64 v[178:179], v35 offset:1168
s_waitcnt lgkmcnt(12)
v_swap_b32 v153, v154
ds_read_b64 v[180:181], v35 offset:1664
ds_read_b64 v[182:183], v35 offset:1680
s_waitcnt lgkmcnt(12)
v_swap_b32 v157, v158
ds_read_b64 v[184:185], v35 offset:1184
ds_read_b64 v[186:187], v35 offset:1200
s_waitcnt lgkmcnt(12)
v_swap_b32 v161, v162
ds_read_b64 v[188:189], v35 offset:1696
ds_read_b64 v[190:191], v35 offset:1712
s_waitcnt lgkmcnt(12)
v_swap_b32 v165, v166
ds_read_b64 v[192:193], v36 offset:0
ds_read_b64 v[194:195], v36 offset:16
s_waitcnt lgkmcnt(12)
v_swap_b32 v169, v170
ds_read_b64 v[196:197], v36 offset:512
ds_read_b64 v[198:199], v36 offset:528
s_waitcnt lgkmcnt(12)
v_swap_b32 v173, v174
ds_read_b64 v[200:201], v36 offset:32
ds_read_b64 v[202:203], v36 offset:48
s_waitcnt lgkmcnt(12)
v_swap_b32 v177, v178
ds_read_b64 v[204:205], v36 offset:544
ds_read_b64 v[206:207], v36 offset:560
s_waitcnt lgkmcnt(12)
v_swap_b32 v181, v182
ds_read_b64 v[208:209], v36 offset:1024
ds_read_b64 v[210:211], v36 offset:1040
s_waitcnt lgkmcnt(12)
v_swap_b32 v185, v186
ds_read_b64 v[212:213], v36 offset:1536
ds_read_b64 v[214:215], v36 offset:1552
s_waitcnt lgkmcnt(12)
v_swap_b32 v189, v190
ds_read_b64 v[216:217], v36 offset:1056
ds_read_b64 v[218:219], v36 offset:1072
s_waitcnt lgkmcnt(12)
v_swap_b32 v193, v194
ds_read_b64 v[220:221], v36 offset:1568
ds_read_b64 v[222:223], v36 offset:1584
s_waitcnt lgkmcnt(12)
v_swap_b32 v197, v198
s_waitcnt lgkmcnt(10)
v_swap_b32 v201, v202
s_waitcnt lgkmcnt(8)
v_swap_b32 v205, v206
s_waitcnt lgkmcnt(6)
v_swap_b32 v209, v210
s_waitcnt lgkmcnt(4)
v_swap_b32 v213, v214
s_waitcnt lgkmcnt(2)
v_swap_b32 v217, v218
s_waitcnt lgkmcnt(0)
v_swap_b32 v221, v222
L_tw:
v_mov_b32 v232, 0
v_mov_b32 v233, 0
v_mov_b32 v234, 0
v_mov_b32 v235, 0
v_mov_b32 v236, 0
v_mov_b32 v237, 0
v_mov_b32 v238, 0
v_mov_b32 v239, 0
v_mov_b32 v240, 0
v_mov_b32 v241, 0
v_mov_b32 v242, 0
v_mov_b32 v243, 0
v_mov_b32 v244, 0
v_mov_b32 v245, 0
v_mov_b32 v246, 0
v_mov_b32 v247, 0
v_mov_b32 v248, 0
v_mov_b32 v249, 0
v_mov_b32 v52, 0
v_mov_b32 v53, 0
v_mov_b32 v54, v37
v_mov_b32 v55, 0
v_mov_b32 v56, 0
v_mov_b32 v57, 0
v_mov_b32 v44, 0
v_mov_b32 v45, 0
v_mov_b32 v46, 0
v_mov_b32 v47, 0
v_mov_b32 v26, 0xff800000
v_subrev_u32 v24, s33, v2
v_and_b32 v0, 255, v24
v_lshrrev_b32 v58, 8, v24
v_mul_u32_u24 v58, 40704, v58
v_add_u32 v24, v24, v58
v_lshrrev_b32 v58, 6, v0
v_mul_u32_u24 v58, 40960, v58
v_bfe_u32 v59, v0, 4, 2
v_lshl_add_u32 v0, v59, 8, v0
v_add_u32 v0, v0, v58
v_and_b32 v1, -2, v4
v_xor_b32 v4, 1, v4
s_cmp_eq_u32 s3, 0
s_cselect_b32 s45, s30, 1073741824
s_lshl_b32 s45, s3, 4
s_add_u32 s45, s45, s33
s_add_u32 s45, s45, 512
v_mov_b32 v59, 0x80000000
v_cmp_eq_u32 vcc, s45, v2
s_nop 1
v_cndmask_b32 v59, v59, v1, vcc
s_cmp_eq_u32 s37, 0
s_cselect_b32 s45, s30, 1073741824
s_cselect_b32 s44, 1073741824, s30

buffer_load_dwordx4 v[224:227], v3, s[16:19], s29 offen offset:0 sc1
buffer_load_dwordx4 v[228:231], v3, s[16:19], s29 offen offset:256 sc1
s_nop 12
s_nop 12
L_tq:
buffer_load_dwordx4 v[224:227], v3, s[16:19], s29 offen offset:0 sc1
buffer_load_dwordx4 v[228:231], v3, s[16:19], s29 offen offset:256 sc1
s_sub_u32 s34, s34, 1
s_cbranch_scc1 L_end
s_waitcnt vmcnt(2)
v_max3_u32 v30, v224, v225, v226
v_max3_u32 v31, v227, v228, v229
v_max3_u32 v30, v30, v230, v231
v_max_u32 v30, v30, v31
v_cmp_eq_u32 vcc, -1, v30
s_cbranch_vccnz L_tq
L_tq_r:
v_smfmac_f32_16x16x64_bf16 v[54:57], v[224:227], v[192:199], v32
v_mov_b32 v12, 0
v_smfmac_f32_16x16x64_bf16 v[54:57], v[228:231], v[208:215], v32
v_mov_b32 v13, 0
v_smfmac_f32_16x16x64_bf16 v[234:237], v[224:227], v[64:71], v32
v_mov_b32 v14, 0
v_smfmac_f32_16x16x64_bf16 v[234:237], v[228:231], v[80:87], v32
v_mov_b32 v15, 0
v_smfmac_f32_16x16x64_bf16 v[238:241], v[224:227], v[96:103], v32
v_mov_b32 v16, 0
v_smfmac_f32_16x16x64_bf16 v[238:241], v[228:231], v[112:119], v32
v_mov_b32 v17, 0
v_smfmac_f32_16x16x64_bf16 v[52:55], v[224:227], v[200:207], v32
v_mov_b32 v18, 0
v_smfmac_f32_16x16x64_bf16 v[52:55], v[228:231], v[216:223], v32
v_mov_b32 v19, 0
v_smfmac_f32_16x16x64_bf16 v[232:235], v[224:227], v[72:79], v32
v_mov_b32 v40, 0
v_smfmac_f32_16x16x64_bf16 v[232:235], v[228:231], v[88:95], v32
v_mov_b32 v41, 0
v_smfmac_f32_16x16x64_bf16 v[242:245], v[224:227], v[128:135], v32
v_mov_b32 v42, 0
v_smfmac_f32_16x16x64_bf16 v[242:245], v[228:231], v[144:151], v32
v_add_f32 v31, v54, v55
v_smfmac_f32_16x16x64_bf16 v[246:249], v[224:227], v[160:167], v32
v_mov_b32 v43, 0
v_smfmac_f32_16x16x64_bf16 v[246:249], v[228:231], v[176:183], v32
v_add_f32 v50, v234, v235
v_smfmac_f32_16x16x64_bf16 v[236:239], v[224:227], v[104:111], v32
v_mov_b32_dpp v26, v31 quad_perm:[0,1,2,3] row_mask:0x1 bank_mask:0x1
v_smfmac_f32_16x16x64_bf16 v[236:239], v[228:231], v[120:127], v32
v_mov_b32_dpp v25, v50 quad_perm:[0,1,2,3] row_mask:0x1 bank_mask:0xf
v_smfmac_f32_16x16x64_bf16 v[240:243], v[224:227], v[136:143], v32
v_mov_b32_dpp v26, v31 row_shl:4 row_mask:0x2 bank_mask:0x1
v_smfmac_f32_16x16x64_bf16 v[240:243], v[228:231], v[152:159], v32
v_max_f32 v48, v31, v50
v_smfmac_f32_16x16x64_bf16 v[244:247], v[224:227], v[168:175], v32
v_mov_b32_dpp v26, v31 row_shl:8 row_mask:0x4 bank_mask:0x1
v_smfmac_f32_16x16x64_bf16 v[244:247], v[228:231], v[184:191], v32
v_add_f32 v51, v238, v239
v_mov_b32_dpp v26, v31 row_shl:12 row_mask:0x8 bank_mask:0x1
v_max_f32 v48, v48, v51
v_mov_b32_dpp v25, v51 quad_perm:[0,1,2,3] row_mask:0x2 bank_mask:0xf
v_add_f32 v250, v242, v243
v_max_f32 v48, v48, v250
s_waitcnt vmcnt(0)
v_mov_b32_dpp v25, v250 quad_perm:[0,1,2,3] row_mask:0x4 bank_mask:0xf
v_add_f32 v251, v246, v247
v_max_f32 v48, v48, v251
s_nop 0
v_mov_b32_dpp v25, v251 quad_perm:[0,1,2,3] row_mask:0x8 bank_mask:0xf
v_max_f32_dpp v48, v48, v48 quad_perm:[1,0,3,2] row_mask:0xf bank_mask:0xf
s_nop 1
v_max_f32_dpp v48, v48, v48 quad_perm:[2,3,0,1] row_mask:0xf bank_mask:0xf
s_nop 1
v_max_f32_dpp v48, v48, v48 row_ror:4 row_mask:0xf bank_mask:0xf
s_nop 1
v_max_f32_dpp v48, v48, v48 row_ror:8 row_mask:0xf bank_mask:0xf
v_mul_f32 v48, s35, v48
v_fma_f32 v25, v25, s35, -v48
v_fma_f32 v26, v26, s35, -v48
v_exp_f32 v25, v25
v_exp_f32 v26, v26
v_cvt_pk_bf16_f32 v27, v25, 0
v_add_f32 v49, v25, v26
v_cvt_pk_bf16_f32 v28, v26, 0
v_mov_b32_dpp v12, v27 row_newbcast:0 row_mask:0xf bank_mask:0x5
v_mov_b32_dpp v13, v27 row_newbcast:0 row_mask:0xf bank_mask:0xa
v_mov_b32_dpp v14, v27 row_newbcast:1 row_mask:0xf bank_mask:0x5
v_mov_b32_dpp v15, v27 row_newbcast:1 row_mask:0xf bank_mask:0xa
v_mov_b32_dpp v16, v27 row_newbcast:2 row_mask:0xf bank_mask:0x5
v_mov_b32 v61, v48
v_mov_b32_dpp v17, v27 row_newbcast:2 row_mask:0xf bank_mask:0xa
v_smfmac_f32_16x16x64_bf16 v[40:43], v[12:15], a[32:39], v33
v_add_f32_dpp v49, v49, v49 quad_perm:[1,0,3,2] row_mask:0xf bank_mask:0xf
v_mov_b32_dpp v18, v27 row_newbcast:3 row_mask:0xf bank_mask:0x5
v_mov_b32_dpp v19, v27 row_newbcast:3 row_mask:0xf bank_mask:0xa
v_add_f32_dpp v49, v49, v49 quad_perm:[2,3,0,1] row_mask:0xf bank_mask:0xf
v_smfmac_f32_16x16x64_bf16 v[44:47], v[12:15], a[152:159], v33
v_mov_b32_dpp v12, v27 row_newbcast:4 row_mask:0xf bank_mask:0x5
v_add_f32_dpp v49, v49, v49 row_ror:4 row_mask:0xf bank_mask:0xf
v_mov_b32_dpp v13, v27 row_newbcast:4 row_mask:0xf bank_mask:0xa
v_smfmac_f32_16x16x64_bf16 v[40:43], v[16:19], a[160:167], v33
v_add_f32_dpp v49, v49, v49 row_ror:8 row_mask:0xf bank_mask:0xf
v_mov_b32_dpp v14, v27 row_newbcast:5 row_mask:0xf bank_mask:0x5
v_mov_b32_dpp v15, v27 row_newbcast:5 row_mask:0xf bank_mask:0xa
v_mov_b32 v30, v49
v_smfmac_f32_16x16x64_bf16 v[44:47], v[16:19], a[168:175], v33
v_mov_b32_dpp v16, v27 row_newbcast:6 row_mask:0xf bank_mask:0x5
v_permlane16_swap_b32 v49, v30
v_mov_b32_dpp v17, v27 row_newbcast:6 row_mask:0xf bank_mask:0xa
v_smfmac_f32_16x16x64_bf16 v[40:43], v[12:15], a[40:47], v33
v_add_f32 v49, v49, v30
v_mov_b32_dpp v18, v27 row_newbcast:7 row_mask:0xf bank_mask:0x5
v_mov_b32_dpp v19, v27 row_newbcast:7 row_mask:0xf bank_mask:0xa
v_mov_b32 v30, v49
v_smfmac_f32_16x16x64_bf16 v[44:47], v[12:15], a[176:183], v33
v_mov_b32_dpp v12, v27 row_newbcast:8 row_mask:0xf bank_mask:0x5
v_permlane32_swap_b32 v49, v30
v_mov_b32_dpp v13, v27 row_newbcast:8 row_mask:0xf bank_mask:0xa
v_smfmac_f32_16x16x64_bf16 v[40:43], v[16:19], a[184:191], v33
v_add_f32 v49, v49, v30
v_mov_b32_dpp v14, v27 row_newbcast:9 row_mask:0xf bank_mask:0x5
v_mov_b32_dpp v15, v27 row_newbcast:9 row_mask:0xf bank_mask:0xa
v_bfi_b32 v60, 1, v4, v49
v_smfmac_f32_16x16x64_bf16 v[44:47], v[16:19], a[192:199], v33
v_mov_b32_dpp v16, v27 row_newbcast:10 row_mask:0xf bank_mask:0x5
v_mov_b32_dpp v17, v27 row_newbcast:10 row_mask:0xf bank_mask:0xa
v_smfmac_f32_16x16x64_bf16 v[40:43], v[12:15], a[48:55], v33
buffer_store_dwordx2 v[60:61], v59, s[16:19], s45 offen
v_mov_b32_dpp v18, v27 row_newbcast:11 row_mask:0xf bank_mask:0x5
v_mov_b32_dpp v19, v27 row_newbcast:11 row_mask:0xf bank_mask:0xa
buffer_store_dwordx2 v[60:61], v59, s[16:19], s44 offen sc1
v_smfmac_f32_16x16x64_bf16 v[44:47], v[12:15], a[200:207], v33
v_mov_b32_dpp v12, v27 row_newbcast:12 row_mask:0xf bank_mask:0x5
v_mov_b32_dpp v13, v27 row_newbcast:12 row_mask:0xf bank_mask:0xa
v_smfmac_f32_16x16x64_bf16 v[40:43], v[16:19], a[208:215], v33
ds_write_b32 v2, v48 offset:1024
v_mov_b32_dpp v14, v27 row_newbcast:13 row_mask:0xf bank_mask:0x5
v_mov_b32_dpp v15, v27 row_newbcast:13 row_mask:0xf bank_mask:0xa
v_smfmac_f32_16x16x64_bf16 v[44:47], v[16:19], a[216:223], v33
v_mov_b32_dpp v16, v27 row_newbcast:14 row_mask:0xf bank_mask:0x5
v_mov_b32_dpp v17, v27 row_newbcast:14 row_mask:0xf bank_mask:0xa
v_smfmac_f32_16x16x64_bf16 v[40:43], v[12:15], a[56:63], v33
v_mov_b32_dpp v18, v27 row_newbcast:15 row_mask:0xf bank_mask:0x5
v_mov_b32_dpp v19, v27 row_newbcast:15 row_mask:0xf bank_mask:0xa
v_smfmac_f32_16x16x64_bf16 v[44:47], v[12:15], a[224:231], v33
v_mov_b32_dpp v12, v28 row_newbcast:0 row_mask:0xf bank_mask:0x5
v_mov_b32_dpp v13, v28 row_newbcast:0 row_mask:0xf bank_mask:0xa
v_smfmac_f32_16x16x64_bf16 v[40:43], v[16:19], a[232:239], v33
s_waitcnt lgkmcnt(0)
s_barrier
ds_read_b32 v6, v0 offset:1024
v_mov_b32_dpp v14, v28 row_newbcast:1 row_mask:0xf bank_mask:0x5
v_mov_b32_dpp v15, v28 row_newbcast:1 row_mask:0xf bank_mask:0xa
ds_read_b32 v58, v24 offset:1024
v_smfmac_f32_16x16x64_bf16 v[44:47], v[16:19], a[240:247], v33
v_mov_b32_dpp v16, v28 row_newbcast:2 row_mask:0xf bank_mask:0x5
v_mov_b32_dpp v17, v28 row_newbcast:2 row_mask:0xf bank_mask:0xa
v_smfmac_f32_16x16x64_bf16 v[40:43], v[12:15], a[64:71], v33
v_mov_b32_dpp v18, v28 row_newbcast:3 row_mask:0xf bank_mask:0x5
v_mov_b32_dpp v19, v28 row_newbcast:3 row_mask:0xf bank_mask:0xa
v_smfmac_f32_16x16x64_bf16 v[44:47], v[12:15], a[248:255], v33
s_nop 0
v_smfmac_f32_16x16x64_bf16 v[40:43], v[16:19], a[144:151], v33
v_smfmac_f32_16x16x64_bf16 v[44:47], v[16:19], a[148:155], v33
s_nop 6
v_cvt_pk_bf16_f32 v40, v40, v41
v_cvt_pk_bf16_f32 v41, v42, v43
v_cvt_pk_bf16_f32 v42, v44, v45
v_cvt_pk_bf16_f32 v43, v46, v47
ds_write_b128 v2, v[40:43]
s_waitcnt lgkmcnt(2)
v_max_f32_dpp v6, v6, v6 row_ror:4 row_mask:0xf bank_mask:0xf
s_nop 1
v_max_f32_dpp v6, v6, v6 row_ror:8 row_mask:0xf bank_mask:0xf
s_waitcnt lgkmcnt(1)
v_sub_f32 v58, v58, v6
v_exp_f32 v58, v58
s_cmp_lg_u32 s3, 0
s_waitcnt lgkmcnt(0)
s_barrier
s_cbranch_scc1 L_np3
ds_read_b128 v[40:43], v24 offset:0
ds_read_b128 v[44:47], v24 offset:256
v_cvt_pk_bf16_f32 v58, v58, v58
v_and_b32 v20, v58, v8
v_and_b32 v21, v58, v9
v_and_b32 v22, v58, v10
v_and_b32 v23, v58, v11
s_cmp_lg_u32 s37, 0
s_waitcnt lgkmcnt(1)
v_mfma_f32_16x16x32_bf16 v[60:63], v[20:23], v[40:43], 0
s_waitcnt lgkmcnt(0)
v_mfma_f32_16x16x32_bf16 v[40:43], v[20:23], v[44:47], 0
s_mov_b32 exec_hi, 0
s_nop 4
v_cvt_pk_bf16_f32 v60, v60, v61
v_cvt_pk_bf16_f32 v61, v62, v63
v_bfi_b32 v60, 1, v4, v60
v_cvt_pk_bf16_f32 v62, v40, v41
v_cvt_pk_bf16_f32 v63, v42, v43
s_cbranch_scc1 L_np3_g
buffer_store_dwordx4 v[60:63], v1, s[16:19], s30 offen
s_nop 1
L_np3:
s_mov_b32 exec_hi, -1
L_tdone:
s_branch L_end
L_q10_s:
s_sub_u32 s34, s34, 1
s_cbranch_scc1 L_end
s_sleep 1
buffer_load_dwordx4 v[12:15], v3, s[16:19], s28 offen sc1
buffer_load_dwordx4 v[16:19], v3, s[16:19], s28 offen offset:256 sc1
s_waitcnt vmcnt(0) lgkmcnt(0)
v_max_u32 v30, v12, v16
v_cmp_eq_u32 vcc, -1, v30
s_cbranch_vccnz L_q10_s
s_branch L_q10_r
L_q20_s:
s_sub_u32 s34, s34, 1
s_cbranch_scc1 L_end
s_sleep 1
buffer_load_dwordx4 v[32:35], v3, s[16:19], s29 offen sc1
buffer_load_dwordx4 v[36:39], v3, s[16:19], s29 offen offset:256 sc1
s_waitcnt vmcnt(0) lgkmcnt(0)
v_max_u32 v60, v32, v36
v_cmp_eq_u32 vcc, -1, v60
s_cbranch_vccnz L_q20_s
s_branch L_q20_r
L_q11_s:
s_sub_u32 s34, s34, 1
s_cbranch_scc1 L_end
s_sleep 1
buffer_load_dwordx4 v[12:15], v3, s[16:19], s28 offen sc1
buffer_load_dwordx4 v[16:19], v3, s[16:19], s28 offen offset:256 sc1
s_waitcnt vmcnt(0) lgkmcnt(0)
v_max_u32 v30, v12, v16
v_cmp_eq_u32 vcc, -1, v30
s_cbranch_vccnz L_q11_s
s_branch L_q11_r
L_q21_s:
s_sub_u32 s34, s34, 1
s_cbranch_scc1 L_end
s_sleep 1
buffer_load_dwordx4 v[12:15], v3, s[16:19], s29 offen sc1
buffer_load_dwordx4 v[16:19], v3, s[16:19], s29 offen offset:256 sc1
s_waitcnt vmcnt(0) lgkmcnt(0)
v_max_u32 v30, v12, v16
v_cmp_eq_u32 vcc, -1, v30
s_cbranch_vccnz L_q21_s
s_branch L_q21_r
L_q12_s:
s_sub_u32 s34, s34, 1
s_cbranch_scc1 L_end
s_sleep 1
buffer_load_dwordx4 v[32:35], v3, s[16:19], s28 offen sc1
buffer_load_dwordx4 v[36:39], v3, s[16:19], s28 offen offset:256 sc1
s_waitcnt vmcnt(0) lgkmcnt(0)
v_max_u32 v30, v32, v36
v_cmp_eq_u32 vcc, -1, v30
s_cbranch_vccnz L_q12_s
s_branch L_q12_r
L_q22_s:
s_sub_u32 s34, s34, 1
s_cbranch_scc1 L_end
s_sleep 1
buffer_load_dwordx4 v[12:15], v3, s[16:19], s29 offen sc1
buffer_load_dwordx4 v[16:19], v3, s[16:19], s29 offen offset:256 sc1
s_waitcnt vmcnt(0) lgkmcnt(0)
v_max_u32 v30, v12, v16
v_cmp_eq_u32 vcc, -1, v30
s_cbranch_vccnz L_q22_s
s_branch L_q22_r
L_q13_s:
s_sub_u32 s34, s34, 1
s_cbranch_scc1 L_end
s_sleep 1
buffer_load_dwordx4 v[12:15], v3, s[16:19], s28 offen sc1
buffer_load_dwordx4 v[16:19], v3, s[16:19], s28 offen offset:256 sc1
s_waitcnt vmcnt(0) lgkmcnt(0)
v_max_u32 v30, v12, v16
v_cmp_eq_u32 vcc, -1, v30
s_cbranch_vccnz L_q13_s
s_branch L_q13_r
L_q2f_s:
s_sub_u32 s34, s34, 1
s_cbranch_scc1 L_end
s_sleep 1
buffer_load_dwordx4 v[12:15], v3, s[16:19], s29 offen sc1
buffer_load_dwordx4 v[16:19], v3, s[16:19], s29 offen offset:256 sc1
s_waitcnt vmcnt(0) lgkmcnt(0)
v_max_u32 v30, v12, v16
v_cmp_eq_u32 vcc, -1, v30
s_cbranch_vccnz L_q2f_s
s_branch L_q2f_r
L_cc_s:
s_sub_u32 s34, s34, 1
s_cbranch_scc1 L_end
buffer_load_dword v50, off, s[20:23], s36 sc1
s_waitcnt vmcnt(0) lgkmcnt(0)
s_branch L_cc_r
L_req:
s_cmp_lg_u32 s3, 0
s_cbranch_scc1 L_req_r
v_mov_b32 v50, 1
s_mov_b64 exec, 1
buffer_atomic_add v50, off, s[20:23], 0 offset:224 sc1
s_mov_b64 exec, -1
s_waitcnt vmcnt(0) lgkmcnt(0)
s_branch L_req_r
L_np11_g:
buffer_store_dwordx4 v[60:63], v6, s[16:19], s30 offen sc1
s_nop 1
s_branch L_np11
L_np12_g:
buffer_store_dwordx4 v[60:63], v6, s[16:19], s30 offen sc1
s_nop 1
s_branch L_np12
L_np22_g:
buffer_store_dwordx4 v[60:63], v48, s[16:19], s31 offen sc1
s_nop 1
s_branch L_np22
L_np13_g:
buffer_store_dwordx4 v[60:63], v6, s[16:19], s30 offen sc1
s_nop 1
s_branch L_np13
L_np23_g:
buffer_store_dwordx4 v[60:63], v48, s[16:19], s31 offen sc1
s_nop 1
s_branch L_np23
L_npe1_g:
buffer_store_dwordx4 v[60:63], v30, s[16:19], s45 offen sc1
s_nop 1
s_branch L_npe1
L_npf1_g:
buffer_store_dwordx4 v[60:63], v30, s[16:19], s30 offen sc1
s_nop 1
s_branch L_npf1
L_npf2_g:
buffer_store_dwordx4 v[60:63], v48, s[16:19], s31 offen sc1
s_nop 1
s_branch L_npf2
L_np3_g:
buffer_store_dwordx4 v[60:63], v1, s[16:19], s30 offen sc1
s_nop 1
s_branch L_np3
L_chain:
s_load_dwordx16 s[64:79], s[0:1], 0
s_load_dwordx8 s[80:87], s[0:1], 64
v_and_b32 v32, 63, v0
v_lshrrev_b32 v35, 6, v0
s_nop 0
v_readfirstlane_b32 s3, v35
v_and_b32 v33, 15, v0
v_lshrrev_b32 v34, 4, v32
v_mov_b32 v38, 0x80000000
s_lshl_b32 s93, s96, 2
s_add_u32 s93, s93, s97
s_lshr_b32 s4, s93, 1
s_and_b32 s5, s93, 1
s_lshl_b32 s5, s5, 2
s_add_u32 s5, s5, s3
s_lshl_b32 s56, s3, 12
v_bfe_u32 v35, v32, 2, 3
v_and_b32 v36, 3, v32
v_lshrrev_b32 v37, 5, v32
v_lshl_add_u32 v36, v37, 2, v36
v_lshlrev_b32 v36, 4, v36
v_and_b32 v37, 2, v35
v_mul_u32_u24 v37, 3, v37
v_add_u32 v37, v37, v35
s_lshr_b32 s6, s3, 1
s_and_b32 s7, s3, 1
s_lshl_b32 s55, s93, 8
s_lshl_b32 s57, s6, 7
s_add_u32 s55, s55, s57
s_lshl_b32 s57, s7, 18
s_add_u32 s55, s55, s57
v_lshl_add_u32 v72, v37, 13, v36
v_add_u32 v72, s55, v72
s_waitcnt lgkmcnt(0)
s_mov_b32 s8, s70
s_mov_b32 s9, s71
s_mov_b32 s10, 3670016
s_mov_b32 s11, 0x20000
s_add_u32 m0, s56, 0
s_mov_b32 s55, 0
buffer_load_dwordx4 v72, s[8:11], s55 offen nt lds
s_add_u32 m0, s56, 1024
s_mov_b32 s55, 131072
buffer_load_dwordx4 v72, s[8:11], s55 offen nt lds
s_add_u32 m0, s56, 2048
s_mov_b32 s55, 16384
buffer_load_dwordx4 v72, s[8:11], s55 offen nt lds
s_add_u32 m0, s56, 3072
s_mov_b32 s55, 147456
buffer_load_dwordx4 v72, s[8:11], s55 offen nt lds
s_add_u32 m0, s56, 16384
s_mov_b32 s55, 524288
buffer_load_dwordx4 v72, s[8:11], s55 offen nt lds
s_add_u32 m0, s56, 17408
s_mov_b32 s55, 655360
buffer_load_dwordx4 v72, s[8:11], s55 offen nt lds
s_add_u32 m0, s56, 18432
s_mov_b32 s55, 540672
buffer_load_dwordx4 v72, s[8:11], s55 offen nt lds
s_add_u32 m0, s56, 19456
s_mov_b32 s55, 671744
buffer_load_dwordx4 v72, s[8:11], s55 offen nt lds
s_add_u32 m0, s56, 32768
s_mov_b32 s55, 1048576
buffer_load_dwordx4 v72, s[8:11], s55 offen nt lds
s_add_u32 m0, s56, 33792
s_mov_b32 s55, 1179648
buffer_load_dwordx4 v72, s[8:11], s55 offen nt lds
s_add_u32 m0, s56, 34816
s_mov_b32 s55, 1064960
buffer_load_dwordx4 v72, s[8:11], s55 offen nt lds
s_add_u32 m0, s56, 35840
s_mov_b32 s55, 1196032
buffer_load_dwordx4 v72, s[8:11], s55 offen nt lds
s_add_u32 m0, s56, 49152
s_mov_b32 s55, 1572864
buffer_load_dwordx4 v72, s[8:11], s55 offen nt lds
s_add_u32 m0, s56, 50176
s_mov_b32 s55, 1703936
buffer_load_dwordx4 v72, s[8:11], s55 offen nt lds
s_add_u32 m0, s56, 51200
s_mov_b32 s55, 1589248
buffer_load_dwordx4 v72, s[8:11], s55 offen nt lds
s_add_u32 m0, s56, 52224
s_mov_b32 s55, 1720320
buffer_load_dwordx4 v72, s[8:11], s55 offen nt lds
s_add_u32 m0, s56, 65536
s_mov_b32 s55, 2097152
buffer_load_dwordx4 v72, s[8:11], s55 offen nt lds
s_add_u32 m0, s56, 66560
s_mov_b32 s55, 2228224
buffer_load_dwordx4 v72, s[8:11], s55 offen nt lds
s_add_u32 m0, s56, 67584
s_mov_b32 s55, 2113536
buffer_load_dwordx4 v72, s[8:11], s55 offen nt lds
s_add_u32 m0, s56, 68608
s_mov_b32 s55, 2244608
buffer_load_dwordx4 v72, s[8:11], s55 offen nt lds
s_add_u32 m0, s56, 81920
s_mov_b32 s55, 2621440
buffer_load_dwordx4 v72, s[8:11], s55 offen nt lds
s_add_u32 m0, s56, 82944
s_mov_b32 s55, 2752512
buffer_load_dwordx4 v72, s[8:11], s55 offen nt lds
s_add_u32 m0, s56, 83968
s_mov_b32 s55, 2637824
buffer_load_dwordx4 v72, s[8:11], s55 offen nt lds
s_add_u32 m0, s56, 84992
s_mov_b32 s55, 2768896
buffer_load_dwordx4 v72, s[8:11], s55 offen nt lds
s_add_u32 m0, s56, 98304
s_mov_b32 s55, 3145728
buffer_load_dwordx4 v72, s[8:11], s55 offen nt lds
s_add_u32 m0, s56, 99328
s_mov_b32 s55, 3276800
buffer_load_dwordx4 v72, s[8:11], s55 offen nt lds
s_add_u32 m0, s56, 100352
s_mov_b32 s55, 3162112
buffer_load_dwordx4 v72, s[8:11], s55 offen nt lds
s_add_u32 m0, s56, 101376
s_mov_b32 s55, 3293184
buffer_load_dwordx4 v72, s[8:11], s55 offen nt lds
s_mov_b32 s16, s86
s_mov_b32 s17, s87
s_mov_b32 s18, 8388608
s_mov_b32 s19, 0x20000
v_mov_b32 v48, -1
v_mov_b32 v49, -1
v_mov_b32 v50, -1
v_mov_b32 v51, -1
v_lshlrev_b32 v52, 4, v32
v_cmp_gt_u32 vcc, 32, v32
s_nop 1
v_cndmask_b32 v52, v38, v52, vcc
v_mul_u32_u24 v53, 7936, v34
v_add_u32 v53, v53, v52
s_mul_i32 s55, s3, 16384
s_lshl_b32 s57, s93, 8
s_add_u32 s55, s55, s57
buffer_store_dwordx4 v[48:51], v53, s[16:19], s55 offen sc1
s_add_u32 s57, s55, 1572864
buffer_store_dwordx4 v[48:51], v53, s[16:19], s57 offen
s_lshl_b32 s100, s2, 1
s_add_u32 s100, s100, s6
s_lshl_b32 s100, s100, 10
s_andn2_b32 s55, s100, 0x1fff
s_add_u32 s100, s100, s55
s_lshl_b32 s55, s7, 13
s_add_u32 s100, s100, s55
s_add_u32 s100, s100, 917504
s_xor_b32 s55, s100, 0x800
buffer_load_dword v62, v52, s[16:19], s55 offen sc1
s_mov_b32 s12, s72
s_mov_b32 s13, s73
s_mov_b32 s14, 3670016
s_mov_b32 s15, 0x20000
s_mov_b32 s20, s84
s_mov_b32 s21, s85
s_mov_b32 s22, 256
s_mov_b32 s23, 0x20000
s_cmp_eq_u32 s7, 0
s_cselect_b32 s24, s76, s78
s_cselect_b32 s25, s77, s79
s_mov_b32 s26, 1605632
s_mov_b32 s27, 0x20000
s_mov_b32 s32, s80
s_mov_b32 s33, s81
s_mov_b32 s34, 1605632
s_mov_b32 s35, 0x20000
s_mov_b32 s36, s64
s_mov_b32 s37, s65
s_mov_b32 s38, 3584
s_mov_b32 s39, 0x20000
s_mov_b32 s40, s82
s_mov_b32 s41, s83
s_mov_b32 s42, 3584
s_mov_b32 s43, 0x20000
s_mul_i32 s55, s2, 57344
s_lshl_b32 s57, s3, 8
s_add_u32 s55, s55, s57
v_mul_u32_u24 v75, 896, v37
v_add3_u32 v75, v75, v36, s55
s_mul_i32 s55, s4, 229376
s_lshl_b32 s57, s5, 7
s_add_u32 s55, s55, s57
s_cmp_eq_u32 s5, 7
s_cselect_b32 s55, 0x80000000, s55
v_mul_u32_u24 v73, 896, v37
v_add3_u32 v73, v73, v36, s55
s_lshl_b32 s55, s2, 7
s_mul_i32 s57, s6, 114688
s_add_u32 s55, s55, s57
v_mul_u32_u24 v74, 3584, v37
v_add3_u32 v74, v74, v36, s55
v_lshrrev_b32 v36, 5, v32
v_lshlrev_b32 v36, 10, v36
v_and_b32 v37, 31, v32
v_lshl_add_u32 v37, v37, 4, v36
v_add_u32 v77, s56, v37
s_lshl_b32 s55, s6, 13
s_lshl_b32 s57, s7, 9
s_add_u32 s55, s55, s57
v_add_u32 v76, s55, v37
v_lshl_add_u32 v36, v35, 6, v36
v_and_b32 v37, 3, v32
v_lshl_add_u32 v36, v37, 3, v36
s_lshl_b32 s55, s6, 9
s_lshl_b32 s57, s7, 5
s_add_u32 s55, s55, s57
v_add_u32 v78, s55, v36
s_lshl_b32 s6, s3, 8
v_lshlrev_b32 v35, 4, v33
v_add_u32 v35, s6, v35
v_and_b32 v36, 1, v34
v_lshl_add_u32 v36, v36, 3, v35
v_cmp_gt_u32 vcc, 896, v35
v_cmp_gt_u32 s[6:7], 2, v34
v_lshl_add_u32 v37, v34, 10, v35
v_cndmask_b32 v3, v38, v37, vcc
v_cndmask_b32 v7, v38, v36, vcc
v_cndmask_b32 v7, v38, v7, s[6:7]
buffer_load_dwordx2 v[40:41], v7, s[36:39], 0 offen offset:0
buffer_load_dwordx2 v[42:43], v7, s[36:39], 0 offen offset:896
buffer_load_dwordx2 v[44:45], v7, s[36:39], 0 offen offset:1792
buffer_load_dwordx2 v[46:47], v7, s[36:39], 0 offen offset:2688
v_add_u32 v8, 147456, v36
v_add_u32 v37, 155648, v36
v_cndmask_b32 v8, v37, v8, s[6:7]
v_lshrrev_b32 v36, 2, v32
v_lshlrev_b32 v36, 4, v36
v_and_b32 v37, 3, v33
v_lshlrev_b32 v39, 13, v37
v_cmp_gt_u32 vcc, 2, v37
s_nop 1
v_cndmask_b32 v39, v38, v39, vcc
s_lshl_b32 s6, s3, 8
v_add_u32 v37, s6, v36
v_cmp_gt_u32 vcc, 896, v37
s_lshl_b32 s6, s2, 10
s_and_b32 s7, s6, 0x6000
s_add_u32 s6, s6, s7
v_add3_u32 v37, s6, v37, v39
v_cndmask_b32 v5, v38, v37, vcc
s_lshl_b32 s6, s4, 10
s_lshl_b32 s7, s5, 7
s_add_u32 s6, s6, s7
s_lshr_b32 s7, s6, 1
v_add_u32 v37, s7, v36
s_mov_b64 vcc, 0x1111
v_cndmask_b32 v6, v38, v37, vcc
v_add_u32 v37, s6, v36
s_and_b32 s6, s6, 0x2000
v_add3_u32 v37, s6, v37, v39
s_cmp_eq_u32 s5, 7
s_cselect_b32 s7, 0, 128
v_cmp_gt_u32 vcc, s7, v36
s_nop 1
v_cndmask_b32 v4, v38, v37, vcc
s_mov_b32 s31, 32768
s_getreg_b32 s6, hwreg(HW_REG_XCC_ID, 2, 1)
s_xor_b32 s101, s6, s3
s_and_b32 s101, s101, 1
s_lshl_b32 s73, s6, 13
s_mov_b32 s70, 0
s_lshr_b32 s6, s3, 1
s_mul_i32 s6, s6, 7
s_mul_i32 s7, s4, 9216
s_and_b32 s55, s3, 1
s_lshl_b32 s55, s55, 8
s_add_u32 s55, s55, s7
v_add_u32 v35, s6, v34
v_lshlrev_b32 v35, 9, v35
v_lshl_add_u32 v35, v33, 4, v35
v_add_u32 v1, s55, v35
v_cmp_gt_u32 vcc, 3, v34
s_nop 1
v_cndmask_b32 v94, v38, v1, vcc
v_and_b32 v35, 1, v33
v_lshl_add_u32 v35, v35, 2, v34
v_min_u32 v35, 6, v35
s_sub_u32 s55, 7, s6
v_mov_b32 v36, s6
v_mov_b32 v37, s55
v_and_b32 v2, 2, v33
v_cmp_eq_u32 vcc, 0, v2
s_nop 1
v_cndmask_b32 v36, v37, v36, vcc
v_add_u32 v35, v35, v36
v_lshlrev_b32 v35, 7, v35
s_add_u32 s7, s7, 7168
v_add_u32 v2, s7, v35
v_and_b32 v35, 12, v33
v_lshl_add_u32 v2, v35, 2, v2
v_and_b32 v36, 2, v33
v_mul_u32_u24 v39, 0x5555, v36
v_add_u32 v15, 0x4444, v39
v_lshlrev_b32 v35, 5, v34
v_xor_b32 v39, 64, v35
v_lshl_add_u32 v35, v36, 3, v35
v_and_b32 v36, 1, v33
v_bfe_u32 v37, v33, 2, 1
v_cmp_eq_u32 s[6:7], 0, v37
v_mul_u32_u24 v37, 3200, v37
v_add_u32 v9, 148480, v35
v_add_u32 v9, v9, v37
v_add_u32 v37, 149504, v39
v_cmp_eq_u32 vcc, 1, v36
s_nop 1
v_cndmask_b32 v9, v9, v37, vcc
v_mul_u32_u24 v10, 640, v36
v_add3_u32 v10, v10, v35, s31
v_add_u32 v37, 151040, v39
v_cndmask_b32 v10, v37, v10, s[6:7]
v_mul_u32_u24 v36, 8256, v36
v_add_u32 v13, 150912, v35
v_add_u32 v13, v13, v36
v_lshrrev_b32 v36, 2, v33
v_lshlrev_b32 v36, 7, v36
v_sub_u32 v13, v13, v36
s_lshl_b32 s6, s3, 5
s_add_u32 s6, s6, 150912
v_mul_u32_u24 v36, 8256, v34
v_cmp_gt_u32 vcc, 2, v34
v_mov_b32 v37, 4736
s_nop 0
v_cndmask_b32 v36, v37, v36, vcc
v_lshl_add_u32 v12, v33, 1, v36
v_add_u32 v12, s6, v12
v_lshlrev_b32 v36, 6, v33
v_cmp_gt_u32 vcc, 2, v33
v_mov_b32 v37, 1280
s_nop 0
v_cndmask_b32 v36, v36, v37, vcc
v_lshl_add_u32 v11, v34, 4, v36
v_add_u32 v11, 147328, v11
v_lshlrev_b32 v39, 4, v32
v_add_u32 v39, 147456, v39
v_mov_b32 v7, v15
s_mov_b32 s80, 0x100000
s_mov_b32 s81, 0x10000100
s_mov_b32 s82, 0x200000
s_mov_b32 s83, 0x20000200
s_mov_b32 s84, 0x400004
s_mov_b32 s85, 0x40000400
s_mov_b32 s86, 0x800008
s_mov_b32 s87, 0x80000800
s_mov_b32 s28, 0xfffc
s_mov_b32 s29, 0
s_lshr_b32 s30, s3, 1
s_lshl_b32 s30, s30, 7
s_add_u32 s30, s30, 4294852608
v_and_b32 v35, 1, v33
v_mov_b32 v36, 0xffff
v_lshlrev_b32 v35, 4, v35
v_lshlrev_b32 v36, v35, v36
v_bfe_u32 v35, v33, 1, 2
v_cmp_eq_u32 vcc, 0, v35
s_nop 1
v_cndmask_b32 v16, 0, v36, vcc
v_and_b32 v20, 0x3f803f80, v16
v_cmp_eq_u32 vcc, 1, v35
s_nop 1
v_cndmask_b32 v17, 0, v36, vcc
v_and_b32 v21, 0x3f803f80, v17
v_cmp_eq_u32 vcc, 2, v35
s_nop 1
v_cndmask_b32 v18, 0, v36, vcc
v_and_b32 v22, 0x3f803f80, v18
v_cmp_eq_u32 vcc, 3, v35
s_nop 1
v_cndmask_b32 v19, 0, v36, vcc
v_and_b32 v23, 0x3f803f80, v19
s_getreg_b32 s55, hwreg(HW_REG_XCC_ID, 0, 3)
s_mul_i32 s57, s55, s55
s_lshl_b32 s57, s57, 8
s_add_u32 s55, s55, s57
s_lshl_b32 s55, s55, 8
s_add_u32 s90, s55, 1
s_mov_b32 s60, -1
s_mov_b32 s61, 0x5555ffff
s_mov_b32 s98, 0
s_mov_b32 s99, 0
s_mov_b32 s59, 0
s_mov_b32 s63, 0
s_mov_b32 s54, 100000
s_mov_b32 s52, 605790414
s_mov_b32 s53, 1012613
s_cmp_ge_u32 s2, 28
s_cmov_b32 s52, 840671438
s_cmov_b32 s53, 4055
v_mov_b32 v52, 0x3f803f80
v_mov_b32 v56, 0
v_mov_b32 v53, 0x3f803f80
v_mov_b32 v57, 0
v_mov_b32 v54, 0x3f803f80
v_mov_b32 v58, 0
v_mov_b32 v55, 0x3f803f80
v_mov_b32 v59, 0
ds_write_b128 v39, v[52:55] offset:2048
ds_write_b128 v39, v[56:59] offset:3072
ds_write_b128 v39, v[56:59] offset:11264
v_add_u32 v79, 0, v76
s_waitcnt vmcnt(31)
s_waitcnt lgkmcnt(0)
s_barrier
ds_read_b64_tr_b16 a[0:1], v79 offset:0
ds_read_b64_tr_b16 a[8:9], v79 offset:8
ds_read_b64_tr_b16 a[2:3], v79 offset:2048
ds_read_b64_tr_b16 a[10:11], v79 offset:2056
ds_read_b64_tr_b16 a[4:5], v79 offset:4096
ds_read_b64_tr_b16 a[12:13], v79 offset:4104
ds_read_b64_tr_b16 a[6:7], v79 offset:6144
ds_read_b64_tr_b16 a[14:15], v79 offset:6152
v_add_u32 v79, 16384, v76
s_waitcnt vmcnt(27)
s_waitcnt lgkmcnt(0)
s_barrier
ds_read_b64_tr_b16 a[16:17], v79 offset:0
ds_read_b64_tr_b16 a[24:25], v79 offset:8
ds_read_b64_tr_b16 a[18:19], v79 offset:2048
ds_read_b64_tr_b16 a[26:27], v79 offset:2056
ds_read_b64_tr_b16 a[20:21], v79 offset:4096
ds_read_b64_tr_b16 a[28:29], v79 offset:4104
ds_read_b64_tr_b16 a[22:23], v79 offset:6144
ds_read_b64_tr_b16 a[30:31], v79 offset:6152
v_add_u32 v79, 32768, v76
s_waitcnt vmcnt(23)
s_waitcnt lgkmcnt(0)
s_barrier
ds_read_b64_tr_b16 a[32:33], v79 offset:0
ds_read_b64_tr_b16 a[40:41], v79 offset:8
ds_read_b64_tr_b16 a[34:35], v79 offset:2048
ds_read_b64_tr_b16 a[42:43], v79 offset:2056
ds_read_b64_tr_b16 a[36:37], v79 offset:4096
ds_read_b64_tr_b16 a[44:45], v79 offset:4104
ds_read_b64_tr_b16 a[38:39], v79 offset:6144
ds_read_b64_tr_b16 a[46:47], v79 offset:6152
v_add_u32 v79, 49152, v76
s_waitcnt vmcnt(19)
s_waitcnt lgkmcnt(0)
s_barrier
ds_read_b64_tr_b16 a[48:49], v79 offset:0
ds_read_b64_tr_b16 a[56:57], v79 offset:8
ds_read_b64_tr_b16 a[50:51], v79 offset:2048
ds_read_b64_tr_b16 a[58:59], v79 offset:2056
ds_read_b64_tr_b16 a[52:53], v79 offset:4096
ds_read_b64_tr_b16 a[60:61], v79 offset:4104
ds_read_b64_tr_b16 a[54:55], v79 offset:6144
ds_read_b64_tr_b16 a[62:63], v79 offset:6152
v_add_u32 v79, 65536, v76
s_waitcnt vmcnt(15)
s_waitcnt lgkmcnt(0)
s_barrier
ds_read_b64_tr_b16 a[64:65], v79 offset:0
ds_read_b64_tr_b16 a[72:73], v79 offset:8
ds_read_b64_tr_b16 a[66:67], v79 offset:2048
ds_read_b64_tr_b16 a[74:75], v79 offset:2056
ds_read_b64_tr_b16 a[68:69], v79 offset:4096
ds_read_b64_tr_b16 a[76:77], v79 offset:4104
ds_read_b64_tr_b16 a[70:71], v79 offset:6144
ds_read_b64_tr_b16 a[78:79], v79 offset:6152
v_add_u32 v79, 81920, v76
s_waitcnt vmcnt(11)
s_waitcnt lgkmcnt(0)
s_barrier
ds_read_b64_tr_b16 a[80:81], v79 offset:0
ds_read_b64_tr_b16 a[88:89], v79 offset:8
ds_read_b64_tr_b16 a[82:83], v79 offset:2048
ds_read_b64_tr_b16 a[90:91], v79 offset:2056
ds_read_b64_tr_b16 a[84:85], v79 offset:4096
ds_read_b64_tr_b16 a[92:93], v79 offset:4104
ds_read_b64_tr_b16 a[86:87], v79 offset:6144
ds_read_b64_tr_b16 a[94:95], v79 offset:6152
v_add_u32 v79, 98304, v76
s_waitcnt vmcnt(7)
s_waitcnt lgkmcnt(0)
s_barrier
ds_read_b64_tr_b16 a[96:97], v79 offset:0
ds_read_b64_tr_b16 a[104:105], v79 offset:8
ds_read_b64_tr_b16 a[98:99], v79 offset:2048
ds_read_b64_tr_b16 a[106:107], v79 offset:2056
ds_read_b64_tr_b16 a[100:101], v79 offset:4096
ds_read_b64_tr_b16 a[108:109], v79 offset:4104
ds_read_b64_tr_b16 a[102:103], v79 offset:6144
ds_read_b64_tr_b16 a[110:111], v79 offset:6152
s_waitcnt vmcnt(3)
ds_write_b64 v8, v[40:41] offset:4096
s_waitcnt vmcnt(2)
ds_write_b64 v8, v[42:43] offset:5120
s_waitcnt vmcnt(1)
ds_write_b64 v8, v[44:45] offset:6144
s_waitcnt vmcnt(0)
ds_write_b64 v8, v[46:47] offset:7168
s_waitcnt lgkmcnt(0)
s_barrier
s_cmp_lg_u32 s3, 0
s_cbranch_scc1 L_c_noat
v_mov_b32 v35, s90
v_cmp_eq_u32 vcc, 0, v32
s_nop 1
v_cndmask_b32 v36, v38, v32, vcc
s_lshl_b32 s55, s96, 4
buffer_atomic_add v35, v36, s[20:23], s55 offen sc1
L_c_noat:
s_mov_b32 s58, 0
s_nop 0
s_branch L_initjob
L_stage2a:
s_mov_b32 s55, 131072
buffer_load_dword v32, v4, s[16:19], s55 offen sc1
s_mov_b32 s55, 163840
buffer_load_dword v33, v4, s[16:19], s55 offen sc1
s_mov_b32 s55, 196608
buffer_load_dword v34, v4, s[16:19], s55 offen sc1
s_mov_b32 s55, 229376
buffer_load_dword v35, v4, s[16:19], s55 offen sc1
s_mov_b32 s55, 262144
buffer_load_dword v36, v4, s[16:19], s55 offen sc1
s_mov_b32 s55, 294912
buffer_load_dword v37, v4, s[16:19], s55 offen sc1
s_mov_b32 s55, 327680
buffer_load_dword v38, v4, s[16:19], s55 offen sc1
s_mov_b32 s55, 360448
buffer_load_dword v39, v4, s[16:19], s55 offen sc1
s_mov_b32 s55, 393216
buffer_load_dword v40, v5, s[16:19], s55 offen sc1
s_mov_b32 s55, 458752
buffer_load_dword v41, v5, s[16:19], s55 offen sc1
s_mov_b32 s55, 524288
buffer_load_dword v42, v5, s[16:19], s55 offen sc1
s_mov_b32 s55, 589824
buffer_load_dword v43, v5, s[16:19], s55 offen sc1
s_mov_b32 s55, 655360
buffer_load_dword v44, v5, s[16:19], s55 offen sc1
s_mov_b32 s55, 720896
buffer_load_dword v45, v5, s[16:19], s55 offen sc1
s_mov_b32 s55, 786432
buffer_load_dword v46, v5, s[16:19], s55 offen sc1
s_mov_b32 s55, 851968
buffer_load_dword v47, v5, s[16:19], s55 offen sc1
s_mov_b32 s55, 1048576
buffer_load_dword v48, v2, s[16:19], s55 offen sc1
buffer_load_dword v49, v1, s[16:19], s55 offen sc1
buffer_load_dword v50, v94, s[16:19], s55 offen offset:2048 sc1
s_mov_b32 s55, 1196032
buffer_load_dword v51, v2, s[16:19], s55 offen sc1
buffer_load_dword v52, v1, s[16:19], s55 offen sc1
buffer_load_dword v53, v94, s[16:19], s55 offen offset:2048 sc1
s_add_u32 m0, s56, 114688
s_mov_b32 s55, 0
buffer_load_dwordx4 v73, s[12:15], s55 offen nt lds
s_add_u32 m0, s56, 115712
s_mov_b32 s55, 14336
buffer_load_dwordx4 v73, s[12:15], s55 offen nt lds
s_add_u32 m0, s56, 116736
s_mov_b32 s55, 1792
buffer_load_dwordx4 v73, s[12:15], s55 offen nt lds
s_add_u32 m0, s56, 117760
s_mov_b32 s55, 16128
buffer_load_dwordx4 v73, s[12:15], s55 offen nt lds
s_add_u32 m0, s56, 131072
s_mov_b32 s55, 28672
buffer_load_dwordx4 v73, s[12:15], s55 offen nt lds
s_add_u32 m0, s56, 132096
s_mov_b32 s55, 43008
buffer_load_dwordx4 v73, s[12:15], s55 offen nt lds
s_add_u32 m0, s56, 133120
s_mov_b32 s55, 30464
buffer_load_dwordx4 v73, s[12:15], s55 offen nt lds
s_add_u32 m0, s56, 134144
s_mov_b32 s55, 44800
buffer_load_dwordx4 v73, s[12:15], s55 offen nt lds
v_and_b32 v88, 0xfc, v0
v_add_u32 v88, 147456, v88
v_and_b32 v31, 63, v0
s_mov_b32 s64, 0x0c0c0602
s_mov_b32 s65, 0x0c0c0703
s_waitcnt vmcnt(14)
v_alignbit_b32 v24, v32, 0, 1
v_alignbit_b32 v24, v33, v24, 1
v_alignbit_b32 v24, v34, v24, 1
v_alignbit_b32 v24, v35, v24, 1
v_alignbit_b32 v24, v36, v24, 1
v_alignbit_b32 v24, v37, v24, 1
v_alignbit_b32 v24, v38, v24, 1
v_alignbit_b32 v24, v39, v24, 1
v_alignbit_b32 v24, v40, v24, 1
v_alignbit_b32 v24, v41, v24, 1
v_alignbit_b32 v24, v42, v24, 1
v_alignbit_b32 v24, v43, v24, 1
v_alignbit_b32 v24, v44, v24, 1
v_alignbit_b32 v24, v45, v24, 1
v_alignbit_b32 v24, v46, v24, 1
v_alignbit_b32 v24, v47, v24, 1
v_not_b32 v24, v24
s_nop 1
v_mov_b32_dpp v30, v24 quad_perm:[1,1,1,1] row_mask:0xf bank_mask:0xf
v_perm_b32 v89, v30, v24, s64
v_perm_b32 v90, v30, v24, s65
s_mov_b32 exec_lo, 0x11111111
s_mov_b32 exec_hi, 0x11111111
ds_write_b32 v88, v89
ds_write_b32 v88, v90 offset:256
s_mov_b64 exec, -1
s_lshl_b32 s64, s93, 8
s_lshl_b32 s65, s2, 8
s_add_u32 s65, s65, 7936
v_mov_b32 v89, s64
v_mov_b32 v90, s65
v_cmp_gt_u32 vcc, 16, v31
s_nop 1
v_cndmask_b32 v89, v90, v89, vcc
v_lshl_add_u32 v89, v31, 4, v89
v_lshlrev_b32 v90, 4, v31
v_add_u32 v90, 147456, v90
s_cmp_eq_u32 s3, 0
s_cselect_b32 s71, 0, 0x40000000
s_add_u32 s57, s71, 1703936
s_waitcnt lgkmcnt(0)
s_barrier
ds_read_b128 v[32:35], v90 offset:0
v_mov_b32_dpp v30, v24 quad_perm:[0,1,0,1] row_mask:0xf bank_mask:0xf
v_lshlrev_b32 v30, 1, v30
s_mov_b32 s64, 0xcccccccc
s_mov_b32 s65, 0xcccccccc
v_cndmask_b32 v24, v24, v30, s[64:65]
s_mov_b64 exec, 0xffffffff
s_waitcnt lgkmcnt(0)
buffer_store_dwordx4 v[32:35], v89, s[16:19], s57 offen sc1
s_mov_b64 exec, -1
s_add_u32 m0, s56, 0
s_mov_b32 s55, 57344
buffer_load_dwordx4 v73, s[12:15], s55 offen nt lds
s_add_u32 m0, s56, 1024
s_mov_b32 s55, 71680
buffer_load_dwordx4 v73, s[12:15], s55 offen nt lds
s_add_u32 m0, s56, 2048
s_mov_b32 s55, 59136
buffer_load_dwordx4 v73, s[12:15], s55 offen nt lds
s_add_u32 m0, s56, 3072
s_mov_b32 s55, 73472
buffer_load_dwordx4 v73, s[12:15], s55 offen nt lds
s_add_u32 m0, s56, 16384
s_mov_b32 s55, 86016
buffer_load_dwordx4 v73, s[12:15], s55 offen nt lds
s_add_u32 m0, s56, 17408
s_mov_b32 s55, 100352
buffer_load_dwordx4 v73, s[12:15], s55 offen nt lds
s_add_u32 m0, s56, 18432
s_mov_b32 s55, 87808
buffer_load_dwordx4 v73, s[12:15], s55 offen nt lds
s_add_u32 m0, s56, 19456
s_mov_b32 s55, 102144
buffer_load_dwordx4 v73, s[12:15], s55 offen nt lds
s_add_u32 m0, s56, 32768
s_mov_b32 s55, 114688
buffer_load_dwordx4 v73, s[12:15], s55 offen nt lds
s_add_u32 m0, s56, 33792
s_mov_b32 s55, 129024
buffer_load_dwordx4 v73, s[12:15], s55 offen nt lds
s_add_u32 m0, s56, 34816
s_mov_b32 s55, 116480
buffer_load_dwordx4 v73, s[12:15], s55 offen nt lds
s_add_u32 m0, s56, 35840
s_mov_b32 s55, 130816
buffer_load_dwordx4 v73, s[12:15], s55 offen nt lds
s_add_u32 m0, s56, 49152
s_mov_b32 s55, 143360
buffer_load_dwordx4 v73, s[12:15], s55 offen nt lds
s_add_u32 m0, s56, 50176
s_mov_b32 s55, 157696
buffer_load_dwordx4 v73, s[12:15], s55 offen nt lds
s_add_u32 m0, s56, 51200
s_mov_b32 s55, 145152
buffer_load_dwordx4 v73, s[12:15], s55 offen nt lds
s_add_u32 m0, s56, 52224
s_mov_b32 s55, 159488
buffer_load_dwordx4 v73, s[12:15], s55 offen nt lds
s_add_u32 m0, s56, 65536
s_mov_b32 s55, 172032
buffer_load_dwordx4 v73, s[12:15], s55 offen nt lds
s_add_u32 m0, s56, 66560
s_mov_b32 s55, 186368
buffer_load_dwordx4 v73, s[12:15], s55 offen nt lds
s_add_u32 m0, s56, 67584
s_mov_b32 s55, 173824
buffer_load_dwordx4 v73, s[12:15], s55 offen nt lds
s_add_u32 m0, s56, 68608
s_mov_b32 s55, 188160
buffer_load_dwordx4 v73, s[12:15], s55 offen nt lds
s_add_u32 m0, s56, 81920
s_mov_b32 s55, 200704
buffer_load_dwordx4 v73, s[12:15], s55 offen nt lds
s_add_u32 m0, s56, 82944
s_mov_b32 s55, 215040
buffer_load_dwordx4 v73, s[12:15], s55 offen nt lds
s_add_u32 m0, s56, 83968
s_mov_b32 s55, 202496
buffer_load_dwordx4 v73, s[12:15], s55 offen nt lds
s_add_u32 m0, s56, 84992
s_mov_b32 s55, 216832
buffer_load_dwordx4 v73, s[12:15], s55 offen nt lds
s_waitcnt vmcnt(38)
v_alignbit_b32 v15, v48, 0, 1
s_waitcnt vmcnt(37)
v_alignbit_b32 v15, v49, v15, 1
s_waitcnt vmcnt(36)
v_alignbit_b32 v15, v50, v15, 1
s_waitcnt vmcnt(35)
v_alignbit_b32 v15, v51, v15, 1
s_waitcnt vmcnt(34)
v_alignbit_b32 v15, v52, v15, 1
s_waitcnt vmcnt(33)
v_alignbit_b32 v15, v53, v15, 1
s_waitcnt vmcnt(24)
v_mov_b32 v31, 1
s_mov_b64 exec, 1
buffer_atomic_add v31, off, s[20:23], s71 offset:128 sc1
s_mov_b64 exec, -1
s_mov_b32 s58, 1
s_nop 0
s_branch L_initjob
L_stage2:
v_bfe_u32 v30, v0, 4, 2
v_and_b32 v31, 15, v0
v_lshlrev_b32 v90, 8, v30
v_lshl_add_u32 v90, v31, 2, v90
v_and_b32 v89, 8, v0
v_lshl_add_u32 v89, v89, 2, v90
v_lshl_add_u32 v89, v30, 8, v89
s_lshl_b32 s64, s3, 7
s_add_u32 s64, s64, 1703936
s_add_u32 s65, s64, 4096
s_lshl_b32 s66, s3, 6
s_add_u32 s66, s66, 1712128
s_add_u32 s67, s66, 4096
v_add_u32 v79, 114688, v77
s_barrier
ds_read_b64_tr_b16 a[112:113], v79 offset:0
ds_read_b64_tr_b16 a[120:121], v79 offset:8
ds_read_b64_tr_b16 a[128:129], v79 offset:512
ds_read_b64_tr_b16 a[136:137], v79 offset:520
ds_read_b64_tr_b16 a[114:115], v79 offset:2048
ds_read_b64_tr_b16 a[122:123], v79 offset:2056
ds_read_b64_tr_b16 a[130:131], v79 offset:2560
ds_read_b64_tr_b16 a[138:139], v79 offset:2568
s_add_u32 m0, s56, 98304
s_mov_b32 s55, 0
buffer_load_dwordx4 v74, s[24:27], s55 offen nt lds
s_add_u32 m0, s56, 99328
s_mov_b32 s55, 57344
buffer_load_dwordx4 v74, s[24:27], s55 offen nt lds
s_add_u32 m0, s56, 100352
s_mov_b32 s55, 7168
buffer_load_dwordx4 v74, s[24:27], s55 offen nt lds
s_add_u32 m0, s56, 101376
s_mov_b32 s55, 64512
buffer_load_dwordx4 v74, s[24:27], s55 offen nt lds
v_add_u32 v79, 131072, v77
s_waitcnt lgkmcnt(0)
s_barrier
ds_read_b64_tr_b16 a[116:117], v79 offset:0
ds_read_b64_tr_b16 a[124:125], v79 offset:8
ds_read_b64_tr_b16 a[132:133], v79 offset:512
ds_read_b64_tr_b16 a[140:141], v79 offset:520
ds_read_b64_tr_b16 a[118:119], v79 offset:2048
ds_read_b64_tr_b16 a[126:127], v79 offset:2056
ds_read_b64_tr_b16 a[134:135], v79 offset:2560
ds_read_b64_tr_b16 a[142:143], v79 offset:2568
s_add_u32 m0, s56, 114688
s_mov_b32 s55, 229376
buffer_load_dwordx4 v74, s[24:27], s55 offen nt lds
s_add_u32 m0, s56, 115712
s_mov_b32 s55, 286720
buffer_load_dwordx4 v74, s[24:27], s55 offen nt lds
s_add_u32 m0, s56, 116736
s_mov_b32 s55, 236544
buffer_load_dwordx4 v74, s[24:27], s55 offen nt lds
s_add_u32 m0, s56, 117760
s_mov_b32 s55, 293888
buffer_load_dwordx4 v74, s[24:27], s55 offen nt lds
v_add_u32 v79, 0, v77
s_waitcnt vmcnt(29)
s_waitcnt lgkmcnt(0)
s_barrier
ds_read_b64_tr_b16 a[144:145], v79 offset:0
ds_read_b64_tr_b16 a[152:153], v79 offset:8
ds_read_b64_tr_b16 a[160:161], v79 offset:512
ds_read_b64_tr_b16 a[168:169], v79 offset:520
ds_read_b64_tr_b16 a[146:147], v79 offset:2048
ds_read_b64_tr_b16 a[154:155], v79 offset:2056
ds_read_b64_tr_b16 a[162:163], v79 offset:2560
ds_read_b64_tr_b16 a[170:171], v79 offset:2568
s_add_u32 m0, s56, 131072
s_mov_b32 s55, 458752
buffer_load_dwordx4 v74, s[24:27], s55 offen nt lds
s_add_u32 m0, s56, 132096
s_mov_b32 s55, 516096
buffer_load_dwordx4 v74, s[24:27], s55 offen nt lds
s_add_u32 m0, s56, 133120
s_mov_b32 s55, 465920
buffer_load_dwordx4 v74, s[24:27], s55 offen nt lds
s_add_u32 m0, s56, 134144
s_mov_b32 s55, 523264
buffer_load_dwordx4 v74, s[24:27], s55 offen nt lds
v_add_u32 v79, 16384, v77
s_waitcnt vmcnt(29)
s_waitcnt lgkmcnt(0)
s_barrier
ds_read_b64_tr_b16 a[148:149], v79 offset:0
ds_read_b64_tr_b16 a[156:157], v79 offset:8
ds_read_b64_tr_b16 a[164:165], v79 offset:512
ds_read_b64_tr_b16 a[172:173], v79 offset:520
ds_read_b64_tr_b16 a[150:151], v79 offset:2048
ds_read_b64_tr_b16 a[158:159], v79 offset:2056
ds_read_b64_tr_b16 a[166:167], v79 offset:2560
ds_read_b64_tr_b16 a[174:175], v79 offset:2568
s_add_u32 m0, s56, 0
s_mov_b32 s55, 688128
buffer_load_dwordx4 v74, s[24:27], s55 offen nt lds
s_add_u32 m0, s56, 1024
s_mov_b32 s55, 745472
buffer_load_dwordx4 v74, s[24:27], s55 offen nt lds
s_add_u32 m0, s56, 2048
s_mov_b32 s55, 695296
buffer_load_dwordx4 v74, s[24:27], s55 offen nt lds
s_add_u32 m0, s56, 3072
s_mov_b32 s55, 752640
buffer_load_dwordx4 v74, s[24:27], s55 offen nt lds
v_add_u32 v79, 32768, v77
s_waitcnt vmcnt(29)
s_waitcnt lgkmcnt(0)
s_barrier
ds_read_b64_tr_b16 a[176:177], v79 offset:0
ds_read_b64_tr_b16 a[184:185], v79 offset:8
ds_read_b64_tr_b16 a[192:193], v79 offset:512
ds_read_b64_tr_b16 a[200:201], v79 offset:520
ds_read_b64_tr_b16 a[178:179], v79 offset:2048
ds_read_b64_tr_b16 a[186:187], v79 offset:2056
ds_read_b64_tr_b16 a[194:195], v79 offset:2560
ds_read_b64_tr_b16 a[202:203], v79 offset:2568
s_add_u32 m0, s56, 16384
s_mov_b32 s55, 917504
buffer_load_dwordx4 v74, s[24:27], s55 offen nt lds
s_add_u32 m0, s56, 17408
s_mov_b32 s55, 974848
buffer_load_dwordx4 v74, s[24:27], s55 offen nt lds
s_add_u32 m0, s56, 18432
s_mov_b32 s55, 924672
buffer_load_dwordx4 v74, s[24:27], s55 offen nt lds
s_add_u32 m0, s56, 19456
s_mov_b32 s55, 982016
buffer_load_dwordx4 v74, s[24:27], s55 offen nt lds
v_add_u32 v79, 49152, v77
s_waitcnt vmcnt(29)
s_waitcnt lgkmcnt(0)
s_barrier
ds_read_b64_tr_b16 a[180:181], v79 offset:0
ds_read_b64_tr_b16 a[188:189], v79 offset:8
ds_read_b64_tr_b16 a[196:197], v79 offset:512
ds_read_b64_tr_b16 a[204:205], v79 offset:520
ds_read_b64_tr_b16 a[182:183], v79 offset:2048
ds_read_b64_tr_b16 a[190:191], v79 offset:2056
ds_read_b64_tr_b16 a[198:199], v79 offset:2560
ds_read_b64_tr_b16 a[206:207], v79 offset:2568
s_add_u32 m0, s56, 32768
s_mov_b32 s55, 1146880
buffer_load_dwordx4 v74, s[24:27], s55 offen nt lds
s_add_u32 m0, s56, 33792
s_mov_b32 s55, 1204224
buffer_load_dwordx4 v74, s[24:27], s55 offen nt lds
s_add_u32 m0, s56, 34816
s_mov_b32 s55, 1154048
buffer_load_dwordx4 v74, s[24:27], s55 offen nt lds
s_add_u32 m0, s56, 35840
s_mov_b32 s55, 1211392
buffer_load_dwordx4 v74, s[24:27], s55 offen nt lds
v_add_u32 v79, 65536, v77
s_waitcnt vmcnt(29)
s_waitcnt lgkmcnt(0)
s_barrier
ds_read_b64_tr_b16 a[208:209], v79 offset:0
ds_read_b64_tr_b16 a[216:217], v79 offset:8
ds_read_b64_tr_b16 a[224:225], v79 offset:512
ds_read_b64_tr_b16 a[232:233], v79 offset:520
ds_read_b64_tr_b16 a[210:211], v79 offset:2048
ds_read_b64_tr_b16 a[218:219], v79 offset:2056
ds_read_b64_tr_b16 a[226:227], v79 offset:2560
ds_read_b64_tr_b16 a[234:235], v79 offset:2568
s_add_u32 m0, s56, 49152
s_mov_b32 s55, 1376256
buffer_load_dwordx4 v74, s[24:27], s55 offen nt lds
s_add_u32 m0, s56, 50176
s_mov_b32 s55, 1433600
buffer_load_dwordx4 v74, s[24:27], s55 offen nt lds
s_add_u32 m0, s56, 51200
s_mov_b32 s55, 1383424
buffer_load_dwordx4 v74, s[24:27], s55 offen nt lds
s_add_u32 m0, s56, 52224
s_mov_b32 s55, 1440768
buffer_load_dwordx4 v74, s[24:27], s55 offen nt lds
v_add_u32 v79, 81920, v77
s_waitcnt vmcnt(29)
s_waitcnt lgkmcnt(0)
s_barrier
ds_read_b64_tr_b16 a[212:213], v79 offset:0
ds_read_b64_tr_b16 a[220:221], v79 offset:8
ds_read_b64_tr_b16 a[228:229], v79 offset:512
ds_read_b64_tr_b16 a[236:237], v79 offset:520
ds_read_b64_tr_b16 a[214:215], v79 offset:2048
ds_read_b64_tr_b16 a[222:223], v79 offset:2056
ds_read_b64_tr_b16 a[230:231], v79 offset:2560
ds_read_b64_tr_b16 a[238:239], v79 offset:2568
s_add_u32 m0, s56, 65536
s_mov_b32 s55, 0
buffer_load_dwordx4 v75, s[32:35], s55 offen nt lds
s_add_u32 m0, s56, 66560
s_mov_b32 s55, 14336
buffer_load_dwordx4 v75, s[32:35], s55 offen nt lds
s_add_u32 m0, s56, 67584
s_mov_b32 s55, 1792
buffer_load_dwordx4 v75, s[32:35], s55 offen nt lds
s_add_u32 m0, s56, 68608
s_mov_b32 s55, 16128
buffer_load_dwordx4 v75, s[32:35], s55 offen nt lds
s_cmp_lt_u32 s2, 28
s_cbranch_scc1 L_st_go
buffer_load_dword v30, off, s[20:23], 0 offset:128 sc1
s_waitcnt vmcnt(0) lgkmcnt(0)
s_branch L_st_done
L_st_go:
v_add_u32 v79, 98304, v78
s_waitcnt vmcnt(28)
s_waitcnt lgkmcnt(0)
s_barrier
ds_read_b64_tr_b16 a[240:241], v79 offset:0
ds_read_b64_tr_b16 a[242:243], v79 offset:2048
ds_read_b64_tr_b16 a[248:249], v79 offset:4096
ds_read_b64_tr_b16 a[250:251], v79 offset:6144
ds_read_b64_tr_b16 a[244:245], v79 offset:8192
ds_read_b64_tr_b16 a[246:247], v79 offset:10240
ds_read_b64_tr_b16 a[252:253], v79 offset:12288
ds_read_b64_tr_b16 a[254:255], v79 offset:14336
s_add_u32 m0, s56, 81920
s_mov_b32 s55, 128
buffer_load_dwordx4 v75, s[32:35], s55 offen nt lds
s_add_u32 m0, s56, 82944
s_mov_b32 s55, 14464
buffer_load_dwordx4 v75, s[32:35], s55 offen nt lds
s_add_u32 m0, s56, 83968
s_mov_b32 s55, 1920
buffer_load_dwordx4 v75, s[32:35], s55 offen nt lds
s_add_u32 m0, s56, 84992
s_mov_b32 s55, 16256
buffer_load_dwordx4 v75, s[32:35], s55 offen nt lds
v_add_u32 v79, 114688, v78
s_waitcnt vmcnt(28)
s_waitcnt lgkmcnt(0)
s_barrier
ds_read_b64_tr_b16 v[96:97], v79 offset:0
ds_read_b64_tr_b16 v[98:99], v79 offset:2048
ds_read_b64_tr_b16 v[104:105], v79 offset:4096
ds_read_b64_tr_b16 v[106:107], v79 offset:6144
ds_read_b64_tr_b16 v[100:101], v79 offset:8192
ds_read_b64_tr_b16 v[102:103], v79 offset:10240
ds_read_b64_tr_b16 v[108:109], v79 offset:12288
ds_read_b64_tr_b16 v[110:111], v79 offset:14336
s_add_u32 m0, s56, 98304
s_mov_b32 s55, 28672
buffer_load_dwordx4 v75, s[32:35], s55 offen nt lds
s_add_u32 m0, s56, 99328
s_mov_b32 s55, 43008
buffer_load_dwordx4 v75, s[32:35], s55 offen nt lds
s_add_u32 m0, s56, 100352
s_mov_b32 s55, 30464
buffer_load_dwordx4 v75, s[32:35], s55 offen nt lds
s_add_u32 m0, s56, 101376
s_mov_b32 s55, 44800
buffer_load_dwordx4 v75, s[32:35], s55 offen nt lds
v_add_u32 v79, 131072, v78
s_waitcnt vmcnt(28)
s_waitcnt lgkmcnt(0)
s_barrier
ds_read_b64_tr_b16 v[112:113], v79 offset:0
ds_read_b64_tr_b16 v[114:115], v79 offset:2048
ds_read_b64_tr_b16 v[120:121], v79 offset:4096
ds_read_b64_tr_b16 v[122:123], v79 offset:6144
ds_read_b64_tr_b16 v[116:117], v79 offset:8192
ds_read_b64_tr_b16 v[118:119], v79 offset:10240
ds_read_b64_tr_b16 v[124:125], v79 offset:12288
ds_read_b64_tr_b16 v[126:127], v79 offset:14336
s_add_u32 m0, s56, 114688
s_mov_b32 s55, 28800
buffer_load_dwordx4 v75, s[32:35], s55 offen nt lds
s_add_u32 m0, s56, 115712
s_mov_b32 s55, 43136
buffer_load_dwordx4 v75, s[32:35], s55 offen nt lds
s_add_u32 m0, s56, 116736
s_mov_b32 s55, 30592
buffer_load_dwordx4 v75, s[32:35], s55 offen nt lds
s_add_u32 m0, s56, 117760
s_mov_b32 s55, 44928
buffer_load_dwordx4 v75, s[32:35], s55 offen nt lds
buffer_load_dword v30, off, s[20:23], 0 offset:128 sc1
v_add_u32 v79, 0, v78
s_waitcnt vmcnt(29)
s_waitcnt lgkmcnt(0)
s_barrier
ds_read_b64_tr_b16 v[128:129], v79 offset:0
ds_read_b64_tr_b16 v[130:131], v79 offset:2048
ds_read_b64_tr_b16 v[136:137], v79 offset:4096
ds_read_b64_tr_b16 v[138:139], v79 offset:6144
ds_read_b64_tr_b16 v[132:133], v79 offset:8192
ds_read_b64_tr_b16 v[134:135], v79 offset:10240
ds_read_b64_tr_b16 v[140:141], v79 offset:12288
ds_read_b64_tr_b16 v[142:143], v79 offset:14336
v_add_u32 v79, 16384, v78
s_waitcnt vmcnt(25)
s_waitcnt lgkmcnt(0)
s_barrier
ds_read_b64_tr_b16 v[144:145], v79 offset:0
ds_read_b64_tr_b16 v[146:147], v79 offset:2048
ds_read_b64_tr_b16 v[152:153], v79 offset:4096
ds_read_b64_tr_b16 v[154:155], v79 offset:6144
ds_read_b64_tr_b16 v[148:149], v79 offset:8192
ds_read_b64_tr_b16 v[150:151], v79 offset:10240
ds_read_b64_tr_b16 v[156:157], v79 offset:12288
ds_read_b64_tr_b16 v[158:159], v79 offset:14336
v_add_u32 v79, 32768, v78
s_waitcnt vmcnt(21)
s_waitcnt lgkmcnt(0)
s_barrier
ds_read_b64_tr_b16 v[160:161], v79 offset:0
ds_read_b64_tr_b16 v[162:163], v79 offset:2048
ds_read_b64_tr_b16 v[168:169], v79 offset:4096
ds_read_b64_tr_b16 v[170:171], v79 offset:6144
ds_read_b64_tr_b16 v[164:165], v79 offset:8192
ds_read_b64_tr_b16 v[166:167], v79 offset:10240
ds_read_b64_tr_b16 v[172:173], v79 offset:12288
ds_read_b64_tr_b16 v[174:175], v79 offset:14336
v_add_u32 v79, 49152, v78
s_waitcnt vmcnt(17)
s_waitcnt lgkmcnt(0)
s_barrier
ds_read_b64_tr_b16 v[176:177], v79 offset:0
ds_read_b64_tr_b16 v[178:179], v79 offset:2048
ds_read_b64_tr_b16 v[184:185], v79 offset:4096
ds_read_b64_tr_b16 v[186:187], v79 offset:6144
ds_read_b64_tr_b16 v[180:181], v79 offset:8192
ds_read_b64_tr_b16 v[182:183], v79 offset:10240
ds_read_b64_tr_b16 v[188:189], v79 offset:12288
ds_read_b64_tr_b16 v[190:191], v79 offset:14336
v_add_u32 v79, 65536, v77
s_waitcnt vmcnt(13)
s_waitcnt lgkmcnt(0)
s_barrier
ds_read_b64_tr_b16 v[192:193], v79 offset:0
ds_read_b64_tr_b16 v[200:201], v79 offset:8
ds_read_b64_tr_b16 v[208:209], v79 offset:512
ds_read_b64_tr_b16 v[216:217], v79 offset:520
ds_read_b64_tr_b16 v[194:195], v79 offset:2048
ds_read_b64_tr_b16 v[202:203], v79 offset:2056
ds_read_b64_tr_b16 v[210:211], v79 offset:2560
ds_read_b64_tr_b16 v[218:219], v79 offset:2568
v_add_u32 v79, 81920, v77
s_waitcnt vmcnt(9)
s_waitcnt lgkmcnt(0)
s_barrier
ds_read_b64_tr_b16 v[224:225], v79 offset:0
ds_read_b64_tr_b16 v[232:233], v79 offset:8
ds_read_b64_tr_b16 v[240:241], v79 offset:512
ds_read_b64_tr_b16 v[248:249], v79 offset:520
ds_read_b64_tr_b16 v[226:227], v79 offset:2048
ds_read_b64_tr_b16 v[234:235], v79 offset:2056
ds_read_b64_tr_b16 v[242:243], v79 offset:2560
ds_read_b64_tr_b16 v[250:251], v79 offset:2568
v_add_u32 v79, 98304, v77
s_waitcnt vmcnt(5)
s_waitcnt lgkmcnt(0)
s_barrier
ds_read_b64_tr_b16 v[196:197], v79 offset:0
ds_read_b64_tr_b16 v[204:205], v79 offset:8
ds_read_b64_tr_b16 v[212:213], v79 offset:512
ds_read_b64_tr_b16 v[220:221], v79 offset:520
ds_read_b64_tr_b16 v[198:199], v79 offset:2048
ds_read_b64_tr_b16 v[206:207], v79 offset:2056
ds_read_b64_tr_b16 v[214:215], v79 offset:2560
ds_read_b64_tr_b16 v[222:223], v79 offset:2568
v_add_u32 v79, 114688, v77
s_waitcnt vmcnt(1)
s_waitcnt lgkmcnt(0)
s_barrier
ds_read_b64_tr_b16 v[228:229], v79 offset:0
ds_read_b64_tr_b16 v[236:237], v79 offset:8
ds_read_b64_tr_b16 v[244:245], v79 offset:512
ds_read_b64_tr_b16 v[252:253], v79 offset:520
ds_read_b64_tr_b16 v[230:231], v79 offset:2048
ds_read_b64_tr_b16 v[238:239], v79 offset:2056
ds_read_b64_tr_b16 v[246:247], v79 offset:2560
ds_read_b64_tr_b16 v[254:255], v79 offset:2568
s_waitcnt vmcnt(0) lgkmcnt(0)
L_st_done:
s_barrier
L_ga:
v_readfirstlane_b32 s68, v30
s_cmp_lt_u32 s68, 32
s_cbranch_scc1 L_ga_s
buffer_load_dword v32, v89, s[16:19], s64 offen offset:0 sc1
buffer_load_dword v33, v89, s[16:19], s64 offen offset:2048 sc1
buffer_load_dword v34, v89, s[16:19], s65 offen offset:0 sc1
buffer_load_dword v35, v89, s[16:19], s65 offen offset:2048 sc1
buffer_load_dword v36, v90, s[16:19], s66 offen offset:0 sc1
buffer_load_dword v37, v90, s[16:19], s66 offen offset:1024 sc1
buffer_load_dword v38, v90, s[16:19], s66 offen offset:2048 sc1
buffer_load_dword v39, v90, s[16:19], s66 offen offset:3072 sc1
buffer_load_dword v40, v90, s[16:19], s67 offen offset:0 sc1
buffer_load_dword v41, v90, s[16:19], s67 offen offset:1024 sc1
buffer_load_dword v42, v90, s[16:19], s67 offen offset:2048 sc1
v_lshlrev_b32 v88, 2, v0
ds_write_b32 v88, v24 offset:16384
v_ashrrev_i32 v90, 31, v94
v_and_b32 v90, 0x80000000, v90
v_xor_b32 v90, 0xe0000000, v90
v_lshlrev_b32 v30, 3, v15
v_and_b32 v30, 0xe0000000, v30
v_xor_b32 v89, v90, v30
ds_write_b32 v88, v30 offset:1024
ds_write_b32 v88, v89 offset:0
v_and_b32 v15, 0xe0000000, v15
v_xor_b32 v89, v90, v15
ds_write_b32 v88, v15 offset:3072
ds_write_b32 v88, v89 offset:2048
v_ashrrev_i32 v90, 31, v3
v_not_b32 v90, v90
s_waitcnt vmcnt(10)
v_and_b32 v32, v90, v32
s_waitcnt vmcnt(9)
v_and_b32 v33, v90, v33
s_waitcnt vmcnt(8)
v_and_b32 v34, v90, v34
s_waitcnt vmcnt(7)
v_and_b32 v35, v90, v35
s_waitcnt vmcnt(6)
v_and_b32 v36, v90, v36
s_waitcnt vmcnt(5)
v_and_b32 v37, v90, v37
s_waitcnt vmcnt(4)
v_and_b32 v38, v90, v38
s_waitcnt vmcnt(3)
v_and_b32 v39, v90, v39
s_waitcnt vmcnt(2)
v_and_b32 v40, v90, v40
s_waitcnt vmcnt(1)
v_and_b32 v41, v90, v41
s_waitcnt vmcnt(0)
v_and_b32 v42, v90, v42
v_lshlrev_b32 v88, 4, v0
ds_write_b128 v88, v[32:35] offset:4096
ds_write_b128 v88, v[36:39] offset:8192
ds_write_b128 v88, v[40:43] offset:12288
s_waitcnt vmcnt(0) lgkmcnt(0)
s_cmp_lg_u32 s3, 0
s_cbranch_scc1 L_nextb
s_lshl_b32 s57, s101, 13
s_add_u32 s100, s100, s57
s_xor_b32 s57, s100, 0x2000
s_mov_b32 s101, 0
s_memtime s[64:65]
s_waitcnt lgkmcnt(0)
buffer_load_dword v32, off, s[16:19], s100 offset:0 sc1
s_waitcnt vmcnt(0)
s_memtime s[66:67]
s_waitcnt lgkmcnt(0)
buffer_load_dword v33, off, s[16:19], s57 offset:0 sc1
s_waitcnt vmcnt(0)
s_memtime s[68:69]
s_waitcnt lgkmcnt(0)
s_sub_u32 s64, s66, s64
s_sub_u32 s66, s68, s66
s_cmp_lt_u32 s64, s66
s_cselect_b32 s64, 1, -1
s_add_u32 s101, s101, s64
v_mov_b32 v32, s101
s_mov_b64 exec, 1
buffer_atomic_add v32, off, s[20:23], 0 offset:192 sc1
s_mov_b64 exec, -1
L_nextb:
s_barrier
L_next:
s_and_b32 s55, s52, 15
s_lshr_b64 s[52:53], s[52:53], 4
s_and_b32 s58, s55, 3
s_cmp_lt_u32 s55, 8
s_cbranch_scc1 L_real
s_cmp_eq_u32 s55, 15
s_cbranch_scc1 L_cend
s_cmp_eq_u32 s55, 12
s_cbranch_scc1 L_stage2
s_cmp_eq_u32 s55, 13
s_cbranch_scc1 L_fin
s_cmp_eq_u32 s55, 14
s_cbranch_scc1 L_stage2a
s_cmp_eq_u32 s55, 8
s_cbranch_scc1 L_cw
s_cmp_lg_u32 s55, 10
s_cbranch_scc1 L_initjob
buffer_load_dword v88, off, s[20:23], 0 offset:224 sc1
s_waitcnt vmcnt(0)
v_readfirstlane_b32 s57, v88
s_cmp_eq_u32 s57, 0
s_cselect_b32 s63, 0x40000000, 0
L_initjob:
s_lshl_b32 s48, s58, 10
s_add_u32 s48, s48, 4096
s_mul_i32 s47, s58, 8192
v_add_u32 v14, s48, v8
ds_read_b64 v[92:93], v14
s_barrier
s_waitcnt lgkmcnt(0)
s_branch L_x2
L_ga_s:
s_sub_u32 s54, s54, 1
s_cbranch_scc1 L_end
s_sleep 4
buffer_load_dword v30, off, s[20:23], 0 offset:128 sc1
s_waitcnt vmcnt(0) lgkmcnt(0)
s_branch L_ga
L_real:
s_cmp_lg_u32 s55, 2
s_cbranch_scc1 L_dec
buffer_load_dword v88, off, s[20:23], 0 offset:192 sc1
s_waitcnt vmcnt(0)
v_readfirstlane_b32 s57, v88
s_lshr_b32 s57, s57, 31
s_lshl_b32 s57, s57, 13
s_xor_b32 s73, s73, s57
L_dec:
s_lshr_b32 s50, s55, 2
s_lshr_b32 s92, 0xc8, s55
s_and_b32 s92, s92, 1
s_or_b32 s31, s92, s59
s_lshl_b32 s91, s55, 1
s_lshr_b32 s91, 0xd4, s91
s_and_b32 s91, s91, 3
s_mov_b32 s98, 0
s_mov_b32 s99, s55
s_mov_b32 s44, 1048576
s_lshr_b32 s70, 10, s55
s_and_b32 s70, s70, 1
s_lshl_b32 s70, s70, 10
s_add_u32 s76, s55, 16
s_add_u32 s77, s55, 24
s_mul_i32 s45, s55, 32768
s_add_u32 s45, s45, 131072
s_mul_i32 s46, s55, 65536
s_add_u32 s46, s46, 393216
s_cmp_eq_u32 s58, 3
s_cselect_b32 s71, s73, 0
s_cselect_b32 s78, -1, 0x11111111
s_mov_b32 s79, s78
s_add_u32 s74, s45, s71
s_lshr_b32 s71, s71, 10
s_add_u32 s71, s71, s55
s_mul_i32 s72, s92, s73
s_add_u32 s75, s46, s72
s_lshr_b32 s72, s72, 10
s_add_u32 s72, s72, s55
s_mul_i32 s47, s58, 8192
s_add_u32 s47, s47, 32768
s_lshl_b32 s48, s58, 10
s_add_u32 s48, s48, 4096
s_mul_i32 s49, s58, 896
s_cmp_eq_u32 s55, 7
s_cselect_b32 s60, -1, 0xf000f
s_and_b32 s61, s60, 0x5555ffff
s_cmp_ge_u32 s2, 28
s_cselect_b32 s51, s50, 0
L_job:
v_add_u32 v14, s48, v8
ds_read_b64 v[92:93], v14
s_waitcnt lgkmcnt(0)
v_lshlrev_b32 v24, 16, v92
v_and_b32 v25, 0xffff0000, v92
v_lshlrev_b32 v26, 16, v93
v_and_b32 v27, 0xffff0000, v93
s_cmp_eq_u32 s59, 2
s_cbranch_scc1 L_xsp
s_bitcmp1_b32 0x30, s99
s_cbranch_scc1 L_xsk
L_s1a:
v_lshl_add_u32 v31, v0, 2, s70
ds_read_b32 v31, v31 offset:0
L_s1:
buffer_load_dwordx2 v[28:29], v2, s[16:19], s44 offen sc1
buffer_load_dwordx4 v[72:75], v1, s[16:19], s44 offen sc1
buffer_load_dwordx4 v[76:79], v94, s[16:19], s44 offen offset:2048 sc1
s_mov_b64 exec, -1
s_waitcnt vmcnt(0) lgkmcnt(0)
L_s1b:
v_lshlrev_b32 v91, 31, v28
v_lshlrev_b32 v89, 2, v31
v_cmp_ne_u32 vcc, v89, v91
s_cbranch_vccnz L_s1_s
v_max_f32_dpp v90, v29, v29 row_ror:4 row_mask:0xf bank_mask:0xf
v_alignbit_b32 v15, v72, v91, 1
v_alignbit_b32 v15, v76, v15, 1
v_max_f32_dpp v90, v90, v90 row_ror:8 row_mask:0xf bank_mask:0xf
v_cmp_ne_u32 vcc, v31, v15
v_and_b32 v72, -2, v72
v_max_f32_dpp v88, v90, v90 quad_perm:[1,0,3,2] row_mask:0xf bank_mask:0xf
v_and_b32 v76, -2, v76
s_cbranch_vccz L_s1f
s_mov_b64 exec, vcc
buffer_load_dwordx4 v[72:75], v1, s[16:19], s44 offen sc1
buffer_load_dwordx4 v[76:79], v94, s[16:19], s44 offen offset:2048 sc1
s_mov_b64 s[66:67], exec
s_mov_b64 exec, -1
s_mov_b32 s68, 1
v_max_f32_dpp v88, v88, v88 quad_perm:[2,3,0,1] row_mask:0xf bank_mask:0xf
v_mov_b32 v89, v88
v_and_b32 v28, -2, v28
s_nop 0
v_permlane16_swap_b32 v88, v89
v_max_f32 v88, v88, v89
v_mov_b32 v89, v88
s_nop 1
v_permlane32_swap_b32 v88, v89
v_max_f32 v88, v88, v89
v_sub_f32 v90, v90, v88
v_exp_f32 v90, v90
v_sub_f32 v29, v29, v88
v_cvt_pk_bf16_f32 v30, v90, v90
v_exp_f32 v90, v29
s_nop 0
v_and_b32_dpp v80, v30, v16 quad_perm:[0,0,0,0] row_mask:0xf bank_mask:0xf
v_and_b32_dpp v81, v30, v17 quad_perm:[0,0,0,0] row_mask:0xf bank_mask:0xf
v_mul_f32 v28, v90, v28
v_cndmask_b32 v28, 0, v28, s[60:61]
v_and_b32_dpp v82, v30, v18 quad_perm:[0,0,0,0] row_mask:0xf bank_mask:0xf
v_and_b32_dpp v83, v30, v19 quad_perm:[0,0,0,0] row_mask:0xf bank_mask:0xf
v_add_f32_dpp v28, v28, v28 row_ror:4 row_mask:0xf bank_mask:0xf
v_and_b32_dpp v84, v30, v16 quad_perm:[1,1,1,1] row_mask:0xf bank_mask:0xf
v_and_b32_dpp v85, v30, v17 quad_perm:[1,1,1,1] row_mask:0xf bank_mask:0xf
v_add_f32_dpp v28, v28, v28 row_ror:8 row_mask:0xf bank_mask:0xf
v_and_b32_dpp v86, v30, v18 quad_perm:[1,1,1,1] row_mask:0xf bank_mask:0xf
v_and_b32_dpp v87, v30, v19 quad_perm:[1,1,1,1] row_mask:0xf bank_mask:0xf
v_add_f32_dpp v28, v28, v28 quad_perm:[1,0,3,2] row_mask:0xf bank_mask:0xf
buffer_load_dwordx4 v[56:59], v1, s[16:19], s44 offen sc1
buffer_load_dwordx4 v[60:63], v94, s[16:19], s44 offen offset:2048 sc1
s_mov_b64 s[64:65], exec
s_branch L_s1e
L_s1B:
s_mov_b64 exec, -1
v_mfma_f32_16x16x32_bf16 v[64:67], v[80:83], v[56:59], 0
v_mfma_f32_16x16x32_bf16 v[64:67], v[84:87], v[60:63], v[64:67]
s_mov_b32 s68, 0
s_branch L_s1g
L_s1c:
s_mov_b64 exec, vcc
buffer_load_dwordx4 v[72:75], v1, s[16:19], s44 offen sc1
buffer_load_dwordx4 v[76:79], v94, s[16:19], s44 offen offset:2048 sc1
s_mov_b64 s[66:67], exec
s_sub_u32 s54, s54, 1
s_cbranch_scc1 L_end
s_mov_b64 exec, s[64:65]
s_waitcnt vmcnt(2)
v_alignbit_b32 v15, v56, v91, 1
v_alignbit_b32 v15, v60, v15, 1
v_cmp_ne_u32 vcc, v31, v15
v_and_b32 v56, -2, v56
v_and_b32 v60, -2, v60
s_cbranch_vccz L_s1B
s_mov_b64 exec, vcc
buffer_load_dwordx4 v[56:59], v1, s[16:19], s44 offen sc1
buffer_load_dwordx4 v[60:63], v94, s[16:19], s44 offen offset:2048 sc1
s_mov_b64 s[64:65], exec
L_s1e:
s_mov_b64 exec, s[66:67]
s_waitcnt vmcnt(2)
v_alignbit_b32 v15, v72, v91, 1
v_alignbit_b32 v15, v76, v15, 1
v_cmp_ne_u32 vcc, v31, v15
v_and_b32 v72, -2, v72
v_and_b32 v76, -2, v76
s_cbranch_vccnz L_s1c
s_mov_b64 exec, -1

L_s1d:
v_mfma_f32_16x16x32_bf16 v[64:67], v[80:83], v[72:75], 0
v_mfma_f32_16x16x32_bf16 v[64:67], v[84:87], v[76:79], v[64:67]
L_s1g:
v_add_f32_dpp v31, v28, v28 quad_perm:[2,3,0,1] row_mask:0xf bank_mask:0xf
v_mov_b32 v89, v31
v_add_u32 v91, s30, v8
v_mov_b32_dpp v88, v10 row_ror:4 row_mask:0xf bank_mask:0xf
v_mov_b32 v68, 0
v_mov_b32 v69, 0
v_mov_b32 v70, 0
v_mov_b32 v71, 0
v_cvt_pk_bf16_f32 v92, v64, v65
v_cvt_pk_bf16_f32 v93, v66, v67
ds_write_b64 v91, v[92:93]
v_mov_b32 v64, 0
v_mov_b32 v65, 0
v_mov_b32 v66, 0
v_mov_b32 v67, 0
s_cmp_eq_u32 s98, 3
s_cbranch_scc1 L_s1r
s_waitcnt lgkmcnt(0)
s_barrier
L_s1m:
ds_read_b128 v[32:35], v10 offset:0
ds_read_b128 v[36:39], v88 offset:0
ds_read_b128 v[40:43], v10 offset:128
ds_read_b128 v[44:47], v88 offset:128
ds_read_b128 v[48:51], v10 offset:256
ds_read_b128 v[52:55], v88 offset:256
s_cmp_eq_u32 s68, 0
s_cbranch_scc1 L_s1h
s_waitcnt vmcnt(0)
L_s1h:
ds_read_b128 v[56:59], v10 offset:384
ds_read_b128 v[60:63], v88 offset:384
v_lshlrev_b32 v30, 2, v0
ds_read_b32 v30, v30 offset:16384
s_cmp_lg_u32 s99, 7
s_cbranch_scc1 L_n6g
s_sub_u32 s57, s45, 32768
buffer_load_dwordx4 a[0:3], v3, s[16:19], s57 offen sc1
s_add_u32 s55, s57, 4096
buffer_load_dwordx4 a[4:7], v3, s[16:19], s55 offen sc1
s_add_u32 s55, s57, 16384
buffer_load_dwordx4 a[8:11], v3, s[16:19], s55 offen sc1
s_add_u32 s55, s57, 20480
buffer_load_dwordx4 a[12:15], v3, s[16:19], s55 offen sc1
L_n6g:
s_waitcnt lgkmcnt(8)
v_smfmac_f32_16x16x64_bf16 v[64:67], v[32:35], a[112:119], v7
s_waitcnt lgkmcnt(7)
v_smfmac_f32_16x16x64_bf16 v[64:67], v[36:39], a[128:135], v7
v_permlane16_swap_b32 v31, v89
s_waitcnt lgkmcnt(6)
v_smfmac_f32_16x16x64_bf16 v[64:67], v[40:43], a[144:151], v7
v_add_f32 v31, v31, v89
s_waitcnt lgkmcnt(5)
v_smfmac_f32_16x16x64_bf16 v[64:67], v[44:47], a[160:167], v7
v_mov_b32 v89, v31
s_waitcnt lgkmcnt(4)
v_smfmac_f32_16x16x64_bf16 v[64:67], v[48:51], a[176:183], v7
s_waitcnt lgkmcnt(3)
v_smfmac_f32_16x16x64_bf16 v[64:67], v[52:55], a[192:199], v7
v_permlane32_swap_b32 v31, v89
s_waitcnt lgkmcnt(2)
v_smfmac_f32_16x16x64_bf16 v[64:67], v[56:59], a[208:215], v7
v_add_f32 v31, v31, v89
s_waitcnt lgkmcnt(1)
v_smfmac_f32_16x16x64_bf16 v[64:67], v[60:63], a[224:231], v7
v_rcp_f32 v31, v31
v_smfmac_f32_16x16x64_bf16 v[68:71], v[32:35], a[120:127], v7
s_waitcnt lgkmcnt(0)
v_bfe_u32 v30, v30, s76, 1
v_smfmac_f32_16x16x64_bf16 v[68:71], v[36:39], a[136:143], v7
s_cmp_lg_u32 s51, 0
v_smfmac_f32_16x16x64_bf16 v[68:71], v[40:43], a[152:159], v7
v_smfmac_f32_16x16x64_bf16 v[68:71], v[44:47], a[168:175], v7
v_smfmac_f32_16x16x64_bf16 v[68:71], v[48:51], a[184:191], v7
v_pk_add_f32 v[64:65], v[64:65], v[66:67]
v_smfmac_f32_16x16x64_bf16 v[68:71], v[52:55], a[200:207], v7
v_add_f32 v64, v64, v65
v_smfmac_f32_16x16x64_bf16 v[68:71], v[56:59], a[216:223], v7
v_smfmac_f32_16x16x64_bf16 v[68:71], v[60:63], a[232:239], v7
v_mul_f32_dpp v66, v64, v31 quad_perm:[0,0,2,2] row_mask:0xf bank_mask:0xf
v_mul_f32_dpp v67, v64, v31 quad_perm:[1,1,3,3] row_mask:0xf bank_mask:0xf
v_mul_f32_dpp v65, v64, v31 quad_perm:[2,2,2,2] row_mask:0xf bank_mask:0xf
v_mul_f32_dpp v64, v64, v31 quad_perm:[3,3,3,3] row_mask:0xf bank_mask:0xf
v_cvt_pk_bf16_f32 v80, v66, v67
v_cvt_pk_bf16_f32 v81, v65, v64
v_and_or_b32 v80, v80, -2, v30
s_nop 0
v_pk_add_f32 v[68:69], v[68:69], v[70:71]
v_add_f32 v68, v68, v69
s_nop 1
v_mul_f32_dpp v70, v68, v31 quad_perm:[0,0,2,2] row_mask:0xf bank_mask:0xf
v_mul_f32_dpp v71, v68, v31 quad_perm:[1,1,3,3] row_mask:0xf bank_mask:0xf
v_mul_f32_dpp v69, v68, v31 quad_perm:[2,2,2,2] row_mask:0xf bank_mask:0xf
v_mul_f32_dpp v68, v68, v31 quad_perm:[3,3,3,3] row_mask:0xf bank_mask:0xf
v_cvt_pk_bf16_f32 v82, v70, v71
v_cvt_pk_bf16_f32 v83, v69, v68
s_mov_b64 exec, s[78:79]
buffer_store_dwordx4 v[80:83], v4, s[16:19], s45 offen sc1
s_mov_b64 exec, -1
s_cbranch_scc1 L_nextb
s_cmp_eq_u32 s98, 1
s_cbranch_scc1 L_ysa
s_cmp_eq_u32 s98, 2
s_cbranch_scc1 L_ysp
s_cmp_eq_u32 s99, 7
s_cbranch_scc1 L_x6
s_cmp_eq_u32 s91, 0
s_cbranch_scc1 L_xsp
s_add_u32 s44, s44, 147456
s_add_u32 s45, s45, 98304
s_xor_b32 s70, s70, 3072
s_add_u32 s76, s76, 3
L_xsp:
s_waitcnt vmcnt(0)
L_xsa:
buffer_load_dwordx4 v[56:59], v3, s[16:19], s74 offen sc1
s_add_u32 s55, s74, 4096
buffer_load_dwordx4 v[60:63], v3, s[16:19], s55 offen sc1
s_add_u32 s55, s74, 16384
buffer_load_dwordx4 v[72:75], v3, s[16:19], s55 offen sc1
s_add_u32 s55, s74, 20480
buffer_load_dwordx4 v[76:79], v3, s[16:19], s55 offen sc1
L_xsb:
v_lshlrev_b32 v31, 4, v0
ds_read_b128 v[40:43], v31 offset:4096
s_waitcnt lgkmcnt(0)
v_lshrrev_b32 v40, s71, v40
v_lshrrev_b32 v41, s71, v41
v_lshrrev_b32 v42, s71, v42
v_lshrrev_b32 v43, s71, v43
v_alignbit_b32 v31, v40, 0, 1
v_alignbit_b32 v31, v41, v31, 1
v_alignbit_b32 v31, v42, v31, 1
v_alignbit_b32 v31, v43, v31, 1
L_xsm:
s_waitcnt vmcnt(3)
v_alignbit_b32 v15, v56, 0, 1
v_and_b32 v56, -2, v56
s_waitcnt vmcnt(2)
v_alignbit_b32 v15, v60, v15, 1
v_and_b32 v60, -2, v60
v_mfma_f32_16x16x32_bf16 v[64:67], v[20:23], v[56:59], v[24:27]
s_waitcnt vmcnt(1)
v_alignbit_b32 v15, v72, v15, 1
v_and_b32 v72, -2, v72
v_mfma_f32_16x16x32_bf16 v[64:67], v[20:23], v[60:63], v[64:67]
s_waitcnt vmcnt(0)
v_alignbit_b32 v15, v76, v15, 1
v_and_b32 v76, -2, v76
v_cmp_ne_u32 vcc, v31, v15
v_mfma_f32_16x16x32_bf16 v[64:67], v[20:23], v[72:75], v[64:67]
s_cbranch_vccnz L_xs_s
v_mfma_f32_16x16x32_bf16 v[64:67], v[20:23], v[76:79], v[64:67]
L_xsc:
v_mov_b32 v68, 0
v_mov_b32 v69, 0
v_mov_b32 v70, 0
v_mov_b32 v71, 0
s_cmp_ge_u32 s2, 28
s_nop 2
v_cvt_pk_bf16_f32 v92, v64, v65
v_cvt_pk_bf16_f32 v93, v66, v67
ds_write_b64 v8, v[92:93] offset:1024
v_lshlrev_b32 v24, 16, v92
v_and_b32 v25, 0xffff0000, v92
v_lshlrev_b32 v26, 16, v93
v_and_b32 v27, 0xffff0000, v93
v_mov_b32 v64, 0
v_mov_b32 v65, 0
v_mov_b32 v66, 0
v_mov_b32 v67, 0
s_waitcnt lgkmcnt(0)
s_barrier
s_cbranch_scc1 L_noffn
ds_read_b128 v[80:83], v11 offset:1024
ds_read_b128 v[32:35], v9 offset:0
ds_read_b128 v[36:39], v9 offset:128
ds_read_b128 v[40:43], v9 offset:256
ds_read_b128 v[44:47], v9 offset:384
ds_read_b128 v[48:51], v9 offset:512
ds_read_b128 v[52:55], v9 offset:640
ds_read_b128 v[56:59], v9 offset:768
s_waitcnt lgkmcnt(7)
v_mfma_f32_16x16x32_bf16 v[84:87], v[80:83], v[80:83], 0
v_lshl_add_u32 v31, v0, 2, s70
ds_read_b32 v31, v31 offset:0
s_waitcnt lgkmcnt(7)
v_smfmac_f32_16x16x64_bf16 v[64:67], v[32:35], a[240:247], v7
v_lshlrev_b32 v30, 2, v0
v_smfmac_f32_16x16x64_bf16 v[68:71], v[32:35], a[248:255], v7
ds_read_b32 v30, v30 offset:16384
s_waitcnt lgkmcnt(7)
v_smfmac_f32_16x16x64_bf16 v[64:67], v[36:39], v[96:103], v7
v_cndmask_b32 v90, 0, v84, s[28:29]
s_waitcnt lgkmcnt(6)
v_smfmac_f32_16x16x64_bf16 v[64:67], v[40:43], v[112:119], v7
v_cndmask_b32 v91, 0, v84, s[80:81]
v_smfmac_f32_16x16x64_bf16 v[68:71], v[36:39], v[104:111], v7
v_add_f32_dpp v90, v90, v90 quad_perm:[1,0,3,2] row_mask:0xf bank_mask:0xf
v_cndmask_b32 v91, v91, v85, s[82:83]
s_waitcnt lgkmcnt(5)
v_smfmac_f32_16x16x64_bf16 v[64:67], v[44:47], v[128:135], v7
v_add_f32_dpp v90, v90, v90 quad_perm:[2,3,0,1] row_mask:0xf bank_mask:0xf
v_cndmask_b32 v91, v91, v86, s[84:85]
s_waitcnt lgkmcnt(4)
v_smfmac_f32_16x16x64_bf16 v[64:67], v[48:51], v[144:151], v7
v_add_f32_dpp v90, v90, v90 row_half_mirror row_mask:0xf bank_mask:0xf
v_cndmask_b32 v91, v91, v87, s[86:87]
v_smfmac_f32_16x16x64_bf16 v[68:71], v[40:43], v[120:127], v7
v_add_f32_dpp v90, v90, v90 row_mirror row_mask:0xf bank_mask:0xf
v_mov_b32 v80, v91
s_waitcnt lgkmcnt(3)
v_smfmac_f32_16x16x64_bf16 v[64:67], v[52:55], v[160:167], v7
v_mul_f32 v90, 0x3b124925, v90
s_waitcnt lgkmcnt(2)
v_smfmac_f32_16x16x64_bf16 v[64:67], v[56:59], v[176:183], v7
v_cvt_pk_bf16_f32 v88, 0, -v90
v_smfmac_f32_16x16x64_bf16 v[68:71], v[44:47], v[136:143], v7
v_permlane32_swap_b32 v91, v80
v_smfmac_f32_16x16x64_bf16 v[68:71], v[48:51], v[152:159], v7
v_mov_b32_dpp v88, v28 quad_perm:[0,1,2,3] row_mask:0x2 bank_mask:0xf
v_smfmac_f32_16x16x64_bf16 v[68:71], v[52:55], v[168:175], v7
v_add_f32 v91, v91, v80
v_smfmac_f32_16x16x64_bf16 v[68:71], v[56:59], v[184:191], v7
v_mov_b32 v80, v91
s_mov_b32 vcc_lo, 0xcccccccc
s_mov_b32 vcc_hi, 0xcccccccc
v_permlane16_swap_b32 v91, v80
v_add_f32 v91, v91, v80
v_pk_add_f32 v[64:65], v[64:65], v[66:67]
v_fmac_f32 v64, v88, v65
v_max_f32 v64, 0, v64
v_pk_add_f32 v[68:69], v[68:69], v[70:71]
v_fmac_f32 v68, v88, v69
v_mul_f32 v64, v64, v68
v_cvt_pk_bf16_f32 v64, v64, v64
ds_write_b16 v12, v64
v_add_f32_dpp v91, v91, v91 quad_perm:[1,0,3,2] row_mask:0xf bank_mask:0xf
v_mov_b32 v65, 0
v_mov_b32 v66, 0
v_add_f32_dpp v91, v91, v91 quad_perm:[2,3,0,1] row_mask:0xf bank_mask:0xf
v_mov_b32 v67, 0
v_mov_b32 v68, 0
v_add_f32_dpp v91, v91, v91 row_half_mirror row_mask:0xf bank_mask:0xf
v_mov_b32 v69, 0
v_mov_b32 v70, 0
v_add_f32_dpp v91, v91, v91 row_mirror row_mask:0xf bank_mask:0xf
v_mov_b32 v71, 0
v_mov_b32 v64, 0
s_waitcnt lgkmcnt(0)
s_barrier
ds_read_b128 v[32:35], v13 offset:0
ds_read_b128 v[36:39], v13 offset:128
ds_read_b128 v[40:43], v13 offset:256
ds_read_b128 v[44:47], v13 offset:384
s_cmp_eq_u32 s91, 0
s_cbranch_scc1 L_nemb2
buffer_load_dwordx2 v[28:29], v2, s[16:19], s44 offen sc1
buffer_load_dwordx4 v[72:75], v1, s[16:19], s44 offen sc1
buffer_load_dwordx4 v[76:79], v94, s[16:19], s44 offen offset:2048 sc1
L_nemb2:
v_mul_f32 v91, 0x3b124925, v91
v_fma_f32 v91, -v90, v90, v91
v_cvt_pk_bf16_f32 v91, 0, v91
v_add_f32 v91, 0x3727c5ac, v91
v_cvt_pk_bf16_f32 v91, 0, v91
s_waitcnt lgkmcnt(3)
v_smfmac_f32_16x16x64_bf16 v[64:67], v[32:35], v[192:199], v7
v_sqrt_f32 v91, v91
v_bfe_u32 v30, v30, s77, 1
s_waitcnt lgkmcnt(2)
v_smfmac_f32_16x16x64_bf16 v[64:67], v[36:39], v[208:215], v7
v_cvt_pk_bf16_f32 v91, 0, v91
v_rcp_f32 v89, v91
s_waitcnt lgkmcnt(1)
v_smfmac_f32_16x16x64_bf16 v[64:67], v[40:43], v[224:231], v7
v_mul_f32 v89, v89, v89
s_waitcnt lgkmcnt(0)
v_smfmac_f32_16x16x64_bf16 v[64:67], v[44:47], v[240:247], v7
v_readfirstlane_b32 s55, v89
v_smfmac_f32_16x16x64_bf16 v[68:71], v[32:35], v[200:207], v7
s_cmp_lg_u32 s50, 0
v_smfmac_f32_16x16x64_bf16 v[68:71], v[36:39], v[216:223], v7
v_mov_b32 v89, s55
v_smfmac_f32_16x16x64_bf16 v[68:71], v[40:43], v[232:239], v7
v_cndmask_b32 v89, v89, v29, vcc
v_smfmac_f32_16x16x64_bf16 v[68:71], v[44:47], v[248:255], v7
v_pk_add_f32 v[64:65], v[64:65], v[66:67]
v_cndmask_b32 v66, v64, v65, vcc
v_cndmask_b32 v67, v65, v64, vcc
s_mov_b32 s98, s91
v_mul_f32_dpp v64, v66, v89 quad_perm:[0,0,2,2] row_mask:0xf bank_mask:0xf
v_mul_f32_dpp v65, v66, v89 quad_perm:[1,1,3,3] row_mask:0xf bank_mask:0xf
v_mul_f32_dpp v66, v67, v89 quad_perm:[2,2,0,0] row_mask:0xf bank_mask:0xf
v_mul_f32_dpp v67, v67, v89 quad_perm:[3,3,1,1] row_mask:0xf bank_mask:0xf
v_pk_add_f32 v[68:69], v[68:69], v[70:71]
v_cndmask_b32 v70, v68, v69, vcc
v_cndmask_b32 v71, v69, v68, vcc
v_cvt_pk_bf16_f32 v80, v64, v65
v_cvt_pk_bf16_f32 v81, v66, v67
v_mul_f32_dpp v68, v70, v89 quad_perm:[0,0,2,2] row_mask:0xf bank_mask:0xf
v_mul_f32_dpp v69, v70, v89 quad_perm:[1,1,3,3] row_mask:0xf bank_mask:0xf
v_and_or_b32 v80, v80, -2, v30
v_mul_f32_dpp v70, v71, v89 quad_perm:[2,2,0,0] row_mask:0xf bank_mask:0xf
v_mul_f32_dpp v71, v71, v89 quad_perm:[3,3,1,1] row_mask:0xf bank_mask:0xf
v_cvt_pk_bf16_f32 v82, v68, v69
v_cvt_pk_bf16_f32 v83, v70, v71
s_mov_b64 exec, s[78:79]
buffer_store_dwordx4 v[80:83], v5, s[16:19], s46 offen sc1
s_mov_b64 exec, -1
s_cbranch_scc1 L_l2x
s_cmp_lg_u32 s91, 0
s_waitcnt vmcnt(1)
s_cbranch_scc1 L_s1b
L_ysp:
s_waitcnt vmcnt(0)
L_ysa:
buffer_load_dwordx4 v[32:35], v3, s[16:19], s75 offen sc1
s_add_u32 s55, s75, 4096
buffer_load_dwordx4 v[36:39], v3, s[16:19], s55 offen sc1
s_add_u32 s55, s75, 16384
buffer_load_dwordx4 v[40:43], v3, s[16:19], s55 offen sc1
s_add_u32 s55, s75, 20480
buffer_load_dwordx4 v[44:47], v3, s[16:19], s55 offen sc1
s_add_u32 s55, s75, 32768
buffer_load_dwordx4 v[48:51], v3, s[16:19], s55 offen sc1
s_add_u32 s55, s75, 36864
buffer_load_dwordx4 v[52:55], v3, s[16:19], s55 offen sc1
s_add_u32 s55, s75, 49152
buffer_load_dwordx4 v[56:59], v3, s[16:19], s55 offen sc1
L_ysb:
v_lshlrev_b32 v31, 4, v0
ds_read_b128 v[80:83], v31 offset:8192
ds_read_b128 v[84:87], v31 offset:12288
s_waitcnt lgkmcnt(1)
v_lshrrev_b32 v80, s72, v80
v_lshrrev_b32 v81, s72, v81
v_lshrrev_b32 v82, s72, v82
v_lshrrev_b32 v83, s72, v83
s_waitcnt lgkmcnt(0)
v_lshrrev_b32 v84, s72, v84
v_lshrrev_b32 v85, s72, v85
v_lshrrev_b32 v86, s72, v86
v_alignbit_b32 v31, v80, 0, 1
v_alignbit_b32 v31, v81, v31, 1
v_alignbit_b32 v31, v82, v31, 1
v_alignbit_b32 v31, v83, v31, 1
v_alignbit_b32 v31, v84, v31, 1
v_alignbit_b32 v31, v85, v31, 1
v_alignbit_b32 v31, v86, v31, 1
L_ysm:
s_waitcnt vmcnt(6)
v_alignbit_b32 v15, v32, 0, 1
v_and_b32 v32, -2, v32
s_waitcnt vmcnt(5)
v_alignbit_b32 v15, v36, v15, 1
v_and_b32 v36, -2, v36
v_mfma_f32_16x16x32_bf16 v[64:67], v[20:23], v[32:35], v[24:27]
s_waitcnt vmcnt(4)
v_alignbit_b32 v15, v40, v15, 1
v_and_b32 v40, -2, v40
v_mfma_f32_16x16x32_bf16 v[64:67], v[20:23], v[36:39], v[64:67]
s_waitcnt vmcnt(3)
v_alignbit_b32 v15, v44, v15, 1
v_and_b32 v44, -2, v44
v_mfma_f32_16x16x32_bf16 v[64:67], v[20:23], v[40:43], v[64:67]
s_waitcnt vmcnt(2)
v_alignbit_b32 v15, v48, v15, 1
v_and_b32 v48, -2, v48
v_mfma_f32_16x16x32_bf16 v[64:67], v[20:23], v[44:47], v[64:67]
s_waitcnt vmcnt(1)
v_alignbit_b32 v15, v52, v15, 1
v_and_b32 v52, -2, v52
v_mfma_f32_16x16x32_bf16 v[64:67], v[20:23], v[48:51], v[64:67]
s_waitcnt vmcnt(0)
v_alignbit_b32 v15, v56, v15, 1
v_and_b32 v56, -2, v56
v_cmp_ne_u32 vcc, v31, v15
v_mfma_f32_16x16x32_bf16 v[64:67], v[20:23], v[52:55], v[64:67]
s_cbranch_vccnz L_ys_s
v_mfma_f32_16x16x32_bf16 v[64:67], v[20:23], v[56:59], v[64:67]
L_ysc:
s_cmp_lg_u32 s50, 0
s_nop 6
v_cvt_pk_bf16_f32 v92, v64, v65
v_cvt_pk_bf16_f32 v93, v66, v67

s_cbranch_scc1 L_out
L_x2:
ds_write_b64 v8, v[92:93] offset:1024
ds_write_b64 v14, v[92:93]
v_mov_b32 v64, 0
v_mov_b32 v65, 0
v_mov_b32 v66, 0
v_mov_b32 v67, 0
v_mov_b32 v68, 0
v_mov_b32 v69, 0
v_mov_b32 v70, 0
v_mov_b32 v71, 0
s_waitcnt lgkmcnt(0)
s_barrier
ds_read_b128 v[80:83], v11 offset:1024
ds_read_b128 v[32:35], v9 offset:0
ds_read_b128 v[36:39], v9 offset:128
ds_read_b128 v[40:43], v9 offset:256
ds_read_b128 v[44:47], v9 offset:384
ds_read_b128 v[48:51], v9 offset:512
ds_read_b128 v[52:55], v9 offset:640
s_cmp_eq_u32 s98, 1
s_cbranch_scc1 L_xp
L_nxp:
s_waitcnt lgkmcnt(6)
v_mfma_f32_16x16x32_bf16 v[84:87], v[80:83], v[80:83], 0
v_lshl_add_u32 v31, v0, 2, s70
ds_read_b32 v31, v31 offset:0
s_waitcnt lgkmcnt(6)
v_smfmac_f32_16x16x64_bf16 v[64:67], v[32:35], a[0:7], v7
s_add_u32 s55, s47, 1572864
s_add_u32 s47, s47, s63
v_smfmac_f32_16x16x64_bf16 v[68:71], v[32:35], a[8:15], v7
ds_read_b128 v[32:35], v9 offset:768
s_waitcnt lgkmcnt(6)
v_smfmac_f32_16x16x64_bf16 v[64:67], v[36:39], a[16:23], v7
v_cndmask_b32 v91, 0, v84, s[80:81]
v_cndmask_b32 v91, v91, v85, s[82:83]
v_smfmac_f32_16x16x64_bf16 v[68:71], v[36:39], a[24:31], v7
v_cndmask_b32 v91, v91, v86, s[84:85]
v_cndmask_b32 v91, v91, v87, s[86:87]
s_waitcnt lgkmcnt(5)
v_smfmac_f32_16x16x64_bf16 v[64:67], v[40:43], a[32:39], v7
v_mov_b32 v80, v91
v_cndmask_b32 v90, 0, v84, s[28:29]
v_smfmac_f32_16x16x64_bf16 v[68:71], v[40:43], a[40:47], v7
v_permlane32_swap_b32 v91, v80
v_add_f32 v91, v91, v80
s_waitcnt lgkmcnt(4)
v_smfmac_f32_16x16x64_bf16 v[64:67], v[44:47], a[48:55], v7
v_mov_b32 v80, v91
v_add_f32_dpp v90, v90, v90 quad_perm:[1,0,3,2] row_mask:0xf bank_mask:0xf
v_smfmac_f32_16x16x64_bf16 v[68:71], v[44:47], a[56:63], v7
v_permlane16_swap_b32 v91, v80
v_add_f32 v91, v91, v80
s_waitcnt lgkmcnt(3)
v_smfmac_f32_16x16x64_bf16 v[64:67], v[48:51], a[64:71], v7
v_add_f32_dpp v90, v90, v90 quad_perm:[2,3,0,1] row_mask:0xf bank_mask:0xf
v_add_f32_dpp v91, v91, v91 quad_perm:[1,0,3,2] row_mask:0xf bank_mask:0xf
v_smfmac_f32_16x16x64_bf16 v[68:71], v[48:51], a[72:79], v7
v_add_f32_dpp v90, v90, v90 row_half_mirror row_mask:0xf bank_mask:0xf
v_add_f32_dpp v91, v91, v91 quad_perm:[2,3,0,1] row_mask:0xf bank_mask:0xf
s_waitcnt lgkmcnt(2)
v_smfmac_f32_16x16x64_bf16 v[64:67], v[52:55], a[80:87], v7
v_add_f32_dpp v90, v90, v90 row_mirror row_mask:0xf bank_mask:0xf
v_add_f32_dpp v91, v91, v91 row_half_mirror row_mask:0xf bank_mask:0xf
v_smfmac_f32_16x16x64_bf16 v[68:71], v[52:55], a[88:95], v7
v_mul_f32 v90, 0x3b124925, v90
v_add_f32_dpp v91, v91, v91 row_mirror row_mask:0xf bank_mask:0xf
s_waitcnt lgkmcnt(0)
v_smfmac_f32_16x16x64_bf16 v[64:67], v[32:35], a[96:103], v7
v_cvt_pk_bf16_f32 v88, 0, -v90
v_mul_f32 v91, 0x3b124925, v91
v_smfmac_f32_16x16x64_bf16 v[68:71], v[32:35], a[104:111], v7
v_fma_f32 v91, -v90, v90, v91
v_cvt_pk_bf16_f32 v91, 0, v91
v_add_f32 v91, 0x3727c5ac, v91
v_cvt_pk_bf16_f32 v91, 0, v91
v_sqrt_f32 v91, v91
v_pk_add_f32 v[64:65], v[64:65], v[66:67]
v_cvt_pk_bf16_f32 v91, 0, v91
v_fmac_f32 v64, v88, v65
v_rcp_f32 v89, v91
v_pk_add_f32 v[68:69], v[68:69], v[70:71]
v_fmac_f32 v68, v88, v69
v_mul_f32 v65, v89, v64
v_mul_f32 v69, v89, v68
v_mul_f32_dpp v66, v64, v89 quad_perm:[1,1,3,3] row_mask:0xf bank_mask:0xf
v_mul_f32_dpp v70, v68, v89 quad_perm:[1,1,3,3] row_mask:0xf bank_mask:0xf
v_cvt_pk_bf16_f32 v80, v65, v66
v_cvt_pk_bf16_f32 v82, v69, v70
s_nop 0
v_mov_b32_dpp v81, v80 quad_perm:[2,2,2,2] row_mask:0xf bank_mask:0xf
v_mov_b32_dpp v83, v82 quad_perm:[2,2,2,2] row_mask:0xf bank_mask:0xf
buffer_store_dwordx4 v[80:83], v6, s[16:19], s55 offen
buffer_store_dwordx4 v[80:83], v6, s[16:19], s47 offen sc1
s_cmp_lg_u32 s99, 3
s_cbranch_scc1 L_next
s_mov_b32 s51, 1
s_mov_b32 s78, 0x11111111
s_mov_b32 s79, s78
v_mov_b32_dpp v88, v10 row_ror:4 row_mask:0xf bank_mask:0xf
v_add_f32_dpp v31, v28, v28 quad_perm:[2,3,0,1] row_mask:0xf bank_mask:0xf
v_mov_b32 v64, 0
v_mov_b32 v65, 0
v_mov_b32 v66, 0
v_mov_b32 v67, 0
v_mov_b32 v68, 0
v_mov_b32 v69, 0
v_mov_b32 v70, 0
v_mov_b32 v71, 0
v_mov_b32 v89, v31
s_mov_b32 s68, 0
s_branch L_s1m
L_s1r:
s_mov_b32 s98, 0
s_cmp_lt_u32 s2, 28
s_cbranch_scc1 L_ysp
s_sleep 10
s_branch L_ysp
L_xsk:
v_lshlrev_b32 v31, 4, v0
ds_read_b128 v[40:43], v31 offset:4096
s_waitcnt lgkmcnt(0)
v_lshrrev_b32 v40, s71, v40
v_lshrrev_b32 v41, s71, v41
v_lshrrev_b32 v42, s71, v42
v_lshrrev_b32 v43, s71, v43
v_alignbit_b32 v31, v40, 0, 1
v_alignbit_b32 v31, v41, v31, 1
v_alignbit_b32 v31, v42, v31, 1
v_alignbit_b32 v31, v43, v31, 1
s_waitcnt vmcnt(2)
s_barrier
v_alignbit_b32 v15, v56, 0, 1
v_and_b32 v56, -2, v56
v_alignbit_b32 v15, v60, v15, 1
v_and_b32 v60, -2, v60
v_mfma_f32_16x16x32_bf16 v[64:67], v[20:23], v[56:59], v[24:27]
v_alignbit_b32 v15, v72, v15, 1
v_and_b32 v72, -2, v72
v_mfma_f32_16x16x32_bf16 v[64:67], v[20:23], v[60:63], v[64:67]
v_alignbit_b32 v15, v76, v15, 1
v_and_b32 v76, -2, v76
v_cmp_ne_u32 vcc, v31, v15
v_mfma_f32_16x16x32_bf16 v[64:67], v[20:23], v[72:75], v[64:67]
s_cbranch_vccnz L_xs_s
v_mfma_f32_16x16x32_bf16 v[64:67], v[20:23], v[76:79], v[64:67]
s_branch L_xsc
L_cw:
s_mov_b64 exec, 0
L_x6:
v_lshlrev_b32 v31, 4, v0
ds_read_b128 v[40:43], v31 offset:4096
ds_read_b64 v[92:93], v8 offset:6144
v_mov_b32_dpp v5, v5 quad_perm:[0,1,0,1] row_mask:0xf bank_mask:0xf
v_and_b32 v88, 2, v0
v_xor_b32 v88, 2, v88
v_lshl_add_u32 v5, v88, 15, v5
s_sub_u32 s46, s46, 65536
s_waitcnt lgkmcnt(0)
v_lshlrev_b32 v48, 16, v92
v_and_b32 v49, 0xffff0000, v92
v_lshlrev_b32 v50, 16, v93
v_and_b32 v51, 0xffff0000, v93
v_lshrrev_b32 v40, 6, v40
v_lshrrev_b32 v41, 6, v41
v_lshrrev_b32 v42, 6, v42
v_lshrrev_b32 v43, 6, v43
v_alignbit_b32 v31, v40, 0, 1
v_alignbit_b32 v31, v41, v31, 1
v_alignbit_b32 v31, v42, v31, 1
v_alignbit_b32 v31, v43, v31, 1
s_sub_u32 s71, s71, 6
s_waitcnt vmcnt(1)
L_x6r:
v_accvgpr_read_b32 v32, a0
v_accvgpr_read_b32 v33, a4
v_accvgpr_read_b32 v34, a8
v_accvgpr_read_b32 v35, a12
v_alignbit_b32 v15, v32, 0, 1
v_alignbit_b32 v15, v33, v15, 1
v_alignbit_b32 v15, v34, v15, 1
v_alignbit_b32 v15, v35, v15, 1
v_cmp_ne_u32 vcc, v31, v15
s_cbranch_vccnz L_x6_s
v_and_b32 v32, -2, v32
v_and_b32 v33, -2, v33
v_and_b32 v34, -2, v34
v_and_b32 v35, -2, v35
v_accvgpr_write_b32 a0, v32
v_accvgpr_write_b32 a4, v33
v_accvgpr_write_b32 a8, v34
v_accvgpr_write_b32 a12, v35
v_mfma_f32_16x16x32_bf16 v[64:67], v[20:23], a[0:3], v[48:51]
v_mfma_f32_16x16x32_bf16 v[64:67], v[20:23], a[4:7], v[64:67]
v_mfma_f32_16x16x32_bf16 v[64:67], v[20:23], a[8:11], v[64:67]
v_mfma_f32_16x16x32_bf16 v[64:67], v[20:23], a[12:15], v[64:67]
s_nop 7
v_cvt_pk_bf16_f32 v92, v64, v65
v_cvt_pk_bf16_f32 v93, v66, v67
ds_write_b64 v8, v[92:93] offset:4224
v_add_u32 v88, 3200, v11
s_mov_b32 vcc_lo, 0x30003
s_mov_b32 vcc_hi, 0x30003
v_cndmask_b32 v88, v88, v11, vcc
s_waitcnt lgkmcnt(0)
s_barrier
ds_read_b128 v[80:83], v88 offset:1024
s_waitcnt vmcnt(0)
buffer_load_dwordx4 v[56:59], v3, s[16:19], s74 offen sc1
s_add_u32 s55, s74, 4096
buffer_load_dwordx4 v[60:63], v3, s[16:19], s55 offen sc1
s_add_u32 s55, s74, 16384
buffer_load_dwordx4 v[72:75], v3, s[16:19], s55 offen sc1
s_add_u32 s55, s74, 20480
buffer_load_dwordx4 v[76:79], v3, s[16:19], s55 offen sc1
s_waitcnt lgkmcnt(0)
v_mfma_f32_16x16x32_bf16 v[84:87], v[80:83], v[80:83], 0
v_lshrrev_b32 v40, s71, v40
v_lshrrev_b32 v41, s71, v41
v_lshrrev_b32 v42, s71, v42
v_lshrrev_b32 v43, s71, v43
v_alignbit_b32 v31, v40, 0, 1
v_alignbit_b32 v31, v41, v31, 1
v_alignbit_b32 v31, v42, v31, 1
v_alignbit_b32 v31, v43, v31, 1
v_cndmask_b32 v91, 0, v84, s[80:81]
v_cndmask_b32 v91, v91, v85, s[82:83]
v_cndmask_b32 v91, v91, v86, s[84:85]
v_cndmask_b32 v91, v91, v87, s[86:87]
v_mov_b32 v80, v91
v_cndmask_b32 v90, 0, v84, s[28:29]
s_nop 0
v_permlane32_swap_b32 v91, v80
v_add_f32 v91, v91, v80
v_mov_b32 v80, v91
v_add_f32_dpp v90, v90, v90 quad_perm:[1,0,3,2] row_mask:0xf bank_mask:0xf
s_nop 0
v_permlane16_swap_b32 v91, v80
v_add_f32 v91, v91, v80
v_add_f32_dpp v90, v90, v90 quad_perm:[2,3,0,1] row_mask:0xf bank_mask:0xf
s_nop 0
v_add_f32_dpp v91, v91, v91 quad_perm:[1,0,3,2] row_mask:0xf bank_mask:0xf
v_add_f32_dpp v90, v90, v90 row_half_mirror row_mask:0xf bank_mask:0xf
s_nop 0
v_add_f32_dpp v91, v91, v91 quad_perm:[2,3,0,1] row_mask:0xf bank_mask:0xf
v_add_f32_dpp v90, v90, v90 row_mirror row_mask:0xf bank_mask:0xf
s_nop 0
v_add_f32_dpp v91, v91, v91 row_half_mirror row_mask:0xf bank_mask:0xf
v_mul_f32 v90, 0x3b124925, v90
s_nop 0
v_add_f32_dpp v91, v91, v91 row_mirror row_mask:0xf bank_mask:0xf
v_cvt_pk_bf16_f32 v28, 0, -v90
v_mul_f32 v91, 0x3b124925, v91
v_fma_f32 v91, -v90, v90, v91
v_readfirstlane_b32 s57, v28
v_cvt_pk_bf16_f32 v91, 0, v91
v_add_f32 v91, 0x3727c5ac, v91
v_cvt_pk_bf16_f32 v91, 0, v91
v_sqrt_f32 v91, v91
s_nop 0
v_cvt_pk_bf16_f32 v91, 0, v91
v_rcp_f32 v29, v91
v_mov_b32 v28, s57
v_mul_f32 v29, v29, v29
s_nop 0
v_readfirstlane_b32 s57, v29
s_nop 1
v_mov_b32 v29, s57
s_waitcnt vmcnt(3)
v_alignbit_b32 v15, v56, 0, 1
v_and_b32 v56, -2, v56
s_waitcnt vmcnt(2)
v_alignbit_b32 v15, v60, v15, 1
v_and_b32 v60, -2, v60
v_mfma_f32_16x16x32_bf16 v[64:67], v[20:23], v[56:59], v[24:27]
s_waitcnt vmcnt(1)
v_alignbit_b32 v15, v72, v15, 1
v_and_b32 v72, -2, v72
v_mfma_f32_16x16x32_bf16 v[64:67], v[20:23], v[60:63], v[64:67]
s_waitcnt vmcnt(0)
v_alignbit_b32 v15, v76, v15, 1
v_and_b32 v76, -2, v76
v_cmp_ne_u32 vcc, v31, v15
v_mfma_f32_16x16x32_bf16 v[64:67], v[20:23], v[72:75], v[64:67]
s_cbranch_vccnz L_xs_s
v_mfma_f32_16x16x32_bf16 v[64:67], v[20:23], v[76:79], v[64:67]
s_cbranch_execnz L_xsc
s_branch L_l2w
L_x6_s:
s_sub_u32 s54, s54, 1
s_cbranch_scc1 L_end
s_nop 7
buffer_load_dwordx4 a[0:3], v3, s[16:19], s57 offen sc1
s_add_u32 s55, s57, 4096
buffer_load_dwordx4 a[4:7], v3, s[16:19], s55 offen sc1
s_add_u32 s55, s57, 16384
buffer_load_dwordx4 a[8:11], v3, s[16:19], s55 offen sc1
s_add_u32 s55, s57, 20480
buffer_load_dwordx4 a[12:15], v3, s[16:19], s55 offen sc1
s_waitcnt vmcnt(0) lgkmcnt(0)
s_branch L_x6r
L_noffn:
s_max_u32 s98, s91, 2
s_cmp_eq_u32 s91, 0
s_cbranch_scc1 L_nf2
s_mov_b32 s68, 1
s_branch L_s1a
L_nf2:
s_cmp_lg_u32 s99, 6
s_cbranch_scc1 L_nsw
v_swap_b32 v20, v21
v_swap_b32 v22, v23
L_nsw:
s_sleep 26
s_branch L_ysp
L_l2x:
s_cmp_lg_u32 s99, 7
s_cbranch_scc1 L_next
s_xor_b32 s55, s2, s3
s_and_b32 s55, s55, 0xfb
s_cbranch_scc1 L_next
L_l2w:
v_subrev_u32 v6, 147456, v8
v_and_b32 v88, 0x80000000, v3
v_or_b32 v6, v6, v88
s_cmp_lt_u32 s2, 4
s_cbranch_scc1 L_l2y
ds_read_b64 v[92:93], v8 offset:4224
v_swap_b32 v20, v21
v_swap_b32 v22, v23
s_sub_u32 s75, s75, 65536
s_sub_u32 s72, s72, 1
s_sub_u32 s49, s49, 896
s_waitcnt lgkmcnt(0)
v_lshlrev_b32 v24, 16, v92
v_and_b32 v25, 0xffff0000, v92
v_lshlrev_b32 v26, 16, v93
v_and_b32 v27, 0xffff0000, v93
L_l2y:
s_nop 2
s_cbranch_execnz L_ysp
s_branch L_out
L_fin:
s_sub_u32 s58, s2, 28
s_cmp_ge_u32 s58, 2
s_cbranch_scc1 L_cend
s_add_u32 s55, s58, 4
s_mov_b32 s59, 2
v_subrev_u32 v6, 147456, v8
v_and_b32 v88, 0x80000000, v3
v_or_b32 v6, v6, v88
s_branch L_dec
L_out:
buffer_store_dwordx2 v[92:93], v6, s[40:43], s49 offen
s_cbranch_execz L_cwe
L_cwe:
s_mov_b64 exec, -1
s_branch L_next
L_xs_s:
s_sub_u32 s54, s54, 1
s_cbranch_scc1 L_end
v_cndmask_b32 v31, 0, v31, vcc
s_mov_b64 exec, vcc
s_nop 7
buffer_load_dwordx4 v[56:59], v3, s[16:19], s74 offen sc1
s_add_u32 s55, s74, 4096
buffer_load_dwordx4 v[60:63], v3, s[16:19], s55 offen sc1
s_add_u32 s55, s74, 16384
buffer_load_dwordx4 v[72:75], v3, s[16:19], s55 offen sc1
s_add_u32 s55, s74, 20480
buffer_load_dwordx4 v[76:79], v3, s[16:19], s55 offen sc1
s_mov_b64 exec, -1
s_branch L_xsm
L_ys_s:
s_sub_u32 s54, s54, 1
s_cbranch_scc1 L_end
v_cndmask_b32 v31, 0, v31, vcc
s_mov_b64 exec, vcc
s_nop 7
buffer_load_dwordx4 v[32:35], v3, s[16:19], s75 offen sc1
s_add_u32 s55, s75, 4096
buffer_load_dwordx4 v[36:39], v3, s[16:19], s55 offen sc1
s_add_u32 s55, s75, 16384
buffer_load_dwordx4 v[40:43], v3, s[16:19], s55 offen sc1
s_add_u32 s55, s75, 20480
buffer_load_dwordx4 v[44:47], v3, s[16:19], s55 offen sc1
s_add_u32 s55, s75, 32768
buffer_load_dwordx4 v[48:51], v3, s[16:19], s55 offen sc1
s_add_u32 s55, s75, 36864
buffer_load_dwordx4 v[52:55], v3, s[16:19], s55 offen sc1
s_add_u32 s55, s75, 49152
buffer_load_dwordx4 v[56:59], v3, s[16:19], s55 offen sc1
s_mov_b64 exec, -1
s_branch L_ysm
L_s1_s:
s_sub_u32 s54, s54, 1
s_cbranch_scc1 L_end
s_mov_b64 exec, vcc
s_branch L_s1
L_xp:
buffer_load_dwordx4 v[56:59], v3, s[16:19], s45 offen sc1
s_add_u32 s55, s45, 4096
buffer_load_dwordx4 v[60:63], v3, s[16:19], s55 offen sc1
s_add_u32 s55, s45, 16384
buffer_load_dwordx4 v[72:75], v3, s[16:19], s55 offen sc1
s_add_u32 s55, s45, 20480
buffer_load_dwordx4 v[76:79], v3, s[16:19], s55 offen sc1
s_branch L_nxp
L_s1f:
v_max_f32_dpp v88, v88, v88 quad_perm:[2,3,0,1] row_mask:0xf bank_mask:0xf
v_mov_b32 v89, v88
v_and_b32 v28, -2, v28
s_nop 0
v_permlane16_swap_b32 v88, v89
v_max_f32 v88, v88, v89
v_mov_b32 v89, v88
s_nop 1
v_permlane32_swap_b32 v88, v89
v_max_f32 v88, v88, v89
v_sub_f32 v90, v90, v88
v_exp_f32 v90, v90
v_sub_f32 v29, v29, v88
v_cvt_pk_bf16_f32 v30, v90, v90
v_exp_f32 v90, v29
s_nop 0
v_and_b32_dpp v80, v30, v16 quad_perm:[0,0,0,0] row_mask:0xf bank_mask:0xf
v_and_b32_dpp v81, v30, v17 quad_perm:[0,0,0,0] row_mask:0xf bank_mask:0xf
v_mul_f32 v28, v90, v28
v_cndmask_b32 v28, 0, v28, s[60:61]
v_and_b32_dpp v82, v30, v18 quad_perm:[0,0,0,0] row_mask:0xf bank_mask:0xf
v_and_b32_dpp v83, v30, v19 quad_perm:[0,0,0,0] row_mask:0xf bank_mask:0xf
v_add_f32_dpp v28, v28, v28 row_ror:4 row_mask:0xf bank_mask:0xf
v_and_b32_dpp v84, v30, v16 quad_perm:[1,1,1,1] row_mask:0xf bank_mask:0xf
v_and_b32_dpp v85, v30, v17 quad_perm:[1,1,1,1] row_mask:0xf bank_mask:0xf
v_add_f32_dpp v28, v28, v28 row_ror:8 row_mask:0xf bank_mask:0xf
v_and_b32_dpp v86, v30, v18 quad_perm:[1,1,1,1] row_mask:0xf bank_mask:0xf
v_and_b32_dpp v87, v30, v19 quad_perm:[1,1,1,1] row_mask:0xf bank_mask:0xf
v_add_f32_dpp v28, v28, v28 quad_perm:[1,0,3,2] row_mask:0xf bank_mask:0xf
s_mov_b32 s68, 0
s_branch L_s1d
L_cend:
s_branch L_end
L_end:
s_endpgm
L_codeend:
.section .rodata,"a"
.p2align 6
.amdhsa_kernel interleave_layers__mha_block_cached__glu_gated_reglu__decode_kernel
  .amdhsa_next_free_vgpr 512
  .amdhsa_next_free_sgpr 102
  .amdhsa_accum_offset 256
  .amdhsa_group_segment_fixed_size 0
  .amdhsa_kernarg_size 96
  .amdhsa_user_sgpr_count 2
  .amdhsa_user_sgpr_kernarg_segment_ptr 1
  .amdhsa_system_sgpr_workgroup_id_x 1
.end_amdhsa_kernel
```
